```python
import torch

def _softmax(x, axis=-1):
    return torch.softmax(x, dim=axis)
def _gelu(x):
    return torch.nn.functional.gelu(x, approximate="tanh")
def _silu(x):
    return torch.nn.functional.silu(x)
def _sigmoid(x):
    return torch.sigmoid(x)
def _layernorm(x, axis=-1, eps=1e-5):
    m = x.mean(dim=axis, keepdim=True)
    v = x.var(dim=axis, keepdim=True, unbiased=False)
    return (x - m) / torch.sqrt(v + eps)
def _scatter_add(tgt, idx, src, axis=0):
    return tgt.clone().index_add_(axis, idx, src)
def _segment_sum(src, seg, n):
    out = torch.zeros((n,) + src.shape[1:], dtype=src.dtype)
    return out.index_add_(0, seg, src)
def _pad(x, pw):
    flat = tuple(v for pair in reversed(pw) for v in pair)
    return torch.nn.functional.pad(x, flat)

kernel_name = 'gated_mix__linear_kernel_hedgehog__sliding_local_dilated__prompt'

def setup_inputs():

    _w = (lambda a: (lambda t: t.to(torch.bfloat16) if t.is_floating_point() else t)(torch.as_tensor(a)))
    def _A_setup():
        B, S, D, H = 1, 2048, 512, 32
        Dh = D // H
        return {
            "x": _w((lambda *s: torch.randn(*s, dtype=torch.bfloat16) * 0.05)(B, S, D)),
            "wqkv": _w((lambda *s: torch.randn(*s, dtype=torch.bfloat16) * 1.6)(D, 3 * D)),
            "w_phi": _w((lambda *s: torch.randn(*s, dtype=torch.bfloat16) * 1.6)(H, Dh, Dh) * (Dh ** -0.5)),
            "wo": _w((lambda *s: torch.randn(*s, dtype=torch.bfloat16) * 0.1)(D, D)),
        }
    _A_in = _A_setup()

    def _B_setup():
        B, S, D = 1, 2048, 512
        return {
            "x": _w((lambda *s: torch.randn(*s, dtype=torch.bfloat16) * 0.05)(B, S, D)),
            "wqkv": _w((lambda *s: torch.randn(*s, dtype=torch.bfloat16) * 0.8)(D, 3 * D)),
            "wo": _w((lambda *s: torch.randn(*s, dtype=torch.bfloat16) * 0.05)(D, D)),
        }
    _B_in = _B_setup()

    return {
        "A_x": _A_in["x"],
        "A_wqkv": _A_in["wqkv"],
        "A_w_phi": _A_in["w_phi"],
        "A_wo": _A_in["wo"],
        "B_x": _B_in["x"],
        "B_wqkv": _B_in["wqkv"],
        "B_wo": _B_in["wo"],
        "gate_w": _w((lambda *s: torch.randn(*s, dtype=torch.bfloat16) * 0.05)(512) * 16.0),
    }

def reference(A_x, A_wqkv, A_w_phi, A_wo, B_x, B_wqkv, B_wo, gate_w):
    def _A_ref(x, wqkv, w_phi, wo):
        B, S, D = x.shape
        H = 32; Dh = D // H
        qkv = (lambda x, *d: x.permute(*d))((x @ wqkv).reshape(B, S, 3, H, Dh), 2, 0, 3, 1, 4)
        q, k, v = qkv[0], qkv[1], qkv[2]
        pq = torch.einsum("bhsd,hdf->bhsf", q, w_phi)
        pk = torch.einsum("bhsd,hdf->bhsf", k, w_phi)
        phi_q = torch.concatenate([_softmax(pq, axis=-1), _softmax(-pq, axis=-1)], axis=-1)
        phi_k = torch.concatenate([_softmax(pk, axis=-1), _softmax(-pk, axis=-1)], axis=-1)
        kv = torch.einsum("bhsf,bhsd->bhfd", phi_k, v)
        z  = torch.einsum("bhsf->bhf", phi_k)
        num = torch.einsum("bhqf,bhfd->bhqd", phi_q, kv)
        den = torch.einsum("bhqf,bhf->bhq", phi_q, z)[..., None] + 1e-6
        o = num / den
        return (lambda x, *d: x.permute(*d))(o, 0, 2, 1, 3).reshape(B, S, D) @ wo

    def _B_ref(x, wqkv, wo):
        B, S, D = x.shape
        H = 32; Dh = D // H
        W, dil = 8, 2
        qkv = (lambda x, *d: x.permute(*d))((x @ wqkv).reshape(B, S, 3, H, Dh), 2, 0, 3, 1, 4)
        q, k, v = qkv[0], qkv[1], qkv[2]
        scale = Dh ** -0.5
        pos = torch.arange(S)
        off = torch.arange(W) * dil
        idx = pos[:, None] - off[None, :]
        mask = idx >= 0
        idx_c = torch.where(mask, idx, 0).reshape(-1)
        kg = k[:, :, idx_c, :].reshape(B, H, S, W, Dh)
        vg = v[:, :, idx_c, :].reshape(B, H, S, W, Dh)
        logits = torch.einsum("bhsd,bhswd->bhsw", q, kg) * scale
        logits = torch.where(mask[None, None, :, :], logits, -1e9)
        attn = _softmax(logits, axis=-1)
        o = torch.einsum("bhsw,bhswd->bhsd", attn, vg)
        return (lambda x, *d: x.permute(*d))(o, 0, 2, 1, 3).reshape(B, S, D) @ wo

    x = A_x
    g = _sigmoid((x * gate_w).sum(-1, keepdims=True))
    a = _A_ref(x, A_wqkv, A_w_phi, A_wo)
    b = _B_ref(x, B_wqkv, B_wo)
    return g * a + (1 - g) * b
```

```asm
; @launch grid=(256,1,1) block=(512,1,1) lds=163840
.amdgcn_target "amdgcn-amd-amdhsa--gfx950"
.text
.globl gated_mix__linear_kernel_hedgehog__sliding_local_dilated__prompt_kernel
.p2align 8
.type gated_mix__linear_kernel_hedgehog__sliding_local_dilated__prompt_kernel,@function
gated_mix__linear_kernel_hedgehog__sliding_local_dilated__prompt_kernel:
    s_load_dwordx2 s[4:5], s[0:1], 0
    s_load_dwordx2 s[12:13], s[0:1], 8
    s_load_dwordx2 s[16:17], s[0:1], 40
    v_lshrrev_b32 v7, 6, v0
    s_cmpk_ge_u32 s2, 256
    s_cbranch_scc1 L_end
    v_readfirstlane_b32 s88, v7
    s_bfe_u32 s82, s2, 0x30003
    s_cmp_eq_u32 s88, 4
    s_cbranch_scc0 L_top
    s_getpc_b64 s[94:95]
    s_mul_i32 s92, s82, 48
    v_and_b32 v254, 63, v0
    v_min_u32 v254, 47, v254
    v_add_lshl_u32 v254, v254, s92, 7
    global_load_dword v255, v254, s[94:95]
L_top:
    v_bfe_u32 v8, v0, 3, 3
    s_and_b32 s86, s2, 1
    s_lshl3_add_u32 s86, s86, s82
    v_and_b32 v9, 7, v0
    s_lshr_b32 s92, s86, 1
    v_bfe_u32 v10, v0, 4, 2
    s_lshl_b32 s92, s92, 8
    v_lshl_add_u32 v11, v7, 4, v8
    s_and_b32 s83, s86, 1
    v_xor_b32 v12, v9, v10
    s_or_b32 s92, s92, s83
    v_lshlrev_b32 v11, 11, v11
    s_lshl_b32 s98, s92, 10
    v_lshl_or_b32 v11, v12, 4, v11
    s_mov_b32 s7, 0x20000
    v_add_u32 v2, s98, v11
    s_lshl_b32 s6, s7, 4
    s_lshl_b32 s80, s88, 11
    v_xor_b32 v3, 64, v2
    s_lshr_b32 s83, s2, 6
    v_add_u32 v3, 0x4000, v3
    s_lshl1_add_u32 s91, s83, s82
    s_and_b32 s91, s91, 7
    s_lshl_b32 s64, s91, 7
    s_cmp_ge_u32 s88, 4
    s_cbranch_scc1 L_upper
    s_mov_b32 m0, s80
    s_waitcnt lgkmcnt(0)
    buffer_load_dwordx4 v2, s[4:7], s64 offen lds
    s_addk_i32 m0, 0x400
    v_add_u32 v32, s7, v2
    buffer_load_dwordx4 v3, s[4:7], s64 offen lds
    s_addk_i32 m0, 0x1c00
    v_add_u32 v33, s7, v3
    buffer_load_dwordx4 v32, s[4:7], s64 offen lds
    s_addk_i32 m0, 0x400
    s_cmpk_ge_u32 s2, 128
    buffer_load_dwordx4 v33, s[4:7], s64 offen lds
    s_cbranch_scc1 L_roleB
    s_branch L_roleA
L_upper:
    s_cmpk_ge_u32 s2, 128
    s_cbranch_scc1 L_bcomp
    s_branch L_acomp
L_roleA:
    s_and_b32 s87, s2, 6
    v_lshrrev_b32 v13, 3, v0
    s_bfe_u32 s83, s2, 0x10006
    v_and_b32 v12, 16, v0
    s_or_b32 s87, s87, s83
    s_mul_i32 s72, s64, 1536
    s_mov_b64 s[8:9], s[12:13]
    v_lshlrev_b32 v9, 4, v9
    s_lshl_b32 s83, s87, 7
    v_lshlrev_b32 v12, 2, v12
    s_mov_b32 s11, s7
    v_xor_b32 v12, v12, v9
    v_mul_u32_u24 v14, 3072, v13
    s_mov_b32 s10, 1572864
    v_add3_u32 v6, v14, v12, s83
    s_lshl_b32 s81, s88, 10
    v_add_u32 v4, 1024, v6
    s_and_b32 s83, s88, 1
    s_lshl_b32 s83, s83, 5
    v_xor_b32 v6, s83, v6
    v_add_u32 v10, 98304, v6
    s_add_u32 m0, s81, 15360
    s_nop 0
    buffer_load_dwordx4 v6, s[8:11], s72 offen offset:1024 lds
    s_add_u32 m0, s81, 19456
    s_nop 0
    buffer_load_dwordx4 v10, s[8:11], s72 offen offset:1024 lds
    s_add_u32 m0, s81, 22528
    s_nop 0
    buffer_load_dwordx4 v6, s[8:11], s72 offen offset:2048 lds
    s_add_u32 m0, s81, 26624
    s_nop 0
    buffer_load_dwordx4 v10, s[8:11], s72 offen offset:2048 lds
    s_add_u32 s64, s64, 128
    s_and_b32 s64, s64, 1023
    s_mul_i32 s73, s64, 1536
    s_add_u32 m0, s80, 32768
    s_nop 0
    buffer_load_dwordx4 v2, s[4:7], s64 offen lds
    s_add_u32 m0, s80, 33792
    s_nop 0
    buffer_load_dwordx4 v3, s[4:7], s64 offen lds
    s_add_u32 m0, s80, 40960
    s_nop 0
    buffer_load_dwordx4 v32, s[4:7], s64 offen lds
    s_add_u32 m0, s80, 41984
    s_nop 0
    buffer_load_dwordx4 v33, s[4:7], s64 offen lds
    s_add_u32 m0, s81, 48128
    s_nop 0
    buffer_load_dwordx4 v6, s[8:11], s73 offen offset:1024 lds
    s_add_u32 m0, s81, 52224
    s_nop 0
    buffer_load_dwordx4 v10, s[8:11], s73 offen offset:1024 lds
    s_add_u32 m0, s81, 55296
    s_nop 0
    buffer_load_dwordx4 v6, s[8:11], s73 offen offset:2048 lds
    s_add_u32 m0, s81, 59392
    s_nop 0
    buffer_load_dwordx4 v10, s[8:11], s73 offen offset:2048 lds
    s_load_dwordx2 s[28:29], s[0:1], 16
    s_load_dwordx2 s[20:21], s[0:1], 80
    s_load_dwordx2 s[12:13], s[0:1], 24
    s_load_dwordx2 s[16:17], s[0:1], 48
    s_load_dwordx2 s[24:25], s[0:1], 64
    s_load_dwordx2 s[32:33], s[0:1], 72
    v_and_b32 v1, 63, v0
    v_add_u32 v5, 2048, v6
    s_lshl_b32 s83, s82, 7
    v_lshl_add_u32 v31, v13, 10, v12
    s_and_b32 s89, s88, 1
    v_add_u32 v31, s83, v31
    s_lshl_b32 s89, s89, 5
    v_xor_b32 v31, s89, v31
    s_and_b32 s89, s88, 3
    s_lshr_b32 s90, s88, 2
    s_waitcnt lgkmcnt(0)
    s_mov_b32 s30, 16384
    s_mov_b32 s31, 0x20000
    s_lshl_b32 s96, s88, 9
    s_add_u32 m0, s96, 155648
    s_lshl_b32 s97, s87, 11
    s_add_u32 s96, s96, s97
    v_lshlrev_b32 v7, 4, v1
    s_mov_b32 exec_hi, 0
    buffer_load_dwordx4 v7, s[28:31], s96 offen lds
    s_mov_b64 exec, -1
    s_mov_b32 s22, 33554432
    s_mov_b32 s23, 0x20000
    s_mov_b32 s14, 524288
    s_mov_b32 s15, 0x20000
    s_mov_b32 s18, 524288
    s_mov_b32 s19, 0x20000
    s_mov_b32 s26, 2097152
    s_mov_b32 s27, 0x20000
    s_mov_b32 s84, 0x3fb8aa3b
    s_mov_b32 s85, 0x3fb8aa3b
    s_mov_b32 s35, 1
    v_lshrrev_b32 v128, 5, v1
    v_bfe_u32 v129, v1, 2, 2
    v_lshl_add_u32 v128, v128, 3, v129
    v_lshlrev_b32 v156, 5, v128
    v_bfe_u32 v128, v1, 4, 1
    v_lshl_or_b32 v156, v128, 4, v156
    v_bfe_u32 v128, v1, 1, 1
    v_lshl_or_b32 v156, v128, 3, v156
    v_add_u32 v156, 155648, v156
    v_bfe_u32 v128, v1, 2, 1
    v_mul_u32_u24 v157, 0x8000, v128
    v_lshl_or_b32 v157, v157, 16, v157
    v_and_b32 v128, 31, v1
    v_lshrrev_b32 v129, 5, v1
    v_lshlrev_b32 v129, 1, v129
    v_bfe_u32 v149, v1, 1, 2
    v_xor_b32 v129, v129, v149
    v_lshlrev_b32 v148, 6, v128
    v_lshl_or_b32 v148, v129, 4, v148
    s_lshl_b32 s92, s89, 11
    v_add_u32 v148, s92, v148
    v_xor_b32 v149, 16, v148
    v_lshlrev_b32 v150, 4, v1
    v_add_u32 v150, s92, v150
    v_lshrrev_b32 v128, 5, v1
    v_bfe_u32 v129, v1, 2, 3
    v_lshl_add_u32 v128, v128, 4, v129
    v_bfe_u32 v129, v1, 1, 1
    v_bfe_u32 v130, v1, 3, 2
    v_xor_b32 v129, v129, v130
    v_lshlrev_b32 v151, 6, v128
    v_lshl_or_b32 v151, v129, 4, v151
    v_and_b32 v129, 1, v1
    v_lshl_or_b32 v151, v129, 3, v151
    s_lshl_b32 s92, s89, 13
    v_add_u32 v151, s92, v151
    v_xor_b32 v152, 32, v151
    v_bfe_u32 v128, v1, 2, 3
    v_lshlrev_b32 v153, 6, v128
    v_and_b32 v129, 3, v1
    v_xor_b32 v129, v129, v130
    v_lshl_or_b32 v153, v129, 4, v153
    v_lshrrev_b32 v129, 5, v1
    v_lshl_or_b32 v153, v129, 3, v153
    s_lshl_b32 s92, s89, 12
    s_add_u32 s92, s92, 32768
    v_add_u32 v153, s92, v153
    s_lshl_b32 s92, s87, 4
    s_add_u32 s92, s92, s86
    s_mul_i32 s92, s92, 4608
    s_add_u32 s92, s92, 5373952
    s_mul_i32 s82, s89, 1152
    s_add_u32 s92, s92, s82
    v_lshlrev_b32 v154, 4, v1
    v_add_u32 v154, s92, v154
    v_add_u32 v155, s92, v1
    v_and_b32 v128, 15, v1
    v_mov_b32 v129, 0x7ffffff0
    v_cmp_eq_u32 vcc, 0, v128
    s_nop 1
    v_cndmask_b32 v155, v129, v155, vcc
    s_lshl_b32 s82, s87, 2
    s_add_u32 s92, s82, s89
    s_lshl_b32 s92, s92, 7
    s_add_u32 s101, s92, 6029312
    s_add_u32 s98, s101, 64
    s_mul_i32 s92, s87, 73728
    s_mul_i32 s82, s89, 1152
    s_add_u32 s92, s92, s82
    s_add_u32 s92, s92, 5373952
    v_lshrrev_b32 v128, 4, v1
    v_and_b32 v129, 15, v1
    v_mul_u32_u24 v27, 4608, v128
    v_add_u32 v27, s92, v27
    v_lshl_add_u32 v25, v129, 4, v27
    v_and_b32 v131, 3, v1
    v_lshl_add_u32 v27, v131, 4, v27
    s_mul_i32 s92, s89, 1360
    s_add_u32 s92, s92, 155648
    v_bfe_u32 v130, v1, 4, 1
    v_lshlrev_b32 v29, 5, v130
    v_add_u32 v29, s92, v29
    v_mul_u32_u24 v28, 80, v129
    v_add_u32 v28, v28, v29
    v_lshrrev_b32 v130, 5, v1
    v_lshl_add_u32 v28, v130, 3, v28
    v_lshl_add_u32 v29, v131, 3, v29
    v_and_b32 v130, 1, v1
    v_lshlrev_b32 v130, 4, v130
    v_mov_b32 v131, 0x3f80
    v_lshlrev_b32 v130, v130, v131
    v_bfe_u32 v131, v1, 1, 3
    v_cmp_eq_u32 vcc, 0, v131
    v_cmp_eq_u32 s[92:93], 1, v131
    s_nop 0
    v_cndmask_b32 v136, 0, v130, vcc
    v_cndmask_b32 v137, 0, v130, s[92:93]
    v_cmp_eq_u32 vcc, 2, v131
    v_cmp_eq_u32 s[92:93], 3, v131
    s_nop 0
    v_cndmask_b32 v138, 0, v130, vcc
    v_cndmask_b32 v139, 0, v130, s[92:93]
    v_cmp_eq_u32 vcc, 4, v131
    v_cmp_eq_u32 s[92:93], 5, v131
    s_nop 0
    v_cndmask_b32 v140, 0, v130, vcc
    v_cndmask_b32 v141, 0, v130, s[92:93]
    v_cmp_eq_u32 vcc, 6, v131
    v_cmp_eq_u32 s[92:93], 7, v131
    s_nop 0
    v_cndmask_b32 v142, 0, v130, vcc
    v_cndmask_b32 v143, 0, v130, s[92:93]
    v_mov_b32 v144, 0x3f803f80
    v_mov_b32 v228, -1
    v_mov_b32 v145, 0x3f803f80
    v_mov_b32 v229, -1
    v_mov_b32 v146, 0x3f803f80
    v_mov_b32 v230, -1
    v_mov_b32 v147, 0x3f803f80
    v_mov_b32 v231, -1
    s_lshl_b32 s92, s86, 2
    s_add_u32 s92, s92, s89
    s_lshl_b32 s82, s87, 1
    s_add_u32 s82, s82, s90
    s_mul_i32 s83, s92, 41984
    s_lshl_b32 s93, s82, 11
    s_add_u32 s83, s83, s93
    v_lshlrev_b32 v0, 4, v1
    v_add_u32 v0, s83, v0
    s_lshl_b32 s92, s92, 8
    s_lshr_b32 s83, s87, 2
    s_lshl_b32 s83, s83, 7
    s_add_u32 s92, s92, s83
    s_add_u32 s99, s92, 6033408
    v_subrev_u32 v26, s80, v31
    v_subrev_u32 v26, s80, v26
    v_subrev_u32 v26, s80, v26
    v_subrev_u32 v26, s80, v26
    s_and_b32 s92, s88, 1
    s_lshl_b32 s92, s92, 5
    s_waitcnt vmcnt(9)
    s_barrier
    s_add_u32 s64, s64, 128
    s_and_b32 s64, s64, 1023
    s_mul_i32 s74, s64, 1536
    s_add_u32 m0, s80, 65536
    s_nop 0
    buffer_load_dwordx4 v2, s[4:7], s64 offen lds
    s_add_u32 m0, s80, 66560
    s_nop 0
    buffer_load_dwordx4 v3, s[4:7], s64 offen lds
    s_add_u32 m0, s80, 73728
    s_nop 0
    buffer_load_dwordx4 v32, s[4:7], s64 offen lds
    s_add_u32 m0, s80, 74752
    s_nop 0
    buffer_load_dwordx4 v33, s[4:7], s64 offen lds
    s_add_u32 m0, s81, 80896
    s_nop 0
    buffer_load_dwordx4 v6, s[8:11], s74 offen offset:1024 lds
    s_add_u32 m0, s81, 84992
    s_nop 0
    buffer_load_dwordx4 v10, s[8:11], s74 offen offset:1024 lds
    s_add_u32 m0, s81, 88064
    s_nop 0
    buffer_load_dwordx4 v6, s[8:11], s74 offen offset:2048 lds
    s_add_u32 m0, s81, 92160
    s_nop 0
    buffer_load_dwordx4 v10, s[8:11], s74 offen offset:2048 lds
    s_waitcnt vmcnt(9)
    s_barrier
    s_add_u32 s64, s64, 128
    s_and_b32 s64, s64, 1023
    s_mul_i32 s75, s64, 1536
    s_add_u32 m0, s80, 98304
    s_nop 0
    buffer_load_dwordx4 v2, s[4:7], s64 offen lds
    s_add_u32 m0, s80, 99328
    s_nop 0
    buffer_load_dwordx4 v3, s[4:7], s64 offen lds
    s_add_u32 m0, s80, 106496
    s_nop 0
    buffer_load_dwordx4 v32, s[4:7], s64 offen lds
    s_add_u32 m0, s80, 107520
    s_nop 0
    buffer_load_dwordx4 v33, s[4:7], s64 offen lds
    s_add_u32 m0, s81, 113664
    s_nop 0
    buffer_load_dwordx4 v6, s[8:11], s75 offen offset:1024 lds
    s_add_u32 m0, s81, 117760
    s_nop 0
    buffer_load_dwordx4 v10, s[8:11], s75 offen offset:1024 lds
    s_add_u32 m0, s81, 120832
    s_nop 0
    buffer_load_dwordx4 v6, s[8:11], s75 offen offset:2048 lds
    s_add_u32 m0, s81, 124928
    s_nop 0
    buffer_load_dwordx4 v10, s[8:11], s75 offen offset:2048 lds
    s_waitcnt vmcnt(8)
    s_barrier
    s_add_u32 s64, s64, 128
    s_and_b32 s64, s64, 1023
    s_mul_i32 s76, s64, 1536
    s_add_u32 m0, s80, 0
    s_nop 0
    buffer_load_dwordx4 v2, s[4:7], s64 offen lds
    s_add_u32 m0, s80, 1024
    s_nop 0
    buffer_load_dwordx4 v3, s[4:7], s64 offen lds
    s_add_u32 m0, s80, 8192
    s_nop 0
    buffer_load_dwordx4 v32, s[4:7], s64 offen lds
    s_add_u32 m0, s80, 9216
    s_nop 0
    buffer_load_dwordx4 v33, s[4:7], s64 offen lds
    s_add_u32 m0, s81, 15360
    s_nop 0
    buffer_load_dwordx4 v6, s[8:11], s76 offen offset:1024 lds
    s_add_u32 m0, s81, 19456
    s_nop 0
    buffer_load_dwordx4 v10, s[8:11], s76 offen offset:1024 lds
    s_add_u32 m0, s81, 22528
    s_nop 0
    buffer_load_dwordx4 v6, s[8:11], s76 offen offset:2048 lds
    s_add_u32 m0, s81, 26624
    s_nop 0
    buffer_load_dwordx4 v10, s[8:11], s76 offen offset:2048 lds
    s_waitcnt vmcnt(8)
    s_barrier
    s_add_u32 s64, s64, 128
    s_and_b32 s64, s64, 1023
    s_mul_i32 s77, s64, 1536
    s_add_u32 m0, s80, 32768
    s_nop 0
    buffer_load_dwordx4 v2, s[4:7], s64 offen lds
    s_add_u32 m0, s80, 33792
    s_nop 0
    buffer_load_dwordx4 v3, s[4:7], s64 offen lds
    s_add_u32 m0, s80, 40960
    s_nop 0
    buffer_load_dwordx4 v32, s[4:7], s64 offen lds
    s_add_u32 m0, s80, 41984
    s_nop 0
    buffer_load_dwordx4 v33, s[4:7], s64 offen lds
    s_add_u32 m0, s81, 48128
    s_nop 0
    buffer_load_dwordx4 v6, s[8:11], s77 offen offset:1024 lds
    s_add_u32 m0, s81, 52224
    s_nop 0
    buffer_load_dwordx4 v10, s[8:11], s77 offen offset:1024 lds
    s_add_u32 m0, s81, 55296
    s_nop 0
    buffer_load_dwordx4 v6, s[8:11], s77 offen offset:2048 lds
    s_add_u32 m0, s81, 59392
    s_nop 0
    buffer_load_dwordx4 v10, s[8:11], s77 offen offset:2048 lds
    s_waitcnt vmcnt(8)
    s_barrier
    s_add_u32 s64, s64, 128
    s_and_b32 s64, s64, 1023
    s_mul_i32 s78, s64, 1536
    s_add_u32 m0, s80, 65536
    s_nop 0
    buffer_load_dwordx4 v2, s[4:7], s64 offen lds
    s_add_u32 m0, s80, 66560
    s_nop 0
    buffer_load_dwordx4 v3, s[4:7], s64 offen lds
    s_add_u32 m0, s80, 73728
    s_nop 0
    buffer_load_dwordx4 v32, s[4:7], s64 offen lds
    s_add_u32 m0, s80, 74752
    s_nop 0
    buffer_load_dwordx4 v33, s[4:7], s64 offen lds
    s_add_u32 m0, s81, 80896
    s_nop 0
    buffer_load_dwordx4 v6, s[8:11], s78 offen offset:1024 lds
    s_add_u32 m0, s81, 84992
    s_nop 0
    buffer_load_dwordx4 v10, s[8:11], s78 offen offset:1024 lds
    s_add_u32 m0, s81, 88064
    s_nop 0
    buffer_load_dwordx4 v6, s[8:11], s78 offen offset:2048 lds
    s_add_u32 m0, s81, 92160
    s_nop 0
    buffer_load_dwordx4 v10, s[8:11], s78 offen offset:2048 lds
    s_waitcnt vmcnt(8)
    s_barrier
    s_add_u32 s64, s64, 128
    s_and_b32 s64, s64, 1023
    s_mul_i32 s79, s64, 1536
    s_add_u32 m0, s80, 98304
    s_nop 0
    buffer_load_dwordx4 v2, s[4:7], s64 offen lds
    s_add_u32 m0, s80, 99328
    s_nop 0
    buffer_load_dwordx4 v3, s[4:7], s64 offen lds
    s_add_u32 m0, s80, 106496
    s_nop 0
    buffer_load_dwordx4 v32, s[4:7], s64 offen lds
    s_add_u32 m0, s80, 107520
    s_nop 0
    buffer_load_dwordx4 v33, s[4:7], s64 offen lds
    s_add_u32 m0, s81, 113664
    s_nop 0
    buffer_load_dwordx4 v6, s[8:11], s79 offen offset:1024 lds
    s_add_u32 m0, s81, 117760
    s_nop 0
    buffer_load_dwordx4 v10, s[8:11], s79 offen offset:1024 lds
    s_add_u32 m0, s81, 120832
    s_nop 0
    buffer_load_dwordx4 v6, s[8:11], s79 offen offset:2048 lds
    s_add_u32 m0, s81, 124928
    s_nop 0
    buffer_load_dwordx4 v10, s[8:11], s79 offen offset:2048 lds
    ds_read_b64_tr_b16 v[96:97], v156 offset:0
    ds_read_b64_tr_b16 v[98:99], v156 offset:128
    ds_read_b64_tr_b16 v[100:101], v156 offset:512
    ds_read_b64_tr_b16 v[102:103], v156 offset:640
    s_waitcnt vmcnt(8)
    s_barrier
    s_add_u32 m0, s81, 131072
    s_nop 0
    buffer_load_dwordx4 v6, s[8:11], s72 offen offset:0 lds
    s_add_u32 m0, s81, 135168
    s_nop 0
    buffer_load_dwordx4 v10, s[8:11], s72 offen offset:0 lds
    s_add_u32 m0, s81, 139264
    s_nop 0
    buffer_load_dwordx4 v6, s[8:11], s73 offen offset:0 lds
    s_add_u32 m0, s81, 143360
    s_nop 0
    buffer_load_dwordx4 v10, s[8:11], s73 offen offset:0 lds
    v_xor_b32 v26, s92, v26
    v_xor_b32 v30, 32, v26
    s_and_b32 s94, s2, 7
    s_lshr_b32 s92, s2, 7
    s_lshl1_add_u32 s94, s94, s92
    s_bfe_u32 s95, s2, 0x10006
    s_bfe_u32 s92, s88, 0x10001
    s_lshl1_add_u32 s95, s95, s92
    s_and_b32 s71, s88, 1
    s_mov_b32 s3, 1
    s_mul_i32 s65, s71, 32768
    s_add_u32 s65, s65, 0
    s_mul_i32 s66, s71, 49152
    s_add_u32 s66, s66, 16384
    s_mov_b32 s83, 2686976
    s_lshl_b32 s92, s94, 2
    s_add_u32 s92, s92, s95
    s_mul_i32 s82, s92, 41984
    s_add_u32 s83, s83, s82
    s_lshl_b32 s82, s71, 14
    s_add_u32 s67, s83, s82
    s_lshl_b32 s92, s92, 8
    s_lshl_b32 s82, s3, 14
    s_add_u32 s92, s92, s82
    s_lshl_b32 s82, s71, 7
    s_add_u32 s92, s92, s82
    s_add_u32 s70, s92, 6033408
    s_lshl_b32 s92, s94, 1
    s_add_u32 s92, s92, s71
    s_waitcnt lgkmcnt(0)
    v_xor_b32 v96, v157, v96
    v_xor_b32 v97, v157, v97
    v_xor_b32 v98, v157, v98
    v_xor_b32 v99, v157, v99
    v_xor_b32 v100, v157, v100
    v_xor_b32 v101, v157, v101
    v_xor_b32 v102, v157, v102
    v_xor_b32 v103, v157, v103
    s_waitcnt vmcnt(4)
    s_barrier
    s_add_u32 m0, s81, 147456
    s_nop 0
    buffer_load_dwordx4 v6, s[8:11], s74 offen offset:0 lds
    s_add_u32 m0, s81, 151552
    s_nop 0
    buffer_load_dwordx4 v10, s[8:11], s74 offen offset:0 lds
    s_add_u32 m0, s81, 49152
    s_nop 0
    buffer_load_dwordx4 v6, s[8:11], s75 offen offset:0 lds
    s_add_u32 m0, s81, 53248
    s_nop 0
    buffer_load_dwordx4 v10, s[8:11], s75 offen offset:0 lds
    s_lshl_b32 s92, s92, 11
    s_lshl_b32 s82, s95, 7
    s_add_u32 s92, s92, s82
    s_add_u32 s68, s92, 5963776
    s_lshr_b32 s92, s94, 1
    s_lshl_b32 s92, s92, 8
    s_and_b32 s82, s94, 1
    s_or_b32 s92, s92, s82
    s_lshl_b32 s82, s95, 6
    s_add_u32 s92, s92, s82
    s_lshl_b32 s92, s92, 10
    s_bfe_u32 s82, s2, 0x30003
    s_lshl_b32 s82, s82, 7
    s_add_u32 s92, s92, s82
    s_lshl_b32 s82, s71, 15
    s_add_u32 s69, s92, s82
    s_lshl_b32 s82, s71, 8
    s_add_u32 s67, s67, s82
    s_sub_u32 s66, s66, s65
    s_lshl_b32 s71, s71, 6
    s_and_b32 s92, s88, 3
    s_lshl_b32 s94, s92, 12
    s_add_u32 s94, s94, 0
    s_lshl_b32 s92, s92, 8
    s_add_u32 s95, s92, 161280
    v_lshrrev_b32 v128, 4, v1
    v_bfe_u32 v129, v1, 2, 2
    v_lshl_add_u32 v129, v128, 3, v129
    v_lshlrev_b32 v130, 7, v129
    v_and_b32 v129, 3, v1
    v_lshl_or_b32 v130, v129, 3, v130
    v_bfe_u32 v129, v1, 3, 1
    v_lshl_or_b32 v130, v129, 6, v130
    v_and_b32 v129, 1, v128
    v_lshl_or_b32 v130, v129, 5, v130
    v_add_u32 v240, s65, v130
    v_xor_b32 v241, 32, v240
    v_xor_b32 v242, 64, v240
    v_xor_b32 v243, 0x60, v240
    v_lshlrev_b32 v128, 4, v1
    v_add_u32 v248, s94, v128
    v_xor_b32 v247, 0x1000, v248
    v_lshlrev_b32 v128, 2, v1
    v_add_u32 v250, s95, v128
    v_xor_b32 v251, 0x100, v250
    v_mov_b32 v129, -1
    ds_write_b32 v250, v129
    v_and_b32 v249, 15, v1
    v_lshrrev_b32 v128, 4, v1
    v_lshlrev_b32 v246, 9, v128
    v_lshl_or_b32 v244, v249, 4, v246
    v_add_u32 v244, s67, v244
    v_xor_b32 v245, 0x100, v244
    v_lshl_or_b32 v246, v249, 2, v246
    v_or_b32 v246, s71, v246
    v_lshlrev_b32 v249, 11, v249
    v_and_b32 v128, 1, v128
    v_lshl_or_b32 v249, v128, 5, v249
    v_lshrrev_b32 v128, 5, v1
    v_lshl_or_b32 v249, v128, 4, v249
    s_load_dword s34, s[32:33], 0x0
    s_add_u32 m0, s81, 57344
    s_nop 0
    buffer_load_dwordx4 v6, s[8:11], s76 offen offset:0 lds
    s_add_u32 m0, s81, 61440
    s_nop 0
    buffer_load_dwordx4 v10, s[8:11], s76 offen offset:0 lds
    s_add_u32 m0, s81, 65536
    s_mov_b32 s96, 393216
    buffer_load_dwordx4 v31, s[16:19], s96 offen lds
    s_add_u32 m0, s81, 69632
    s_mov_b32 s96, 425984
    buffer_load_dwordx4 v31, s[16:19], s96 offen lds
    s_waitcnt lgkmcnt(0)
    s_cmp_ge_u32 s34, 1
    s_cbranch_scc1 L_rdy1
    s_mov_b32 s97, 0
L_spin2:
    v_mov_b32 v128, 0
    global_load_dword v128, v128, s[32:33] sc1
    s_waitcnt vmcnt(0)
    v_cmp_eq_u32 vcc, 0, v128
    s_cbranch_vccz L_spun3
    s_add_u32 s97, s97, 1
    s_cmp_lt_u32 s97, 1048576
    s_cbranch_scc1 L_spin2
L_spun3:
L_rdy1:
    s_barrier
    s_setprio 3
    ds_read_b128 v[112:115], v150 offset:0
    ds_read_b128 v[116:119], v150 offset:8192
    s_add_u32 m0, s81, 106496
    s_nop 0
    buffer_load_dwordx4 v6, s[8:11], s77 offen offset:0 lds
    s_waitcnt lgkmcnt(1)
    v_permlane16_swap_b32 v112, v114
    v_permlane16_swap_b32 v113, v115
    s_nop 1
    v_mfma_f32_32x32x16_bf16 v[32:47], v[96:99], v[112:115], 0
    s_waitcnt lgkmcnt(0)
    v_permlane16_swap_b32 v116, v118
    v_permlane16_swap_b32 v117, v119
    s_nop 1
    v_mfma_f32_32x32x16_bf16 v[48:63], v[100:103], v[116:119], 0
    s_add_u32 m0, s81, 110592
    s_nop 0
    buffer_load_dwordx4 v10, s[8:11], s77 offen offset:0 lds
    s_add_u32 m0, s81, 114688
    s_nop 0
    buffer_load_dwordx4 v6, s[8:11], s78 offen offset:0 lds
    s_setprio 0
    s_add_u32 m0, s81, 118784
    s_nop 0
    buffer_load_dwordx4 v10, s[8:11], s78 offen offset:0 lds
    v_max3_f32 v128, v32, v33, v34
    v_max3_f32 v129, v35, v36, v37
    v_max3_f32 v128, v128, v38, v39
    v_max3_f32 v129, v129, v40, v41
    v_max3_f32 v128, v128, v42, v43
    v_max3_f32 v129, v129, v44, v45
    s_add_u32 m0, s81, 122880
    s_nop 0
    buffer_load_dwordx4 v6, s[8:11], s79 offen offset:0 lds
    v_max3_f32 v128, v128, v46, v47
    v_max_f32 v128, v128, v129
    v_mul_f32 v130, 0xbfb8aa3b, v128
    v_pk_fma_f32 v[32:33], v[32:33], s[84:85], v[130:131] op_sel_hi:[1,0,0]
    v_pk_fma_f32 v[34:35], v[34:35], s[84:85], v[130:131] op_sel_hi:[1,0,0]
    v_exp_f32 v32, v32
    s_add_u32 m0, s81, 126976
    s_nop 0
    buffer_load_dwordx4 v10, s[8:11], s79 offen offset:0 lds
    v_exp_f32 v33, v33
    v_pk_fma_f32 v[36:37], v[36:37], s[84:85], v[130:131] op_sel_hi:[1,0,0]
    v_exp_f32 v34, v34
    s_add_u32 m0, s81, 73728
    s_mov_b32 s96, 458752
    buffer_load_dwordx4 v31, s[16:19], s96 offen lds
    v_exp_f32 v35, v35
    v_pk_fma_f32 v[38:39], v[38:39], s[84:85], v[130:131] op_sel_hi:[1,0,0]
    v_exp_f32 v36, v36
    s_add_u32 m0, s81, 77824
    s_mov_b32 s96, 491520
    buffer_load_dwordx4 v31, s[16:19], s96 offen lds
    v_exp_f32 v37, v37
    v_pk_fma_f32 v[40:41], v[40:41], s[84:85], v[130:131] op_sel_hi:[1,0,0]
    v_exp_f32 v38, v38
    v_exp_f32 v39, v39
    s_add_u32 m0, s81, 81920
    s_mov_b32 s96, 0
    buffer_load_dwordx4 v31, s[12:15], s96 offen lds
    v_pk_fma_f32 v[42:43], v[42:43], s[84:85], v[130:131] op_sel_hi:[1,0,0]
    v_exp_f32 v40, v40
    v_exp_f32 v41, v41
    s_add_u32 m0, s81, 86016
    s_mov_b32 s96, 32768
    buffer_load_dwordx4 v31, s[12:15], s96 offen lds
    v_pk_fma_f32 v[44:45], v[44:45], s[84:85], v[130:131] op_sel_hi:[1,0,0]
    v_exp_f32 v42, v42
    v_exp_f32 v43, v43
    buffer_store_dwordx4 v[228:231], v154, s[20:23], 0 offen offset:0 sc1
    buffer_store_dwordx4 v[228:231], v155, s[20:23], 0 offen offset:1024 sc1
    buffer_store_dwordx4 v[228:231], v0, s[20:23], 0 offen offset:0 sc1
    buffer_store_dwordx4 v[228:231], v0, s[20:23], 0 offen offset:1024 sc1
    buffer_store_dwordx4 v[228:231], v0, s[20:23], 0 offen offset:2048 sc1
    buffer_store_dwordx4 v[228:231], v0, s[20:23], 0 offen offset:3072 sc1
    v_pk_fma_f32 v[46:47], v[46:47], s[84:85], v[130:131] op_sel_hi:[1,0,0]
    v_exp_f32 v44, v44
    v_exp_f32 v45, v45
    v_exp_f32 v46, v46
    v_exp_f32 v47, v47
    v_pk_add_f32 v[132:133], v[32:33], v[34:35]
    v_pk_add_f32 v[134:135], v[36:37], v[38:39]
    v_pk_add_f32 v[132:133], v[132:133], v[40:41]
    v_pk_add_f32 v[134:135], v[134:135], v[42:43]
    v_pk_add_f32 v[132:133], v[132:133], v[44:45]
    v_pk_add_f32 v[134:135], v[134:135], v[46:47]
    v_pk_add_f32 v[132:133], v[132:133], v[134:135]
    v_add_f32 v132, v132, v133
    v_rcp_f32 v130, v132
    s_nop 0
    v_pk_mul_f32 v[32:33], v[32:33], v[130:131] op_sel_hi:[1,0]
    v_pk_mul_f32 v[34:35], v[34:35], v[130:131] op_sel_hi:[1,0]
    v_cvt_pk_bf16_f32 v32, v32, v33
    v_pk_mul_f32 v[36:37], v[36:37], v[130:131] op_sel_hi:[1,0]
    v_cvt_pk_bf16_f32 v33, v34, v35
    v_pk_mul_f32 v[38:39], v[38:39], v[130:131] op_sel_hi:[1,0]
    v_cvt_pk_bf16_f32 v34, v36, v37
    v_pk_mul_f32 v[40:41], v[40:41], v[130:131] op_sel_hi:[1,0]
    v_cvt_pk_bf16_f32 v35, v38, v39
    v_pk_mul_f32 v[42:43], v[42:43], v[130:131] op_sel_hi:[1,0]
    v_cvt_pk_bf16_f32 v36, v40, v41
    ds_write_b128 v148, v[32:35] offset:0
    v_pk_mul_f32 v[44:45], v[44:45], v[130:131] op_sel_hi:[1,0]
    v_cvt_pk_bf16_f32 v37, v42, v43
    v_pk_mul_f32 v[46:47], v[46:47], v[130:131] op_sel_hi:[1,0]
    v_cvt_pk_bf16_f32 v38, v44, v45
    v_cvt_pk_bf16_f32 v39, v46, v47
    ds_write_b128 v149, v[36:39] offset:0
    v_max3_f32 v128, v48, v49, v50
    v_max3_f32 v129, v51, v52, v53
    v_max3_f32 v128, v128, v54, v55
    v_max3_f32 v129, v129, v56, v57
    v_max3_f32 v128, v128, v58, v59
    v_max3_f32 v129, v129, v60, v61
    v_max3_f32 v128, v128, v62, v63
    v_max_f32 v128, v128, v129
    v_mul_f32 v130, 0xbfb8aa3b, v128
    v_pk_fma_f32 v[48:49], v[48:49], s[84:85], v[130:131] op_sel_hi:[1,0,0]
    v_pk_fma_f32 v[50:51], v[50:51], s[84:85], v[130:131] op_sel_hi:[1,0,0]
    v_exp_f32 v48, v48
    v_exp_f32 v49, v49
    v_pk_fma_f32 v[52:53], v[52:53], s[84:85], v[130:131] op_sel_hi:[1,0,0]
    v_exp_f32 v50, v50
    v_exp_f32 v51, v51
    v_pk_fma_f32 v[54:55], v[54:55], s[84:85], v[130:131] op_sel_hi:[1,0,0]
    v_exp_f32 v52, v52
    v_exp_f32 v53, v53
    v_pk_fma_f32 v[56:57], v[56:57], s[84:85], v[130:131] op_sel_hi:[1,0,0]
    v_exp_f32 v54, v54
    v_exp_f32 v55, v55
    v_pk_fma_f32 v[58:59], v[58:59], s[84:85], v[130:131] op_sel_hi:[1,0,0]
    v_exp_f32 v56, v56
    v_exp_f32 v57, v57
    v_pk_fma_f32 v[60:61], v[60:61], s[84:85], v[130:131] op_sel_hi:[1,0,0]
    v_exp_f32 v58, v58
    v_exp_f32 v59, v59
    v_pk_fma_f32 v[62:63], v[62:63], s[84:85], v[130:131] op_sel_hi:[1,0,0]
    v_exp_f32 v60, v60
    v_exp_f32 v61, v61
    v_exp_f32 v62, v62
    v_exp_f32 v63, v63
    v_pk_add_f32 v[132:133], v[48:49], v[50:51]
    v_pk_add_f32 v[134:135], v[52:53], v[54:55]
    v_pk_add_f32 v[132:133], v[132:133], v[56:57]
    v_pk_add_f32 v[134:135], v[134:135], v[58:59]
    v_pk_add_f32 v[132:133], v[132:133], v[60:61]
    v_pk_add_f32 v[134:135], v[134:135], v[62:63]
    v_pk_add_f32 v[132:133], v[132:133], v[134:135]
    v_add_f32 v132, v132, v133
    v_rcp_f32 v130, v132
    s_nop 0
    v_pk_mul_f32 v[48:49], v[48:49], v[130:131] op_sel_hi:[1,0]
    v_pk_mul_f32 v[50:51], v[50:51], v[130:131] op_sel_hi:[1,0]
    v_cvt_pk_bf16_f32 v48, v48, v49
    v_pk_mul_f32 v[52:53], v[52:53], v[130:131] op_sel_hi:[1,0]
    v_cvt_pk_bf16_f32 v49, v50, v51
    v_pk_mul_f32 v[54:55], v[54:55], v[130:131] op_sel_hi:[1,0]
    v_cvt_pk_bf16_f32 v50, v52, v53
    v_pk_mul_f32 v[56:57], v[56:57], v[130:131] op_sel_hi:[1,0]
    v_cvt_pk_bf16_f32 v51, v54, v55
    v_pk_mul_f32 v[58:59], v[58:59], v[130:131] op_sel_hi:[1,0]
    v_cvt_pk_bf16_f32 v52, v56, v57
    ds_write_b128 v148, v[48:51] offset:8192
    v_pk_mul_f32 v[60:61], v[60:61], v[130:131] op_sel_hi:[1,0]
    v_cvt_pk_bf16_f32 v53, v58, v59
    v_pk_mul_f32 v[62:63], v[62:63], v[130:131] op_sel_hi:[1,0]
    v_cvt_pk_bf16_f32 v54, v60, v61
    v_cvt_pk_bf16_f32 v55, v62, v63
    ds_write_b128 v149, v[52:55] offset:8192
    s_waitcnt vmcnt(10) lgkmcnt(0)
    s_barrier
    s_setprio 3
    ds_read_b64_tr_b16 v[48:49], v151 offset:0
    ds_read_b64_tr_b16 v[50:51], v151 offset:512
    ds_read_b64_tr_b16 v[52:53], v152 offset:0
    ds_read_b64_tr_b16 v[54:55], v152 offset:512
    ds_read_b64_tr_b16 v[32:33], v153 offset:0
    ds_read_b64_tr_b16 v[34:35], v153 offset:512
    ds_read_b64_tr_b16 v[56:57], v151 offset:2048
    ds_read_b64_tr_b16 v[58:59], v151 offset:2560
    ds_read_b64_tr_b16 v[60:61], v152 offset:2048
    ds_read_b64_tr_b16 v[62:63], v152 offset:2560
    ds_read_b64_tr_b16 v[36:37], v153 offset:1024
    ds_read_b64_tr_b16 v[38:39], v153 offset:1536
    s_waitcnt lgkmcnt(6)
    v_mfma_f32_16x16x32_bf16 v[80:83], v[48:51], v[32:35], 0
    v_mfma_f32_16x16x32_bf16 v[84:87], v[52:55], v[32:35], 0
    v_mfma_f32_16x16x32_bf16 v[88:91], v[48:51], v[144:147], 0
    v_mfma_f32_16x16x32_bf16 v[92:95], v[52:55], v[144:147], 0
    ds_read_b64_tr_b16 v[64:65], v151 offset:4096
    ds_read_b64_tr_b16 v[66:67], v151 offset:4608
    ds_read_b64_tr_b16 v[68:69], v152 offset:4096
    ds_read_b64_tr_b16 v[70:71], v152 offset:4608
    ds_read_b64_tr_b16 v[40:41], v153 offset:2048
    ds_read_b64_tr_b16 v[42:43], v153 offset:2560
    s_waitcnt lgkmcnt(6)
    v_mfma_f32_16x16x32_bf16 v[80:83], v[56:59], v[36:39], v[80:83]
    v_mfma_f32_16x16x32_bf16 v[84:87], v[60:63], v[36:39], v[84:87]
    v_mfma_f32_16x16x32_bf16 v[88:91], v[56:59], v[144:147], v[88:91]
    v_mfma_f32_16x16x32_bf16 v[92:95], v[60:63], v[144:147], v[92:95]
    ds_read_b64_tr_b16 v[72:73], v151 offset:6144
    ds_read_b64_tr_b16 v[74:75], v151 offset:6656
    ds_read_b64_tr_b16 v[76:77], v152 offset:6144
    ds_read_b64_tr_b16 v[78:79], v152 offset:6656
    ds_read_b64_tr_b16 v[44:45], v153 offset:3072
    ds_read_b64_tr_b16 v[46:47], v153 offset:3584
    s_waitcnt lgkmcnt(6)
    v_mfma_f32_16x16x32_bf16 v[80:83], v[64:67], v[40:43], v[80:83]
    v_mfma_f32_16x16x32_bf16 v[84:87], v[68:71], v[40:43], v[84:87]
    v_mfma_f32_16x16x32_bf16 v[88:91], v[64:67], v[144:147], v[88:91]
    v_mfma_f32_16x16x32_bf16 v[92:95], v[68:71], v[144:147], v[92:95]
    s_waitcnt lgkmcnt(0)
    v_mfma_f32_16x16x32_bf16 v[80:83], v[72:75], v[44:47], v[80:83]
    v_mfma_f32_16x16x32_bf16 v[84:87], v[76:79], v[44:47], v[84:87]
    v_mfma_f32_16x16x32_bf16 v[88:91], v[72:75], v[144:147], v[88:91]
    v_mfma_f32_16x16x32_bf16 v[92:95], v[76:79], v[144:147], v[92:95]
    s_waitcnt vmcnt(0)
    s_nop 3
    v_cvt_pk_bf16_f32 v112, v80, v81
    v_cvt_pk_bf16_f32 v113, v82, v83
    v_cvt_pk_bf16_f32 v114, v84, v85
    v_cvt_pk_bf16_f32 v115, v86, v87
    buffer_store_dwordx4 v[112:115], v154, s[20:23], 0 offen offset:0 sc1
    v_cvt_pk_bf16_f32 v116, v88, v89
    v_cvt_pk_bf16_f32 v117, v90, v91
    v_cvt_pk_bf16_f32 v118, v92, v93
    v_cvt_pk_bf16_f32 v119, v94, v95
    buffer_store_dwordx4 v[116:119], v155, s[20:23], 0 offen offset:1024 sc1
    s_atomic_add s35, s[20:21], s101
    s_setprio 0
    s_lshl_b32 s92, s88, 13
    s_lshl_b32 s82, s88, 16
    s_lshl_b32 s83, s88, 12
    s_lshl_b32 s93, s88, 15
    s_add_u32 m0, s92, 0
    s_add_u32 s96, s82, 0
    buffer_load_dwordx4 v26, s[16:19], s96 offen lds
    v_mov_b32 v8, v136
    s_add_u32 m0, s92, 1024
    s_add_u32 s96, s82, 8192
    buffer_load_dwordx4 v30, s[16:19], s96 offen lds
    v_mov_b32 v9, v137
    s_add_u32 m0, s92, 2048
    s_add_u32 s96, s82, 16384
    buffer_load_dwordx4 v26, s[16:19], s96 offen lds
    v_mov_b32 v10, v138
    s_add_u32 m0, s92, 3072
    s_add_u32 s96, s82, 24576
    buffer_load_dwordx4 v30, s[16:19], s96 offen lds
    v_mov_b32 v11, v139
    s_mov_b32 s34, 0
    s_atomic_or s34, s[20:21], s101 glc
    s_add_u32 m0, s92, 4096
    s_add_u32 s96, s82, 32768
    buffer_load_dwordx4 v26, s[16:19], s96 offen lds
    v_mov_b32 v12, v140
    s_add_u32 m0, s92, 5120
    s_add_u32 s96, s82, 40960
    buffer_load_dwordx4 v30, s[16:19], s96 offen lds
    v_mov_b32 v13, v141
    s_add_u32 m0, s92, 6144
    s_add_u32 s96, s82, 49152
    buffer_load_dwordx4 v26, s[16:19], s96 offen lds
    v_mov_b32 v14, v142
    s_add_u32 m0, s92, 7168
    s_add_u32 s96, s82, 57344
    buffer_load_dwordx4 v30, s[16:19], s96 offen lds
    v_mov_b32 v15, v143
    s_add_u32 m0, s83, 32768
    s_add_u32 s96, s93, 262144
    buffer_load_dwordx4 v26, s[16:19], s96 offen lds
    s_add_u32 m0, s83, 33792
    s_add_u32 s96, s93, 270336
    buffer_load_dwordx4 v30, s[16:19], s96 offen lds
    s_add_u32 m0, s83, 34816
    s_add_u32 s96, s93, 278528
    buffer_load_dwordx4 v26, s[16:19], s96 offen lds
    s_add_u32 m0, s83, 35840
    s_add_u32 s96, s93, 286720
    buffer_load_dwordx4 v30, s[16:19], s96 offen lds
    s_add_u32 s96, s86, 0
    s_and_b32 s96, s96, 3
    s_mul_i32 s72, s96, 18432
    s_add_u32 s96, s86, 1
    s_and_b32 s96, s96, 3
    s_mul_i32 s73, s96, 18432
    s_add_u32 s96, s86, 2
    s_and_b32 s96, s96, 3
    s_mul_i32 s74, s96, 18432
    s_add_u32 s96, s86, 3
    s_and_b32 s96, s96, 3
    s_mul_i32 s75, s96, 18432
    v_mov_b32 v2, v240
    v_mov_b32 v3, v241
    v_mov_b32 v4, v242
    v_mov_b32 v5, v243
    v_mov_b32 v6, v244
    v_mov_b32 v7, v245
    v_mov_b32 v19, v246
    v_mov_b32 v20, v247
    v_mov_b32 v21, v248
    v_mov_b32 v22, v249
    v_mov_b32 v23, v250
    v_mov_b32 v24, v251
    s_waitcnt lgkmcnt(0)
    s_cmp_ge_u32 s34, 16
    s_cbranch_scc1 L_quick
    s_mov_b32 s34, 0
    s_atomic_or s34, s[20:21], s101 glc
    s_waitcnt lgkmcnt(0)
    s_cmp_ge_u32 s34, 16
    s_cbranch_scc0 L_slow1
L_quick:
    buffer_load_dwordx4 v[32:35], v25, s[20:23], s72 offen offset:0 sc1
    buffer_load_dwordx4 v[36:39], v25, s[20:23], s72 offen offset:256 sc1
    buffer_load_dwordx4 v[40:43], v25, s[20:23], s72 offen offset:512 sc1
    buffer_load_dwordx4 v[44:47], v25, s[20:23], s72 offen offset:768 sc1
    buffer_load_dwordx4 v[96:99], v27, s[20:23], s72 offen offset:1024 sc1
    buffer_load_dwordx4 v[48:51], v25, s[20:23], s73 offen offset:0 sc1
    buffer_load_dwordx4 v[52:55], v25, s[20:23], s73 offen offset:256 sc1
    buffer_load_dwordx4 v[56:59], v25, s[20:23], s73 offen offset:512 sc1
    buffer_load_dwordx4 v[60:63], v25, s[20:23], s73 offen offset:768 sc1
    buffer_load_dwordx4 v[100:103], v27, s[20:23], s73 offen offset:1024 sc1
    buffer_load_dwordx4 v[64:67], v25, s[20:23], s74 offen offset:0 sc1
    buffer_load_dwordx4 v[68:71], v25, s[20:23], s74 offen offset:256 sc1
    buffer_load_dwordx4 v[72:75], v25, s[20:23], s74 offen offset:512 sc1
    buffer_load_dwordx4 v[76:79], v25, s[20:23], s74 offen offset:768 sc1
    buffer_load_dwordx4 v[104:107], v27, s[20:23], s74 offen offset:1024 sc1
    buffer_load_dwordx4 v[80:83], v25, s[20:23], s75 offen offset:0 sc1
    s_waitcnt vmcnt(16)
    s_atomic_add s35, s[20:21], s98
    s_barrier
    buffer_load_dwordx4 v[84:87], v25, s[20:23], s75 offen offset:256 sc1
    ds_read_b64_tr_b16 v[128:129], v2 offset:0
    ds_read_b64_tr_b16 v[130:131], v2 offset:512
    buffer_load_dwordx4 v[88:91], v25, s[20:23], s75 offen offset:512 sc1
    ds_read_b64_tr_b16 v[132:133], v3 offset:0
    ds_read_b64_tr_b16 v[134:135], v3 offset:512
    buffer_load_dwordx4 v[92:95], v25, s[20:23], s75 offen offset:768 sc1
    ds_read_b64_tr_b16 v[136:137], v4 offset:0
    ds_read_b64_tr_b16 v[138:139], v4 offset:512
    buffer_load_dwordx4 v[108:111], v27, s[20:23], s75 offen offset:1024 sc1
    ds_read_b64_tr_b16 v[140:141], v5 offset:0
    ds_read_b64_tr_b16 v[142:143], v5 offset:512
    s_add_u32 m0, s81, 90112
    s_mov_b32 s96, 65536
    buffer_load_dwordx4 v31, s[12:15], s96 offen lds
    ds_read_b64_tr_b16 v[144:145], v2 offset:4096
    ds_read_b64_tr_b16 v[146:147], v2 offset:4608
    s_add_u32 m0, s81, 94208
    s_mov_b32 s96, 98304
    buffer_load_dwordx4 v31, s[12:15], s96 offen lds
    ds_read_b64_tr_b16 v[148:149], v3 offset:4096
    ds_read_b64_tr_b16 v[150:151], v3 offset:4608
    s_branch L_sums
L_slow1:
    s_mov_b32 s34, 0
    s_atomic_or s34, s[20:21], s101 glc
    s_waitcnt vmcnt(0)
    s_atomic_add s35, s[20:21], s98
    s_barrier
    s_waitcnt lgkmcnt(0)
    s_cmp_ge_u32 s34, 16
    s_cbranch_scc0 L_slow2
    buffer_load_dwordx4 v[32:35], v25, s[20:23], s72 offen offset:0 sc1
    ds_read_b64_tr_b16 v[128:129], v2 offset:0
    buffer_load_dwordx4 v[36:39], v25, s[20:23], s72 offen offset:256 sc1
    ds_read_b64_tr_b16 v[130:131], v2 offset:512
    buffer_load_dwordx4 v[40:43], v25, s[20:23], s72 offen offset:512 sc1
    buffer_load_dwordx4 v[44:47], v25, s[20:23], s72 offen offset:768 sc1
    ds_read_b64_tr_b16 v[132:133], v3 offset:0
    buffer_load_dwordx4 v[96:99], v27, s[20:23], s72 offen offset:1024 sc1
    buffer_load_dwordx4 v[48:51], v25, s[20:23], s73 offen offset:0 sc1
    ds_read_b64_tr_b16 v[134:135], v3 offset:512
    buffer_load_dwordx4 v[52:55], v25, s[20:23], s73 offen offset:256 sc1
    buffer_load_dwordx4 v[56:59], v25, s[20:23], s73 offen offset:512 sc1
    ds_read_b64_tr_b16 v[136:137], v4 offset:0
    buffer_load_dwordx4 v[60:63], v25, s[20:23], s73 offen offset:768 sc1
    buffer_load_dwordx4 v[100:103], v27, s[20:23], s73 offen offset:1024 sc1
    ds_read_b64_tr_b16 v[138:139], v4 offset:512
    buffer_load_dwordx4 v[64:67], v25, s[20:23], s74 offen offset:0 sc1
    buffer_load_dwordx4 v[68:71], v25, s[20:23], s74 offen offset:256 sc1
    ds_read_b64_tr_b16 v[140:141], v5 offset:0
    buffer_load_dwordx4 v[72:75], v25, s[20:23], s74 offen offset:512 sc1
    ds_read_b64_tr_b16 v[142:143], v5 offset:512
    buffer_load_dwordx4 v[76:79], v25, s[20:23], s74 offen offset:768 sc1
    buffer_load_dwordx4 v[104:107], v27, s[20:23], s74 offen offset:1024 sc1
    ds_read_b64_tr_b16 v[144:145], v2 offset:4096
    buffer_load_dwordx4 v[80:83], v25, s[20:23], s75 offen offset:0 sc1
    buffer_load_dwordx4 v[84:87], v25, s[20:23], s75 offen offset:256 sc1
    ds_read_b64_tr_b16 v[146:147], v2 offset:4608
    buffer_load_dwordx4 v[88:91], v25, s[20:23], s75 offen offset:512 sc1
    buffer_load_dwordx4 v[92:95], v25, s[20:23], s75 offen offset:768 sc1
    ds_read_b64_tr_b16 v[148:149], v3 offset:4096
    buffer_load_dwordx4 v[108:111], v27, s[20:23], s75 offen offset:1024 sc1
    s_add_u32 m0, s81, 90112
    s_mov_b32 s96, 65536
    buffer_load_dwordx4 v31, s[12:15], s96 offen lds
    ds_read_b64_tr_b16 v[150:151], v3 offset:4608
    s_add_u32 m0, s81, 94208
    s_mov_b32 s96, 98304
    buffer_load_dwordx4 v31, s[12:15], s96 offen lds
    s_branch L_sums
L_slow2:
    s_mov_b32 s34, 0
    s_atomic_or s34, s[20:21], s101 glc
    ds_read_b64_tr_b16 v[128:129], v2 offset:0
    ds_read_b64_tr_b16 v[130:131], v2 offset:512
    ds_read_b64_tr_b16 v[132:133], v3 offset:0
    ds_read_b64_tr_b16 v[134:135], v3 offset:512
    ds_read_b64_tr_b16 v[136:137], v4 offset:0
    ds_read_b64_tr_b16 v[138:139], v4 offset:512
    ds_read_b64_tr_b16 v[140:141], v5 offset:0
    ds_read_b64_tr_b16 v[142:143], v5 offset:512
    ds_read_b64_tr_b16 v[144:145], v2 offset:4096
    ds_read_b64_tr_b16 v[146:147], v2 offset:4608
    ds_read_b64_tr_b16 v[148:149], v3 offset:4096
    ds_read_b64_tr_b16 v[150:151], v3 offset:4608
L_again:
    s_mov_b32 s97, 0
    s_branch L_sc5
L_sp4:
    s_mov_b32 s34, 0
    s_atomic_or s34, s[20:21], s101 glc
L_sc5:
    s_waitcnt lgkmcnt(0)
    s_cmp_ge_u32 s34, 16
    s_cbranch_scc1 L_so6
    s_add_u32 s97, s97, 1
    s_cmp_lt_u32 s97, 1048576
    s_cbranch_scc1 L_sp4
L_so6:
    buffer_load_dwordx4 v[32:35], v25, s[20:23], s72 offen offset:0 sc1
    buffer_load_dwordx4 v[36:39], v25, s[20:23], s72 offen offset:256 sc1
    buffer_load_dwordx4 v[40:43], v25, s[20:23], s72 offen offset:512 sc1
    buffer_load_dwordx4 v[44:47], v25, s[20:23], s72 offen offset:768 sc1
    buffer_load_dwordx4 v[96:99], v27, s[20:23], s72 offen offset:1024 sc1
    buffer_load_dwordx4 v[48:51], v25, s[20:23], s73 offen offset:0 sc1
    buffer_load_dwordx4 v[52:55], v25, s[20:23], s73 offen offset:256 sc1
    buffer_load_dwordx4 v[56:59], v25, s[20:23], s73 offen offset:512 sc1
    buffer_load_dwordx4 v[60:63], v25, s[20:23], s73 offen offset:768 sc1
    buffer_load_dwordx4 v[100:103], v27, s[20:23], s73 offen offset:1024 sc1
    buffer_load_dwordx4 v[64:67], v25, s[20:23], s74 offen offset:0 sc1
    buffer_load_dwordx4 v[68:71], v25, s[20:23], s74 offen offset:256 sc1
    buffer_load_dwordx4 v[72:75], v25, s[20:23], s74 offen offset:512 sc1
    buffer_load_dwordx4 v[76:79], v25, s[20:23], s74 offen offset:768 sc1
    buffer_load_dwordx4 v[104:107], v27, s[20:23], s74 offen offset:1024 sc1
    buffer_load_dwordx4 v[80:83], v25, s[20:23], s75 offen offset:0 sc1
    buffer_load_dwordx4 v[84:87], v25, s[20:23], s75 offen offset:256 sc1
    buffer_load_dwordx4 v[88:91], v25, s[20:23], s75 offen offset:512 sc1
    buffer_load_dwordx4 v[92:95], v25, s[20:23], s75 offen offset:768 sc1
    buffer_load_dwordx4 v[108:111], v27, s[20:23], s75 offen offset:1024 sc1
    s_add_u32 m0, s81, 90112
    s_mov_b32 s96, 65536
    buffer_load_dwordx4 v31, s[12:15], s96 offen lds
    s_add_u32 m0, s81, 94208
    s_mov_b32 s96, 98304
    buffer_load_dwordx4 v31, s[12:15], s96 offen lds
L_sums:
    s_mov_b32 s34, 0
    s_atomic_or s34, s[20:21], s70 glc
    s_setprio 3
    s_waitcnt vmcnt(21)
    v_mfma_f32_16x16x32_bf16 v[112:115], v[8:11], v[32:35], 0
    s_waitcnt vmcnt(20)
    v_mfma_f32_16x16x32_bf16 v[112:115], v[12:15], v[36:39], v[112:115]
    s_waitcnt vmcnt(19)
    v_mfma_f32_16x16x32_bf16 v[116:119], v[8:11], v[40:43], 0
    s_waitcnt vmcnt(18)
    v_mfma_f32_16x16x32_bf16 v[116:119], v[12:15], v[44:47], v[116:119]
    s_waitcnt vmcnt(17)
    v_mfma_f32_16x16x32_bf16 v[120:123], v[8:11], v[96:99], 0
    s_waitcnt vmcnt(16)
    v_mfma_f32_16x16x32_bf16 v[112:115], v[8:11], v[48:51], v[112:115]
    s_waitcnt vmcnt(15)
    v_mfma_f32_16x16x32_bf16 v[112:115], v[12:15], v[52:55], v[112:115]
    s_waitcnt vmcnt(14)
    v_mfma_f32_16x16x32_bf16 v[116:119], v[8:11], v[56:59], v[116:119]
    s_waitcnt vmcnt(13)
    v_mfma_f32_16x16x32_bf16 v[116:119], v[12:15], v[60:63], v[116:119]
    s_waitcnt vmcnt(12)
    v_mfma_f32_16x16x32_bf16 v[120:123], v[8:11], v[100:103], v[120:123]
    s_waitcnt vmcnt(11)
    v_mfma_f32_16x16x32_bf16 v[112:115], v[8:11], v[64:67], v[112:115]
    s_waitcnt vmcnt(10)
    v_mfma_f32_16x16x32_bf16 v[112:115], v[12:15], v[68:71], v[112:115]
    s_waitcnt vmcnt(9)
    v_mfma_f32_16x16x32_bf16 v[116:119], v[8:11], v[72:75], v[116:119]
    s_waitcnt vmcnt(8)
    v_mfma_f32_16x16x32_bf16 v[116:119], v[12:15], v[76:79], v[116:119]
    s_waitcnt vmcnt(7)
    v_mfma_f32_16x16x32_bf16 v[120:123], v[8:11], v[104:107], v[120:123]
    s_waitcnt vmcnt(6)
    v_mfma_f32_16x16x32_bf16 v[112:115], v[8:11], v[80:83], v[112:115]
    s_waitcnt vmcnt(5)
    v_mfma_f32_16x16x32_bf16 v[112:115], v[12:15], v[84:87], v[112:115]
    s_waitcnt vmcnt(4)
    v_mfma_f32_16x16x32_bf16 v[116:119], v[8:11], v[88:91], v[116:119]
    s_waitcnt vmcnt(3)
    v_mfma_f32_16x16x32_bf16 v[116:119], v[12:15], v[92:95], v[116:119]
    s_waitcnt vmcnt(2)
    v_mfma_f32_16x16x32_bf16 v[120:123], v[8:11], v[108:111], v[120:123]
    s_bitcmp1_b32 s101, 6
    s_nop 4
    v_add_f32 v124, v112, v116
    s_nop 0
    v_cmp_u_f32 vcc, v124, v120
    s_cbranch_scc1 L_take
    s_cbranch_vccz L_take
    s_add_u32 s101, s101, 64
    s_waitcnt lgkmcnt(0)
    s_mov_b32 s34, 0
    s_branch L_again
L_take:
    v_cvt_pk_bf16_f32 v112, v112, v113
    v_cvt_pk_bf16_f32 v113, v114, v115
    ds_write_b64 v28, v[112:113] offset:0
    v_cvt_pk_bf16_f32 v116, v116, v117
    v_cvt_pk_bf16_f32 v117, v118, v119
    ds_write_b64 v28, v[116:117] offset:16
    v_cvt_pk_bf16_f32 v120, v120, v121
    v_cvt_pk_bf16_f32 v121, v122, v123
    s_mov_b32 exec_hi, 0
    ds_write_b64 v29, v[120:121] offset:1280
    s_mov_b64 exec, -1
    s_setprio 0
    s_add_u32 m0, s81, 98304
    s_mov_b32 s96, 131072
    buffer_load_dwordx4 v31, s[12:15], s96 offen lds
    ds_read_b64_tr_b16 v[152:153], v4 offset:4096
    ds_read_b64_tr_b16 v[154:155], v4 offset:4608
    ds_read_b64_tr_b16 v[156:157], v5 offset:4096
    ds_read_b64_tr_b16 v[158:159], v5 offset:4608
    s_add_u32 m0, s81, 102400
    s_mov_b32 s96, 163840
    buffer_load_dwordx4 v31, s[12:15], s96 offen lds
    ds_read_b64_tr_b16 v[160:161], v2 offset:8192
    ds_read_b64_tr_b16 v[162:163], v2 offset:8704
    ds_read_b64_tr_b16 v[164:165], v3 offset:8192
    ds_read_b64_tr_b16 v[166:167], v3 offset:8704
    s_add_u32 m0, s81, 106496
    s_mov_b32 s96, 196608
    buffer_load_dwordx4 v31, s[12:15], s96 offen lds
    ds_read_b64_tr_b16 v[168:169], v4 offset:8192
    ds_read_b64_tr_b16 v[170:171], v4 offset:8704
    ds_read_b64_tr_b16 v[172:173], v5 offset:8192
    ds_read_b64_tr_b16 v[174:175], v5 offset:8704
    s_add_u32 m0, s81, 110592
    s_mov_b32 s96, 229376
    buffer_load_dwordx4 v31, s[12:15], s96 offen lds
    ds_read_b64_tr_b16 v[176:177], v2 offset:12288
    ds_read_b64_tr_b16 v[178:179], v2 offset:12800
    ds_read_b64_tr_b16 v[180:181], v3 offset:12288
    ds_read_b64_tr_b16 v[182:183], v3 offset:12800
    s_add_u32 m0, s81, 114688
    s_mov_b32 s96, 262144
    buffer_load_dwordx4 v31, s[12:15], s96 offen lds
    ds_read_b64_tr_b16 v[184:185], v4 offset:12288
    ds_read_b64_tr_b16 v[186:187], v4 offset:12800
    ds_read_b64_tr_b16 v[188:189], v5 offset:12288
    ds_read_b64_tr_b16 v[190:191], v5 offset:12800
    s_add_u32 m0, s81, 118784
    s_mov_b32 s96, 294912
    buffer_load_dwordx4 v31, s[12:15], s96 offen lds
    v_add_u32 v2, s66, v2
    ds_read_b64_tr_b16 v[192:193], v2 offset:0
    ds_read_b64_tr_b16 v[194:195], v2 offset:512
    s_add_u32 m0, s81, 122880
    s_mov_b32 s96, 327680
    buffer_load_dwordx4 v31, s[12:15], s96 offen lds
    v_add_u32 v3, s66, v3
    ds_read_b64_tr_b16 v[196:197], v3 offset:0
    ds_read_b64_tr_b16 v[198:199], v3 offset:512
    s_add_u32 m0, s81, 126976
    s_mov_b32 s96, 360448
    buffer_load_dwordx4 v31, s[12:15], s96 offen lds
    v_add_u32 v4, s66, v4
    ds_read_b64_tr_b16 v[200:201], v4 offset:0
    s_waitcnt lgkmcnt(0)
    s_barrier
    s_mov_b32 s72, 0
    s_xor_b32 s73, s72, 4096
    s_xor_b32 s74, s72, 8192
    s_xor_b32 s75, s72, 12288
    s_cmp_ge_u32 s34, 8
    s_cbranch_scc0 L_hlate
    s_add_u32 m0, s81, 131072
    s_mov_b32 s96, 393216
    buffer_load_dwordx4 v31, s[12:15], s96 offen lds
    ds_read_b64_tr_b16 v[202:203], v4 offset:512
    v_add_u32 v5, s66, v5
    s_add_u32 m0, s81, 135168
    s_mov_b32 s96, 425984
    buffer_load_dwordx4 v31, s[12:15], s96 offen lds
    ds_read_b64_tr_b16 v[204:205], v5 offset:0
    ds_read_b64_tr_b16 v[206:207], v5 offset:512
    ds_read_b64_tr_b16 v[208:209], v2 offset:4096
    s_add_u32 m0, s81, 139264
    s_mov_b32 s96, 458752
    buffer_load_dwordx4 v31, s[12:15], s96 offen lds
    ds_read_b64_tr_b16 v[210:211], v2 offset:4608
    ds_read_b64_tr_b16 v[212:213], v3 offset:4096
    ds_read_b64_tr_b16 v[214:215], v3 offset:4608
    s_add_u32 m0, s81, 143360
    s_mov_b32 s96, 491520
    buffer_load_dwordx4 v31, s[12:15], s96 offen lds
    ds_read_b64_tr_b16 v[216:217], v4 offset:4096
    ds_read_b64_tr_b16 v[218:219], v4 offset:4608
    ds_read_b64_tr_b16 v[220:221], v5 offset:4096
    v_xor_b32 v17, 64, v19
    buffer_load_dword v16, v19, s[20:23], s68 offen sc1
    buffer_load_dword v17, v17, s[20:23], s68 offen sc1
    ds_read_b64_tr_b16 v[222:223], v5 offset:4608
    ds_read_b64_tr_b16 v[224:225], v2 offset:8192
    ds_read_b64_tr_b16 v[226:227], v2 offset:8704
    buffer_load_dwordx4 v[32:35], v7, s[20:23], s72 offen offset:0 sc1
    ds_read_b64_tr_b16 v[228:229], v3 offset:8192
    ds_read_b64_tr_b16 v[230:231], v3 offset:8704
    ds_read_b64_tr_b16 v[232:233], v4 offset:8192
    buffer_load_dwordx4 v[36:39], v7, s[20:23], s72 offen offset:2048 sc1
    ds_read_b64_tr_b16 v[234:235], v4 offset:8704
    ds_read_b64_tr_b16 v[236:237], v5 offset:8192
    ds_read_b64_tr_b16 v[238:239], v5 offset:8704
    buffer_load_dwordx4 v[40:43], v7, s[20:23], s73 offen offset:0 sc1
    ds_read_b64_tr_b16 v[240:241], v2 offset:12288
    ds_read_b64_tr_b16 v[242:243], v2 offset:12800
    ds_read_b64_tr_b16 v[244:245], v3 offset:12288
    buffer_load_dwordx4 v[44:47], v7, s[20:23], s73 offen offset:2048 sc1
    ds_read_b64_tr_b16 v[246:247], v3 offset:12800
    ds_read_b64_tr_b16 v[248:249], v4 offset:12288
    ds_read_b64_tr_b16 v[250:251], v4 offset:12800
    buffer_load_dwordx4 v[48:51], v7, s[20:23], s74 offen offset:0 sc1
    ds_read_b64_tr_b16 v[252:253], v5 offset:12288
    ds_read_b64_tr_b16 v[254:255], v5 offset:12800
    s_waitcnt vmcnt(7) lgkmcnt(0)
    s_barrier
    buffer_load_dwordx4 v[52:55], v7, s[20:23], s74 offen offset:2048 sc1
    buffer_load_dwordx4 v[56:59], v7, s[20:23], s75 offen offset:0 sc1
    buffer_load_dwordx4 v[60:63], v7, s[20:23], s75 offen offset:2048 sc1
    buffer_load_dwordx4 v[64:67], v6, s[20:23], s72 offen offset:0 sc1
    buffer_load_dwordx4 v[68:71], v6, s[20:23], s72 offen offset:2048 sc1
    s_branch L_p2mb
L_hlate:
    s_mov_b32 s34, 0
    s_atomic_or s34, s[20:21], s70 glc
    s_add_u32 m0, s81, 131072
    s_mov_b32 s96, 393216
    buffer_load_dwordx4 v31, s[12:15], s96 offen lds
    ds_read_b64_tr_b16 v[202:203], v4 offset:512
    v_add_u32 v5, s66, v5
    ds_read_b64_tr_b16 v[204:205], v5 offset:0
    ds_read_b64_tr_b16 v[206:207], v5 offset:512
    s_add_u32 m0, s81, 135168
    s_mov_b32 s96, 425984
    buffer_load_dwordx4 v31, s[12:15], s96 offen lds
    ds_read_b64_tr_b16 v[208:209], v2 offset:4096
    ds_read_b64_tr_b16 v[210:211], v2 offset:4608
    ds_read_b64_tr_b16 v[212:213], v3 offset:4096
    ds_read_b64_tr_b16 v[214:215], v3 offset:4608
    s_add_u32 m0, s81, 139264
    s_mov_b32 s96, 458752
    buffer_load_dwordx4 v31, s[12:15], s96 offen lds
    ds_read_b64_tr_b16 v[216:217], v4 offset:4096
    ds_read_b64_tr_b16 v[218:219], v4 offset:4608
    ds_read_b64_tr_b16 v[220:221], v5 offset:4096
    ds_read_b64_tr_b16 v[222:223], v5 offset:4608
    ds_read_b64_tr_b16 v[224:225], v2 offset:8192
    s_add_u32 m0, s81, 143360
    s_mov_b32 s96, 491520
    buffer_load_dwordx4 v31, s[12:15], s96 offen lds
    ds_read_b64_tr_b16 v[226:227], v2 offset:8704
    ds_read_b64_tr_b16 v[228:229], v3 offset:8192
    ds_read_b64_tr_b16 v[230:231], v3 offset:8704
    ds_read_b64_tr_b16 v[232:233], v4 offset:8192
    ds_read_b64_tr_b16 v[234:235], v4 offset:8704
    ds_read_b64_tr_b16 v[236:237], v5 offset:8192
    ds_read_b64_tr_b16 v[238:239], v5 offset:8704
    ds_read_b64_tr_b16 v[240:241], v2 offset:12288
    ds_read_b64_tr_b16 v[242:243], v2 offset:12800
    ds_read_b64_tr_b16 v[244:245], v3 offset:12288
    ds_read_b64_tr_b16 v[246:247], v3 offset:12800
    ds_read_b64_tr_b16 v[248:249], v4 offset:12288
    ds_read_b64_tr_b16 v[250:251], v4 offset:12800
    ds_read_b64_tr_b16 v[252:253], v5 offset:12288
    ds_read_b64_tr_b16 v[254:255], v5 offset:12800
    s_waitcnt lgkmcnt(0)
    s_cmp_ge_u32 s34, 8
    s_cbranch_scc0 L_hlate2
    v_xor_b32 v17, 64, v19
    buffer_load_dword v16, v19, s[20:23], s68 offen sc1
    buffer_load_dword v17, v17, s[20:23], s68 offen sc1
    buffer_load_dwordx4 v[32:35], v7, s[20:23], s72 offen offset:0 sc1
    buffer_load_dwordx4 v[36:39], v7, s[20:23], s72 offen offset:2048 sc1
    s_waitcnt vmcnt(4)
    s_barrier
    buffer_load_dwordx4 v[40:43], v7, s[20:23], s73 offen offset:0 sc1
    buffer_load_dwordx4 v[44:47], v7, s[20:23], s73 offen offset:2048 sc1
    buffer_load_dwordx4 v[48:51], v7, s[20:23], s74 offen offset:0 sc1
    buffer_load_dwordx4 v[52:55], v7, s[20:23], s74 offen offset:2048 sc1
    buffer_load_dwordx4 v[56:59], v7, s[20:23], s75 offen offset:0 sc1
    buffer_load_dwordx4 v[60:63], v7, s[20:23], s75 offen offset:2048 sc1
    buffer_load_dwordx4 v[64:67], v6, s[20:23], s72 offen offset:0 sc1
    buffer_load_dwordx4 v[68:71], v6, s[20:23], s72 offen offset:2048 sc1
    s_branch L_p2mb
L_hlate2:
    s_mov_b32 s34, 0
    s_atomic_or s34, s[20:21], s70 glc
    s_waitcnt vmcnt(0)
    s_barrier
    s_branch L_p2chk
L_acomp:
    s_waitcnt lgkmcnt(0)
    s_and_b32 s87, s2, 6
    v_lshrrev_b32 v13, 3, v0
    s_bfe_u32 s83, s2, 0x10006
    v_and_b32 v12, 16, v0
    s_or_b32 s87, s87, s83
    s_mul_i32 s72, s64, 1536
    s_mov_b64 s[8:9], s[12:13]
    v_lshlrev_b32 v9, 4, v9
    s_lshl_b32 s83, s87, 7
    v_lshlrev_b32 v12, 2, v12
    s_mov_b32 s11, s7
    v_xor_b32 v12, v12, v9
    v_mul_u32_u24 v14, 3072, v13
    s_mov_b32 s10, 1572864
    v_add3_u32 v6, v14, v12, s83
    s_lshl_b32 s81, s88, 10
    v_add_u32 v4, 1024, v6
    s_load_dwordx2 s[28:29], s[0:1], 16
    s_load_dwordx2 s[20:21], s[0:1], 80
    s_load_dwordx2 s[12:13], s[0:1], 24
    s_load_dwordx2 s[16:17], s[0:1], 48
    s_load_dwordx2 s[24:25], s[0:1], 64
    s_load_dwordx2 s[32:33], s[0:1], 72
    v_and_b32 v1, 63, v0
    v_add_u32 v5, 2048, v6
    s_lshl_b32 s83, s82, 7
    v_lshl_add_u32 v31, v13, 10, v12
    s_and_b32 s89, s88, 1
    v_add_u32 v31, s83, v31
    s_lshl_b32 s89, s89, 5
    v_xor_b32 v31, s89, v31
    s_and_b32 s89, s88, 3
    s_lshr_b32 s90, s88, 2
    s_mov_b32 s22, 33554432
    s_mov_b32 s23, 0x20000
    s_lshl_b32 s93, s89, 12
    v_and_b32 v2, 15, v1
    v_lshrrev_b32 v64, 4, v1
    v_bfe_u32 v65, v1, 1, 3
    v_lshlrev_b32 v2, 7, v2
    v_xor_b32 v64, v64, v65
    v_lshl_or_b32 v2, v64, 4, v2
    v_add_u32 v2, s93, v2
    v_xor_b32 v3, 64, v2
    v_add_u32 v4, 0x10000, v2
    v_add_u32 v5, 0x10000, v3
    v_lshrrev_b32 v64, 4, v1
    v_bfe_u32 v65, v1, 2, 2
    v_lshl_add_u32 v65, v64, 3, v65
    v_lshlrev_b32 v8, 7, v65
    v_and_b32 v65, 3, v1
    v_lshl_or_b32 v8, v65, 3, v8
    v_bfe_u32 v65, v1, 3, 1
    v_lshl_or_b32 v8, v65, 6, v8
    v_and_b32 v65, 1, v64
    v_lshl_or_b32 v8, v65, 5, v8
    v_xor_b32 v9, 32, v8
    v_xor_b32 v10, 64, v8
    v_xor_b32 v11, 96, v8
    v_add_u32 v12, 65536, v8
    v_add_u32 v13, 65536, v9
    v_add_u32 v14, 65536, v10
    v_add_u32 v15, 65536, v11
    v_add_u32 v16, 131072, v8
    v_add_u32 v17, 131072, v9
    v_add_u32 v18, 131072, v10
    v_add_u32 v19, 131072, v11
    v_subrev_u32 v29, 0x8000, v31
    s_mov_b32 s14, 524288
    s_mov_b32 s15, 0x20000
    s_mov_b32 s18, 524288
    s_mov_b32 s19, 0x20000
    s_mov_b32 s26, 2097152
    s_mov_b32 s27, 0x20000
    s_mov_b32 s84, 0x3fb8aa3b
    s_mov_b32 s85, 0x3fb8aa3b
    s_mov_b32 s35, 1
    v_lshrrev_b32 v64, 5, v1
    v_bfe_u32 v65, v1, 2, 2
    v_lshl_add_u32 v64, v64, 3, v65
    v_lshlrev_b32 v26, 5, v64
    v_bfe_u32 v64, v1, 4, 1
    v_lshl_or_b32 v26, v64, 4, v26
    v_bfe_u32 v64, v1, 1, 1
    v_lshl_or_b32 v26, v64, 3, v26
    v_add_u32 v26, 155648, v26
    v_bfe_u32 v64, v1, 2, 1
    v_mul_u32_u24 v27, 0x8000, v64
    v_lshl_or_b32 v27, v27, 16, v27
    v_and_b32 v64, 31, v1
    v_lshrrev_b32 v65, 5, v1
    v_lshlrev_b32 v65, 1, v65
    v_bfe_u32 v23, v1, 1, 2
    v_xor_b32 v65, v65, v23
    v_lshlrev_b32 v22, 6, v64
    v_lshl_or_b32 v22, v65, 4, v22
    s_lshl_b32 s92, s89, 11
    v_add_u32 v22, s92, v22
    v_xor_b32 v23, 16, v22
    v_lshlrev_b32 v24, 4, v1
    v_add_u32 v24, s92, v24
    v_and_b32 v64, 15, v1
    v_lshrrev_b32 v65, 4, v1
    v_bfe_u32 v66, v1, 1, 2
    v_xor_b32 v65, v65, v66
    v_lshlrev_b32 v25, 6, v64
    v_lshl_or_b32 v25, v65, 4, v25
    s_lshl_b32 s92, s89, 10
    s_add_u32 s92, s92, 32768
    v_add_u32 v25, s92, v25
    s_mov_b32 s35, 2
    s_mov_b32 s90, 0
    v_and_b32 v64, 3, v1
    v_bfe_u32 v65, v1, 2, 1
    v_lshl_or_b32 v64, v65, 3, v64
    v_bfe_u32 v65, v1, 3, 1
    v_lshl_or_b32 v64, v65, 2, v64
    v_and_b32 v65, 16, v1
    v_or_b32 v64, v64, v65
    v_min_u32 v64, 16, v64
    v_mul_u32_u24 v28, 80, v64
    v_and_b32 v65, 32, v1
    v_add_u32 v28, v28, v65
    s_mul_i32 s92, s90, 2720
    s_add_u32 s92, s92, 155648
    v_add_u32 v28, s92, v28
    s_lshl_b32 s92, s86, 2
    s_add_u32 s92, s92, s89
    s_lshl_b32 s82, s87, 1
    s_add_u32 s82, s82, s90
    s_mul_i32 s83, s92, 41984
    s_lshl_b32 s93, s82, 11
    s_add_u32 s83, s83, s93
    v_lshlrev_b32 v0, 4, v1
    v_add_u32 v0, s83, v0
    s_lshl_b32 s92, s92, 8
    s_lshr_b32 s83, s87, 2
    s_lshl_b32 s83, s83, 7
    s_add_u32 s92, s92, s83
    s_add_u32 s99, s92, 6033408
    s_and_b32 s94, s2, 7
    s_lshr_b32 s92, s2, 7
    s_lshl1_add_u32 s94, s94, s92
    s_bfe_u32 s95, s2, 0x10006
    s_bfe_u32 s92, s88, 0x10001
    s_lshl1_add_u32 s95, s95, s92
    s_and_b32 s71, s88, 1
    s_mov_b32 s3, 0
    s_mul_i32 s65, s71, 32768
    s_add_u32 s65, s65, 81920
    s_mul_i32 s66, s71, 32768
    s_add_u32 s66, s66, 98304
    s_mov_b32 s83, 0
    s_lshl_b32 s92, s94, 2
    s_add_u32 s92, s92, s95
    s_mul_i32 s82, s92, 41984
    s_add_u32 s83, s83, s82
    s_lshl_b32 s82, s71, 14
    s_add_u32 s67, s83, s82
    s_lshl_b32 s92, s92, 8
    s_lshl_b32 s82, s3, 14
    s_add_u32 s92, s92, s82
    s_lshl_b32 s82, s71, 7
    s_add_u32 s92, s92, s82
    s_add_u32 s70, s92, 6033408
    s_lshl_b32 s92, s94, 1
    s_add_u32 s92, s92, s71
    s_lshl_b32 s92, s92, 11
    s_lshl_b32 s82, s95, 7
    s_add_u32 s92, s92, s82
    s_add_u32 s68, s92, 5963776
    s_lshr_b32 s92, s94, 1
    s_lshl_b32 s92, s92, 8
    s_and_b32 s82, s94, 1
    s_or_b32 s92, s92, s82
    s_lshl_b32 s82, s95, 6
    s_add_u32 s92, s92, s82
    s_lshl_b32 s92, s92, 10
    s_bfe_u32 s82, s2, 0x30003
    s_lshl_b32 s82, s82, 7
    s_add_u32 s92, s92, s82
    s_lshl_b32 s82, s71, 15
    s_add_u32 s69, s92, s82
    s_lshl_b32 s82, s71, 8
    s_add_u32 s67, s67, s82
    s_sub_u32 s66, s66, s65
    s_lshl_b32 s71, s71, 6
    s_and_b32 s92, s88, 3
    s_lshl_b32 s94, s92, 12
    s_add_u32 s94, s94, 0
    s_lshl_b32 s92, s92, 8
    s_add_u32 s95, s92, 161280
    s_waitcnt lgkmcnt(0)
    s_barrier
    s_setprio 2
    ds_read_b128 v[128:131], v2 offset:0
    ds_read_b128 v[132:135], v2 offset:2048
    ds_read_b64_tr_b16 v[96:97], v8 offset:16384
    ds_read_b64_tr_b16 v[98:99], v8 offset:16896
    ds_read_b64_tr_b16 v[100:101], v9 offset:16384
    ds_read_b64_tr_b16 v[102:103], v9 offset:16896
    ds_read_b64_tr_b16 v[104:105], v10 offset:16384
    ds_read_b64_tr_b16 v[106:107], v10 offset:16896
    ds_read_b64_tr_b16 v[108:109], v11 offset:16384
    ds_read_b64_tr_b16 v[110:111], v11 offset:16896
    s_waitcnt lgkmcnt(4)
    v_mfma_f32_16x16x32_bf16 v[32:35], v[96:99], v[128:131], 0
    ds_read_b64_tr_b16 v[112:113], v8 offset:24576
    v_mfma_f32_16x16x32_bf16 v[36:39], v[96:99], v[132:135], 0
    ds_read_b64_tr_b16 v[114:115], v8 offset:25088
    v_mfma_f32_16x16x32_bf16 v[40:43], v[100:103], v[128:131], 0
    ds_read_b64_tr_b16 v[116:117], v9 offset:24576
    v_mfma_f32_16x16x32_bf16 v[44:47], v[100:103], v[132:135], 0
    ds_read_b64_tr_b16 v[118:119], v9 offset:25088
    s_waitcnt lgkmcnt(4)
    v_mfma_f32_16x16x32_bf16 v[48:51], v[104:107], v[128:131], 0
    ds_read_b64_tr_b16 v[120:121], v10 offset:24576
    v_mfma_f32_16x16x32_bf16 v[52:55], v[104:107], v[132:135], 0
    ds_read_b64_tr_b16 v[122:123], v10 offset:25088
    v_mfma_f32_16x16x32_bf16 v[56:59], v[108:111], v[128:131], 0
    ds_read_b64_tr_b16 v[124:125], v11 offset:24576
    v_mfma_f32_16x16x32_bf16 v[60:63], v[108:111], v[132:135], 0
    ds_read_b64_tr_b16 v[126:127], v11 offset:25088
    s_waitcnt lgkmcnt(4)
    v_mfma_f32_16x16x32_bf16 v[64:67], v[112:115], v[128:131], 0
    ds_read_b128 v[136:139], v3 offset:0
    ds_read_b128 v[140:143], v3 offset:2048
    v_mfma_f32_16x16x32_bf16 v[68:71], v[112:115], v[132:135], 0
    ds_read_b64_tr_b16 v[96:97], v8 offset:20480
    ds_read_b64_tr_b16 v[98:99], v8 offset:20992
    v_mfma_f32_16x16x32_bf16 v[72:75], v[116:119], v[128:131], 0
    ds_read_b64_tr_b16 v[100:101], v9 offset:20480
    v_mfma_f32_16x16x32_bf16 v[76:79], v[116:119], v[132:135], 0
    ds_read_b64_tr_b16 v[102:103], v9 offset:20992
    s_waitcnt lgkmcnt(6)
    v_mfma_f32_16x16x32_bf16 v[80:83], v[120:123], v[128:131], 0
    ds_read_b64_tr_b16 v[104:105], v10 offset:20480
    v_mfma_f32_16x16x32_bf16 v[84:87], v[120:123], v[132:135], 0
    ds_read_b64_tr_b16 v[106:107], v10 offset:20992
    v_mfma_f32_16x16x32_bf16 v[88:91], v[124:127], v[128:131], 0
    ds_read_b64_tr_b16 v[108:109], v11 offset:20480
    v_mfma_f32_16x16x32_bf16 v[92:95], v[124:127], v[132:135], 0
    ds_read_b64_tr_b16 v[110:111], v11 offset:20992
    s_waitcnt lgkmcnt(4)
    v_mfma_f32_16x16x32_bf16 v[32:35], v[96:99], v[136:139], v[32:35]
    ds_read_b64_tr_b16 v[112:113], v8 offset:28672
    v_mfma_f32_16x16x32_bf16 v[36:39], v[96:99], v[140:143], v[36:39]
    ds_read_b64_tr_b16 v[114:115], v8 offset:29184
    v_mfma_f32_16x16x32_bf16 v[40:43], v[100:103], v[136:139], v[40:43]
    ds_read_b64_tr_b16 v[116:117], v9 offset:28672
    v_mfma_f32_16x16x32_bf16 v[44:47], v[100:103], v[140:143], v[44:47]
    ds_read_b64_tr_b16 v[118:119], v9 offset:29184
    s_waitcnt lgkmcnt(4)
    v_mfma_f32_16x16x32_bf16 v[48:51], v[104:107], v[136:139], v[48:51]
    ds_read_b64_tr_b16 v[120:121], v10 offset:28672
    v_mfma_f32_16x16x32_bf16 v[52:55], v[104:107], v[140:143], v[52:55]
    ds_read_b64_tr_b16 v[122:123], v10 offset:29184
    v_mfma_f32_16x16x32_bf16 v[56:59], v[108:111], v[136:139], v[56:59]
    ds_read_b64_tr_b16 v[124:125], v11 offset:28672
    v_mfma_f32_16x16x32_bf16 v[60:63], v[108:111], v[140:143], v[60:63]
    ds_read_b64_tr_b16 v[126:127], v11 offset:29184
    s_barrier
    s_waitcnt lgkmcnt(4)
    v_mfma_f32_16x16x32_bf16 v[64:67], v[112:115], v[136:139], v[64:67]
    ds_read_b128 v[144:147], v2 offset:32768
    ds_read_b128 v[148:151], v2 offset:34816
    v_mfma_f32_16x16x32_bf16 v[68:71], v[112:115], v[140:143], v[68:71]
    ds_read_b64_tr_b16 v[96:97], v8 offset:49152
    ds_read_b64_tr_b16 v[98:99], v8 offset:49664
    v_mfma_f32_16x16x32_bf16 v[72:75], v[116:119], v[136:139], v[72:75]
    ds_read_b64_tr_b16 v[100:101], v9 offset:49152
    v_mfma_f32_16x16x32_bf16 v[76:79], v[116:119], v[140:143], v[76:79]
    ds_read_b64_tr_b16 v[102:103], v9 offset:49664
    s_waitcnt lgkmcnt(6)
    v_mfma_f32_16x16x32_bf16 v[80:83], v[120:123], v[136:139], v[80:83]
    ds_read_b64_tr_b16 v[104:105], v10 offset:49152
    v_mfma_f32_16x16x32_bf16 v[84:87], v[120:123], v[140:143], v[84:87]
    ds_read_b64_tr_b16 v[106:107], v10 offset:49664
    v_mfma_f32_16x16x32_bf16 v[88:91], v[124:127], v[136:139], v[88:91]
    ds_read_b64_tr_b16 v[108:109], v11 offset:49152
    v_mfma_f32_16x16x32_bf16 v[92:95], v[124:127], v[140:143], v[92:95]
    ds_read_b64_tr_b16 v[110:111], v11 offset:49664
    s_waitcnt lgkmcnt(4)
    v_mfma_f32_16x16x32_bf16 v[32:35], v[96:99], v[144:147], v[32:35]
    ds_read_b64_tr_b16 v[112:113], v8 offset:57344
    v_mfma_f32_16x16x32_bf16 v[36:39], v[96:99], v[148:151], v[36:39]
    ds_read_b64_tr_b16 v[114:115], v8 offset:57856
    v_mfma_f32_16x16x32_bf16 v[40:43], v[100:103], v[144:147], v[40:43]
    ds_read_b64_tr_b16 v[116:117], v9 offset:57344
    v_mfma_f32_16x16x32_bf16 v[44:47], v[100:103], v[148:151], v[44:47]
    ds_read_b64_tr_b16 v[118:119], v9 offset:57856
    s_waitcnt lgkmcnt(4)
    v_mfma_f32_16x16x32_bf16 v[48:51], v[104:107], v[144:147], v[48:51]
    ds_read_b64_tr_b16 v[120:121], v10 offset:57344
    v_mfma_f32_16x16x32_bf16 v[52:55], v[104:107], v[148:151], v[52:55]
    ds_read_b64_tr_b16 v[122:123], v10 offset:57856
    v_mfma_f32_16x16x32_bf16 v[56:59], v[108:111], v[144:147], v[56:59]
    ds_read_b64_tr_b16 v[124:125], v11 offset:57344
    v_mfma_f32_16x16x32_bf16 v[60:63], v[108:111], v[148:151], v[60:63]
    ds_read_b64_tr_b16 v[126:127], v11 offset:57856
    s_waitcnt lgkmcnt(4)
    v_mfma_f32_16x16x32_bf16 v[64:67], v[112:115], v[144:147], v[64:67]
    ds_read_b128 v[152:155], v3 offset:32768
    ds_read_b128 v[156:159], v3 offset:34816
    v_mfma_f32_16x16x32_bf16 v[68:71], v[112:115], v[148:151], v[68:71]
    ds_read_b64_tr_b16 v[96:97], v8 offset:53248
    ds_read_b64_tr_b16 v[98:99], v8 offset:53760
    v_mfma_f32_16x16x32_bf16 v[72:75], v[116:119], v[144:147], v[72:75]
    ds_read_b64_tr_b16 v[100:101], v9 offset:53248
    v_mfma_f32_16x16x32_bf16 v[76:79], v[116:119], v[148:151], v[76:79]
    ds_read_b64_tr_b16 v[102:103], v9 offset:53760
    s_waitcnt lgkmcnt(6)
    v_mfma_f32_16x16x32_bf16 v[80:83], v[120:123], v[144:147], v[80:83]
    ds_read_b64_tr_b16 v[104:105], v10 offset:53248
    v_mfma_f32_16x16x32_bf16 v[84:87], v[120:123], v[148:151], v[84:87]
    ds_read_b64_tr_b16 v[106:107], v10 offset:53760
    v_mfma_f32_16x16x32_bf16 v[88:91], v[124:127], v[144:147], v[88:91]
    ds_read_b64_tr_b16 v[108:109], v11 offset:53248
    v_mfma_f32_16x16x32_bf16 v[92:95], v[124:127], v[148:151], v[92:95]
    ds_read_b64_tr_b16 v[110:111], v11 offset:53760
    s_waitcnt lgkmcnt(4)
    v_mfma_f32_16x16x32_bf16 v[32:35], v[96:99], v[152:155], v[32:35]
    ds_read_b64_tr_b16 v[112:113], v8 offset:61440
    v_mfma_f32_16x16x32_bf16 v[36:39], v[96:99], v[156:159], v[36:39]
    ds_read_b64_tr_b16 v[114:115], v8 offset:61952
    v_mfma_f32_16x16x32_bf16 v[40:43], v[100:103], v[152:155], v[40:43]
    ds_read_b64_tr_b16 v[116:117], v9 offset:61440
    v_mfma_f32_16x16x32_bf16 v[44:47], v[100:103], v[156:159], v[44:47]
    ds_read_b64_tr_b16 v[118:119], v9 offset:61952
    s_waitcnt lgkmcnt(4)
    v_mfma_f32_16x16x32_bf16 v[48:51], v[104:107], v[152:155], v[48:51]
    ds_read_b64_tr_b16 v[120:121], v10 offset:61440
    v_mfma_f32_16x16x32_bf16 v[52:55], v[104:107], v[156:159], v[52:55]
    ds_read_b64_tr_b16 v[122:123], v10 offset:61952
    v_mfma_f32_16x16x32_bf16 v[56:59], v[108:111], v[152:155], v[56:59]
    ds_read_b64_tr_b16 v[124:125], v11 offset:61440
    v_mfma_f32_16x16x32_bf16 v[60:63], v[108:111], v[156:159], v[60:63]
    ds_read_b64_tr_b16 v[126:127], v11 offset:61952
    s_barrier
    s_waitcnt lgkmcnt(4)
    v_mfma_f32_16x16x32_bf16 v[64:67], v[112:115], v[152:155], v[64:67]
    ds_read_b128 v[160:163], v4 offset:0
    ds_read_b128 v[164:167], v4 offset:2048
    v_mfma_f32_16x16x32_bf16 v[68:71], v[112:115], v[156:159], v[68:71]
    ds_read_b64_tr_b16 v[96:97], v12 offset:16384
    ds_read_b64_tr_b16 v[98:99], v12 offset:16896
    v_mfma_f32_16x16x32_bf16 v[72:75], v[116:119], v[152:155], v[72:75]
    ds_read_b64_tr_b16 v[100:101], v13 offset:16384
    v_mfma_f32_16x16x32_bf16 v[76:79], v[116:119], v[156:159], v[76:79]
    ds_read_b64_tr_b16 v[102:103], v13 offset:16896
    s_waitcnt lgkmcnt(6)
    v_mfma_f32_16x16x32_bf16 v[80:83], v[120:123], v[152:155], v[80:83]
    ds_read_b64_tr_b16 v[104:105], v14 offset:16384
    v_mfma_f32_16x16x32_bf16 v[84:87], v[120:123], v[156:159], v[84:87]
    ds_read_b64_tr_b16 v[106:107], v14 offset:16896
    v_mfma_f32_16x16x32_bf16 v[88:91], v[124:127], v[152:155], v[88:91]
    ds_read_b64_tr_b16 v[108:109], v15 offset:16384
    v_mfma_f32_16x16x32_bf16 v[92:95], v[124:127], v[156:159], v[92:95]
    ds_read_b64_tr_b16 v[110:111], v15 offset:16896
    s_waitcnt lgkmcnt(4)
    v_mfma_f32_16x16x32_bf16 v[32:35], v[96:99], v[160:163], v[32:35]
    ds_read_b64_tr_b16 v[112:113], v12 offset:24576
    v_mfma_f32_16x16x32_bf16 v[36:39], v[96:99], v[164:167], v[36:39]
    ds_read_b64_tr_b16 v[114:115], v12 offset:25088
    v_mfma_f32_16x16x32_bf16 v[40:43], v[100:103], v[160:163], v[40:43]
    ds_read_b64_tr_b16 v[116:117], v13 offset:24576
    v_mfma_f32_16x16x32_bf16 v[44:47], v[100:103], v[164:167], v[44:47]
    ds_read_b64_tr_b16 v[118:119], v13 offset:25088
    s_waitcnt lgkmcnt(4)
    v_mfma_f32_16x16x32_bf16 v[48:51], v[104:107], v[160:163], v[48:51]
    ds_read_b64_tr_b16 v[120:121], v14 offset:24576
    v_mfma_f32_16x16x32_bf16 v[52:55], v[104:107], v[164:167], v[52:55]
    ds_read_b64_tr_b16 v[122:123], v14 offset:25088
    v_mfma_f32_16x16x32_bf16 v[56:59], v[108:111], v[160:163], v[56:59]
    ds_read_b64_tr_b16 v[124:125], v15 offset:24576
    v_mfma_f32_16x16x32_bf16 v[60:63], v[108:111], v[164:167], v[60:63]
    ds_read_b64_tr_b16 v[126:127], v15 offset:25088
    s_waitcnt lgkmcnt(4)
    v_mfma_f32_16x16x32_bf16 v[64:67], v[112:115], v[160:163], v[64:67]
    ds_read_b128 v[168:171], v5 offset:0
    ds_read_b128 v[172:175], v5 offset:2048
    v_mfma_f32_16x16x32_bf16 v[68:71], v[112:115], v[164:167], v[68:71]
    ds_read_b64_tr_b16 v[96:97], v12 offset:20480
    ds_read_b64_tr_b16 v[98:99], v12 offset:20992
    v_mfma_f32_16x16x32_bf16 v[72:75], v[116:119], v[160:163], v[72:75]
    ds_read_b64_tr_b16 v[100:101], v13 offset:20480
    v_mfma_f32_16x16x32_bf16 v[76:79], v[116:119], v[164:167], v[76:79]
    ds_read_b64_tr_b16 v[102:103], v13 offset:20992
    s_waitcnt lgkmcnt(6)
    v_mfma_f32_16x16x32_bf16 v[80:83], v[120:123], v[160:163], v[80:83]
    ds_read_b64_tr_b16 v[104:105], v14 offset:20480
    v_mfma_f32_16x16x32_bf16 v[84:87], v[120:123], v[164:167], v[84:87]
    ds_read_b64_tr_b16 v[106:107], v14 offset:20992
    v_mfma_f32_16x16x32_bf16 v[88:91], v[124:127], v[160:163], v[88:91]
    ds_read_b64_tr_b16 v[108:109], v15 offset:20480
    v_mfma_f32_16x16x32_bf16 v[92:95], v[124:127], v[164:167], v[92:95]
    ds_read_b64_tr_b16 v[110:111], v15 offset:20992
    s_waitcnt lgkmcnt(4)
    v_mfma_f32_16x16x32_bf16 v[32:35], v[96:99], v[168:171], v[32:35]
    ds_read_b64_tr_b16 v[112:113], v12 offset:28672
    v_mfma_f32_16x16x32_bf16 v[36:39], v[96:99], v[172:175], v[36:39]
    ds_read_b64_tr_b16 v[114:115], v12 offset:29184
    v_mfma_f32_16x16x32_bf16 v[40:43], v[100:103], v[168:171], v[40:43]
    ds_read_b64_tr_b16 v[116:117], v13 offset:28672
    v_mfma_f32_16x16x32_bf16 v[44:47], v[100:103], v[172:175], v[44:47]
    ds_read_b64_tr_b16 v[118:119], v13 offset:29184
    s_waitcnt lgkmcnt(4)
    v_mfma_f32_16x16x32_bf16 v[48:51], v[104:107], v[168:171], v[48:51]
    ds_read_b64_tr_b16 v[120:121], v14 offset:28672
    v_mfma_f32_16x16x32_bf16 v[52:55], v[104:107], v[172:175], v[52:55]
    ds_read_b64_tr_b16 v[122:123], v14 offset:29184
    v_mfma_f32_16x16x32_bf16 v[56:59], v[108:111], v[168:171], v[56:59]
    ds_read_b64_tr_b16 v[124:125], v15 offset:28672
    v_mfma_f32_16x16x32_bf16 v[60:63], v[108:111], v[172:175], v[60:63]
    ds_read_b64_tr_b16 v[126:127], v15 offset:29184
    s_barrier
    s_waitcnt lgkmcnt(4)
    v_mfma_f32_16x16x32_bf16 v[64:67], v[112:115], v[168:171], v[64:67]
    ds_read_b128 v[176:179], v4 offset:32768
    ds_read_b128 v[180:183], v4 offset:34816
    v_mfma_f32_16x16x32_bf16 v[68:71], v[112:115], v[172:175], v[68:71]
    ds_read_b64_tr_b16 v[96:97], v12 offset:49152
    ds_read_b64_tr_b16 v[98:99], v12 offset:49664
    v_mfma_f32_16x16x32_bf16 v[72:75], v[116:119], v[168:171], v[72:75]
    ds_read_b64_tr_b16 v[100:101], v13 offset:49152
    v_mfma_f32_16x16x32_bf16 v[76:79], v[116:119], v[172:175], v[76:79]
    ds_read_b64_tr_b16 v[102:103], v13 offset:49664
    s_waitcnt lgkmcnt(6)
    v_mfma_f32_16x16x32_bf16 v[80:83], v[120:123], v[168:171], v[80:83]
    ds_read_b64_tr_b16 v[104:105], v14 offset:49152
    v_mfma_f32_16x16x32_bf16 v[84:87], v[120:123], v[172:175], v[84:87]
    ds_read_b64_tr_b16 v[106:107], v14 offset:49664
    v_mfma_f32_16x16x32_bf16 v[88:91], v[124:127], v[168:171], v[88:91]
    ds_read_b64_tr_b16 v[108:109], v15 offset:49152
    v_mfma_f32_16x16x32_bf16 v[92:95], v[124:127], v[172:175], v[92:95]
    ds_read_b64_tr_b16 v[110:111], v15 offset:49664
    s_waitcnt lgkmcnt(4)
    v_mfma_f32_16x16x32_bf16 v[32:35], v[96:99], v[176:179], v[32:35]
    ds_read_b64_tr_b16 v[112:113], v12 offset:57344
    v_mfma_f32_16x16x32_bf16 v[36:39], v[96:99], v[180:183], v[36:39]
    ds_read_b64_tr_b16 v[114:115], v12 offset:57856
    v_mfma_f32_16x16x32_bf16 v[40:43], v[100:103], v[176:179], v[40:43]
    ds_read_b64_tr_b16 v[116:117], v13 offset:57344
    v_mfma_f32_16x16x32_bf16 v[44:47], v[100:103], v[180:183], v[44:47]
    ds_read_b64_tr_b16 v[118:119], v13 offset:57856
    s_waitcnt lgkmcnt(4)
    v_mfma_f32_16x16x32_bf16 v[48:51], v[104:107], v[176:179], v[48:51]
    ds_read_b64_tr_b16 v[120:121], v14 offset:57344
    v_mfma_f32_16x16x32_bf16 v[52:55], v[104:107], v[180:183], v[52:55]
    ds_read_b64_tr_b16 v[122:123], v14 offset:57856
    v_mfma_f32_16x16x32_bf16 v[56:59], v[108:111], v[176:179], v[56:59]
    ds_read_b64_tr_b16 v[124:125], v15 offset:57344
    v_mfma_f32_16x16x32_bf16 v[60:63], v[108:111], v[180:183], v[60:63]
    ds_read_b64_tr_b16 v[126:127], v15 offset:57856
    s_waitcnt lgkmcnt(4)
    v_mfma_f32_16x16x32_bf16 v[64:67], v[112:115], v[176:179], v[64:67]
    ds_read_b128 v[184:187], v5 offset:32768
    ds_read_b128 v[188:191], v5 offset:34816
    v_mfma_f32_16x16x32_bf16 v[68:71], v[112:115], v[180:183], v[68:71]
    ds_read_b64_tr_b16 v[96:97], v12 offset:53248
    ds_read_b64_tr_b16 v[98:99], v12 offset:53760
    v_mfma_f32_16x16x32_bf16 v[72:75], v[116:119], v[176:179], v[72:75]
    ds_read_b64_tr_b16 v[100:101], v13 offset:53248
    v_mfma_f32_16x16x32_bf16 v[76:79], v[116:119], v[180:183], v[76:79]
    ds_read_b64_tr_b16 v[102:103], v13 offset:53760
    s_waitcnt lgkmcnt(6)
    v_mfma_f32_16x16x32_bf16 v[80:83], v[120:123], v[176:179], v[80:83]
    ds_read_b64_tr_b16 v[104:105], v14 offset:53248
    v_mfma_f32_16x16x32_bf16 v[84:87], v[120:123], v[180:183], v[84:87]
    ds_read_b64_tr_b16 v[106:107], v14 offset:53760
    v_mfma_f32_16x16x32_bf16 v[88:91], v[124:127], v[176:179], v[88:91]
    ds_read_b64_tr_b16 v[108:109], v15 offset:53248
    v_mfma_f32_16x16x32_bf16 v[92:95], v[124:127], v[180:183], v[92:95]
    ds_read_b64_tr_b16 v[110:111], v15 offset:53760
    s_waitcnt lgkmcnt(4)
    v_mfma_f32_16x16x32_bf16 v[32:35], v[96:99], v[184:187], v[32:35]
    ds_read_b64_tr_b16 v[112:113], v12 offset:61440
    v_mfma_f32_16x16x32_bf16 v[36:39], v[96:99], v[188:191], v[36:39]
    ds_read_b64_tr_b16 v[114:115], v12 offset:61952
    v_mfma_f32_16x16x32_bf16 v[40:43], v[100:103], v[184:187], v[40:43]
    ds_read_b64_tr_b16 v[116:117], v13 offset:61440
    v_mfma_f32_16x16x32_bf16 v[44:47], v[100:103], v[188:191], v[44:47]
    ds_read_b64_tr_b16 v[118:119], v13 offset:61952
    s_waitcnt lgkmcnt(4)
    v_mfma_f32_16x16x32_bf16 v[48:51], v[104:107], v[184:187], v[48:51]
    ds_read_b64_tr_b16 v[120:121], v14 offset:61440
    v_mfma_f32_16x16x32_bf16 v[52:55], v[104:107], v[188:191], v[52:55]
    ds_read_b64_tr_b16 v[122:123], v14 offset:61952
    v_mfma_f32_16x16x32_bf16 v[56:59], v[108:111], v[184:187], v[56:59]
    ds_read_b64_tr_b16 v[124:125], v15 offset:61440
    v_mfma_f32_16x16x32_bf16 v[60:63], v[108:111], v[188:191], v[60:63]
    ds_read_b64_tr_b16 v[126:127], v15 offset:61952
    s_barrier
    s_waitcnt lgkmcnt(4)
    v_mfma_f32_16x16x32_bf16 v[64:67], v[112:115], v[184:187], v[64:67]
    ds_read_b128 v[192:195], v2 offset:0
    ds_read_b128 v[196:199], v2 offset:2048
    v_mfma_f32_16x16x32_bf16 v[68:71], v[112:115], v[188:191], v[68:71]
    ds_read_b64_tr_b16 v[96:97], v8 offset:16384
    ds_read_b64_tr_b16 v[98:99], v8 offset:16896
    v_mfma_f32_16x16x32_bf16 v[72:75], v[116:119], v[184:187], v[72:75]
    ds_read_b64_tr_b16 v[100:101], v9 offset:16384
    v_mfma_f32_16x16x32_bf16 v[76:79], v[116:119], v[188:191], v[76:79]
    ds_read_b64_tr_b16 v[102:103], v9 offset:16896
    s_waitcnt lgkmcnt(6)
    v_mfma_f32_16x16x32_bf16 v[80:83], v[120:123], v[184:187], v[80:83]
    ds_read_b64_tr_b16 v[104:105], v10 offset:16384
    v_mfma_f32_16x16x32_bf16 v[84:87], v[120:123], v[188:191], v[84:87]
    ds_read_b64_tr_b16 v[106:107], v10 offset:16896
    v_mfma_f32_16x16x32_bf16 v[88:91], v[124:127], v[184:187], v[88:91]
    ds_read_b64_tr_b16 v[108:109], v11 offset:16384
    v_mfma_f32_16x16x32_bf16 v[92:95], v[124:127], v[188:191], v[92:95]
    ds_read_b64_tr_b16 v[110:111], v11 offset:16896
    s_waitcnt lgkmcnt(4)
    v_mfma_f32_16x16x32_bf16 v[32:35], v[96:99], v[192:195], v[32:35]
    ds_read_b64_tr_b16 v[112:113], v8 offset:24576
    v_mfma_f32_16x16x32_bf16 v[36:39], v[96:99], v[196:199], v[36:39]
    ds_read_b64_tr_b16 v[114:115], v8 offset:25088
    v_mfma_f32_16x16x32_bf16 v[40:43], v[100:103], v[192:195], v[40:43]
    ds_read_b64_tr_b16 v[116:117], v9 offset:24576
    v_mfma_f32_16x16x32_bf16 v[44:47], v[100:103], v[196:199], v[44:47]
    ds_read_b64_tr_b16 v[118:119], v9 offset:25088
    s_waitcnt lgkmcnt(4)
    v_mfma_f32_16x16x32_bf16 v[48:51], v[104:107], v[192:195], v[48:51]
    ds_read_b64_tr_b16 v[120:121], v10 offset:24576
    v_mfma_f32_16x16x32_bf16 v[52:55], v[104:107], v[196:199], v[52:55]
    ds_read_b64_tr_b16 v[122:123], v10 offset:25088
    v_mfma_f32_16x16x32_bf16 v[56:59], v[108:111], v[192:195], v[56:59]
    ds_read_b64_tr_b16 v[124:125], v11 offset:24576
    v_mfma_f32_16x16x32_bf16 v[60:63], v[108:111], v[196:199], v[60:63]
    ds_read_b64_tr_b16 v[126:127], v11 offset:25088
    s_waitcnt lgkmcnt(4)
    v_mfma_f32_16x16x32_bf16 v[64:67], v[112:115], v[192:195], v[64:67]
    ds_read_b128 v[200:203], v3 offset:0
    ds_read_b128 v[204:207], v3 offset:2048
    v_mfma_f32_16x16x32_bf16 v[68:71], v[112:115], v[196:199], v[68:71]
    ds_read_b64_tr_b16 v[96:97], v8 offset:20480
    ds_read_b64_tr_b16 v[98:99], v8 offset:20992
    v_mfma_f32_16x16x32_bf16 v[72:75], v[116:119], v[192:195], v[72:75]
    ds_read_b64_tr_b16 v[100:101], v9 offset:20480
    v_mfma_f32_16x16x32_bf16 v[76:79], v[116:119], v[196:199], v[76:79]
    ds_read_b64_tr_b16 v[102:103], v9 offset:20992
    s_waitcnt lgkmcnt(6)
    v_mfma_f32_16x16x32_bf16 v[80:83], v[120:123], v[192:195], v[80:83]
    ds_read_b64_tr_b16 v[104:105], v10 offset:20480
    v_mfma_f32_16x16x32_bf16 v[84:87], v[120:123], v[196:199], v[84:87]
    ds_read_b64_tr_b16 v[106:107], v10 offset:20992
    v_mfma_f32_16x16x32_bf16 v[88:91], v[124:127], v[192:195], v[88:91]
    ds_read_b64_tr_b16 v[108:109], v11 offset:20480
    v_mfma_f32_16x16x32_bf16 v[92:95], v[124:127], v[196:199], v[92:95]
    ds_read_b64_tr_b16 v[110:111], v11 offset:20992
    s_waitcnt lgkmcnt(4)
    v_mfma_f32_16x16x32_bf16 v[32:35], v[96:99], v[200:203], v[32:35]
    ds_read_b64_tr_b16 v[112:113], v8 offset:28672
    v_mfma_f32_16x16x32_bf16 v[36:39], v[96:99], v[204:207], v[36:39]
    ds_read_b64_tr_b16 v[114:115], v8 offset:29184
    v_mfma_f32_16x16x32_bf16 v[40:43], v[100:103], v[200:203], v[40:43]
    ds_read_b64_tr_b16 v[116:117], v9 offset:28672
    v_mfma_f32_16x16x32_bf16 v[44:47], v[100:103], v[204:207], v[44:47]
    ds_read_b64_tr_b16 v[118:119], v9 offset:29184
    s_waitcnt lgkmcnt(4)
    v_mfma_f32_16x16x32_bf16 v[48:51], v[104:107], v[200:203], v[48:51]
    ds_read_b64_tr_b16 v[120:121], v10 offset:28672
    v_mfma_f32_16x16x32_bf16 v[52:55], v[104:107], v[204:207], v[52:55]
    ds_read_b64_tr_b16 v[122:123], v10 offset:29184
    v_mfma_f32_16x16x32_bf16 v[56:59], v[108:111], v[200:203], v[56:59]
    ds_read_b64_tr_b16 v[124:125], v11 offset:28672
    v_mfma_f32_16x16x32_bf16 v[60:63], v[108:111], v[204:207], v[60:63]
    ds_read_b64_tr_b16 v[126:127], v11 offset:29184
    s_barrier
    s_waitcnt lgkmcnt(4)
    v_mfma_f32_16x16x32_bf16 v[64:67], v[112:115], v[200:203], v[64:67]
    ds_read_b128 v[208:211], v2 offset:32768
    ds_read_b128 v[212:215], v2 offset:34816
    v_mfma_f32_16x16x32_bf16 v[68:71], v[112:115], v[204:207], v[68:71]
    ds_read_b64_tr_b16 v[96:97], v8 offset:49152
    ds_read_b64_tr_b16 v[98:99], v8 offset:49664
    v_mfma_f32_16x16x32_bf16 v[72:75], v[116:119], v[200:203], v[72:75]
    ds_read_b64_tr_b16 v[100:101], v9 offset:49152
    v_mfma_f32_16x16x32_bf16 v[76:79], v[116:119], v[204:207], v[76:79]
    ds_read_b64_tr_b16 v[102:103], v9 offset:49664
    s_waitcnt lgkmcnt(6)
    v_mfma_f32_16x16x32_bf16 v[80:83], v[120:123], v[200:203], v[80:83]
    ds_read_b64_tr_b16 v[104:105], v10 offset:49152
    v_mfma_f32_16x16x32_bf16 v[84:87], v[120:123], v[204:207], v[84:87]
    ds_read_b64_tr_b16 v[106:107], v10 offset:49664
    v_mfma_f32_16x16x32_bf16 v[88:91], v[124:127], v[200:203], v[88:91]
    ds_read_b64_tr_b16 v[108:109], v11 offset:49152
    v_mfma_f32_16x16x32_bf16 v[92:95], v[124:127], v[204:207], v[92:95]
    ds_read_b64_tr_b16 v[110:111], v11 offset:49664
    s_waitcnt lgkmcnt(4)
    v_mfma_f32_16x16x32_bf16 v[32:35], v[96:99], v[208:211], v[32:35]
    ds_read_b64_tr_b16 v[112:113], v8 offset:57344
    v_mfma_f32_16x16x32_bf16 v[36:39], v[96:99], v[212:215], v[36:39]
    ds_read_b64_tr_b16 v[114:115], v8 offset:57856
    v_mfma_f32_16x16x32_bf16 v[40:43], v[100:103], v[208:211], v[40:43]
    ds_read_b64_tr_b16 v[116:117], v9 offset:57344
    v_mfma_f32_16x16x32_bf16 v[44:47], v[100:103], v[212:215], v[44:47]
    ds_read_b64_tr_b16 v[118:119], v9 offset:57856
    s_waitcnt lgkmcnt(4)
    v_mfma_f32_16x16x32_bf16 v[48:51], v[104:107], v[208:211], v[48:51]
    ds_read_b64_tr_b16 v[120:121], v10 offset:57344
    v_mfma_f32_16x16x32_bf16 v[52:55], v[104:107], v[212:215], v[52:55]
    ds_read_b64_tr_b16 v[122:123], v10 offset:57856
    v_mfma_f32_16x16x32_bf16 v[56:59], v[108:111], v[208:211], v[56:59]
    ds_read_b64_tr_b16 v[124:125], v11 offset:57344
    v_mfma_f32_16x16x32_bf16 v[60:63], v[108:111], v[212:215], v[60:63]
    ds_read_b64_tr_b16 v[126:127], v11 offset:57856
    s_waitcnt lgkmcnt(4)
    v_mfma_f32_16x16x32_bf16 v[64:67], v[112:115], v[208:211], v[64:67]
    ds_read_b128 v[216:219], v3 offset:32768
    ds_read_b128 v[220:223], v3 offset:34816
    v_mfma_f32_16x16x32_bf16 v[68:71], v[112:115], v[212:215], v[68:71]
    ds_read_b64_tr_b16 v[96:97], v8 offset:53248
    ds_read_b64_tr_b16 v[98:99], v8 offset:53760
    v_mfma_f32_16x16x32_bf16 v[72:75], v[116:119], v[208:211], v[72:75]
    ds_read_b64_tr_b16 v[100:101], v9 offset:53248
    v_mfma_f32_16x16x32_bf16 v[76:79], v[116:119], v[212:215], v[76:79]
    ds_read_b64_tr_b16 v[102:103], v9 offset:53760
    s_waitcnt lgkmcnt(6)
    v_mfma_f32_16x16x32_bf16 v[80:83], v[120:123], v[208:211], v[80:83]
    ds_read_b64_tr_b16 v[104:105], v10 offset:53248
    v_mfma_f32_16x16x32_bf16 v[84:87], v[120:123], v[212:215], v[84:87]
    ds_read_b64_tr_b16 v[106:107], v10 offset:53760
    v_mfma_f32_16x16x32_bf16 v[88:91], v[124:127], v[208:211], v[88:91]
    ds_read_b64_tr_b16 v[108:109], v11 offset:53248
    v_mfma_f32_16x16x32_bf16 v[92:95], v[124:127], v[212:215], v[92:95]
    ds_read_b64_tr_b16 v[110:111], v11 offset:53760
    s_waitcnt lgkmcnt(4)
    v_mfma_f32_16x16x32_bf16 v[32:35], v[96:99], v[216:219], v[32:35]
    ds_read_b64_tr_b16 v[112:113], v8 offset:61440
    v_mfma_f32_16x16x32_bf16 v[36:39], v[96:99], v[220:223], v[36:39]
    ds_read_b64_tr_b16 v[114:115], v8 offset:61952
    v_mfma_f32_16x16x32_bf16 v[40:43], v[100:103], v[216:219], v[40:43]
    ds_read_b64_tr_b16 v[116:117], v9 offset:61440
    v_mfma_f32_16x16x32_bf16 v[44:47], v[100:103], v[220:223], v[44:47]
    ds_read_b64_tr_b16 v[118:119], v9 offset:61952
    s_waitcnt lgkmcnt(4)
    v_mfma_f32_16x16x32_bf16 v[48:51], v[104:107], v[216:219], v[48:51]
    ds_read_b64_tr_b16 v[120:121], v10 offset:61440
    v_mfma_f32_16x16x32_bf16 v[52:55], v[104:107], v[220:223], v[52:55]
    ds_read_b64_tr_b16 v[122:123], v10 offset:61952
    v_mfma_f32_16x16x32_bf16 v[56:59], v[108:111], v[216:219], v[56:59]
    ds_read_b64_tr_b16 v[124:125], v11 offset:61440
    v_mfma_f32_16x16x32_bf16 v[60:63], v[108:111], v[220:223], v[60:63]
    ds_read_b64_tr_b16 v[126:127], v11 offset:61952
    s_waitcnt vmcnt(0)
    s_barrier
    s_waitcnt lgkmcnt(4)
    v_mfma_f32_16x16x32_bf16 v[64:67], v[112:115], v[216:219], v[64:67]
    ds_read_b128 v[224:227], v4 offset:0
    ds_read_b128 v[228:231], v4 offset:2048
    v_mfma_f32_16x16x32_bf16 v[68:71], v[112:115], v[220:223], v[68:71]
    ds_read_b64_tr_b16 v[96:97], v12 offset:16384
    ds_read_b64_tr_b16 v[98:99], v12 offset:16896
    v_mfma_f32_16x16x32_bf16 v[72:75], v[116:119], v[216:219], v[72:75]
    ds_read_b64_tr_b16 v[100:101], v13 offset:16384
    v_mfma_f32_16x16x32_bf16 v[76:79], v[116:119], v[220:223], v[76:79]
    ds_read_b64_tr_b16 v[102:103], v13 offset:16896
    s_waitcnt lgkmcnt(6)
    v_mfma_f32_16x16x32_bf16 v[80:83], v[120:123], v[216:219], v[80:83]
    ds_read_b64_tr_b16 v[104:105], v14 offset:16384
    v_mfma_f32_16x16x32_bf16 v[84:87], v[120:123], v[220:223], v[84:87]
    ds_read_b64_tr_b16 v[106:107], v14 offset:16896
    v_mfma_f32_16x16x32_bf16 v[88:91], v[124:127], v[216:219], v[88:91]
    ds_read_b64_tr_b16 v[108:109], v15 offset:16384
    v_mfma_f32_16x16x32_bf16 v[92:95], v[124:127], v[220:223], v[92:95]
    ds_read_b64_tr_b16 v[110:111], v15 offset:16896
    s_waitcnt lgkmcnt(4)
    v_mfma_f32_16x16x32_bf16 v[32:35], v[96:99], v[224:227], v[32:35]
    ds_read_b64_tr_b16 v[112:113], v12 offset:24576
    v_mfma_f32_16x16x32_bf16 v[36:39], v[96:99], v[228:231], v[36:39]
    ds_read_b64_tr_b16 v[114:115], v12 offset:25088
    v_mfma_f32_16x16x32_bf16 v[40:43], v[100:103], v[224:227], v[40:43]
    ds_read_b64_tr_b16 v[116:117], v13 offset:24576
    v_mfma_f32_16x16x32_bf16 v[44:47], v[100:103], v[228:231], v[44:47]
    ds_read_b64_tr_b16 v[118:119], v13 offset:25088
    s_waitcnt lgkmcnt(4)
    v_mfma_f32_16x16x32_bf16 v[48:51], v[104:107], v[224:227], v[48:51]
    ds_read_b64_tr_b16 v[120:121], v14 offset:24576
    v_mfma_f32_16x16x32_bf16 v[52:55], v[104:107], v[228:231], v[52:55]
    ds_read_b64_tr_b16 v[122:123], v14 offset:25088
    v_mfma_f32_16x16x32_bf16 v[56:59], v[108:111], v[224:227], v[56:59]
    ds_read_b64_tr_b16 v[124:125], v15 offset:24576
    v_mfma_f32_16x16x32_bf16 v[60:63], v[108:111], v[228:231], v[60:63]
    ds_read_b64_tr_b16 v[126:127], v15 offset:25088
    s_waitcnt lgkmcnt(4)
    v_mfma_f32_16x16x32_bf16 v[64:67], v[112:115], v[224:227], v[64:67]
    ds_read_b128 v[232:235], v5 offset:0
    ds_read_b128 v[236:239], v5 offset:2048
    v_mfma_f32_16x16x32_bf16 v[68:71], v[112:115], v[228:231], v[68:71]
    ds_read_b64_tr_b16 v[96:97], v12 offset:20480
    ds_read_b64_tr_b16 v[98:99], v12 offset:20992
    v_mfma_f32_16x16x32_bf16 v[72:75], v[116:119], v[224:227], v[72:75]
    ds_read_b64_tr_b16 v[100:101], v13 offset:20480
    v_mfma_f32_16x16x32_bf16 v[76:79], v[116:119], v[228:231], v[76:79]
    ds_read_b64_tr_b16 v[102:103], v13 offset:20992
    s_waitcnt lgkmcnt(6)
    v_mfma_f32_16x16x32_bf16 v[80:83], v[120:123], v[224:227], v[80:83]
    ds_read_b64_tr_b16 v[104:105], v14 offset:20480
    v_mfma_f32_16x16x32_bf16 v[84:87], v[120:123], v[228:231], v[84:87]
    ds_read_b64_tr_b16 v[106:107], v14 offset:20992
    v_mfma_f32_16x16x32_bf16 v[88:91], v[124:127], v[224:227], v[88:91]
    ds_read_b64_tr_b16 v[108:109], v15 offset:20480
    v_mfma_f32_16x16x32_bf16 v[92:95], v[124:127], v[228:231], v[92:95]
    ds_read_b64_tr_b16 v[110:111], v15 offset:20992
    s_waitcnt lgkmcnt(4)
    v_mfma_f32_16x16x32_bf16 v[32:35], v[96:99], v[232:235], v[32:35]
    ds_read_b64_tr_b16 v[112:113], v12 offset:28672
    v_mfma_f32_16x16x32_bf16 v[36:39], v[96:99], v[236:239], v[36:39]
    ds_read_b64_tr_b16 v[114:115], v12 offset:29184
    v_mfma_f32_16x16x32_bf16 v[40:43], v[100:103], v[232:235], v[40:43]
    ds_read_b64_tr_b16 v[116:117], v13 offset:28672
    v_mfma_f32_16x16x32_bf16 v[44:47], v[100:103], v[236:239], v[44:47]
    ds_read_b64_tr_b16 v[118:119], v13 offset:29184
    s_waitcnt lgkmcnt(4)
    v_mfma_f32_16x16x32_bf16 v[48:51], v[104:107], v[232:235], v[48:51]
    ds_read_b64_tr_b16 v[120:121], v14 offset:28672
    v_mfma_f32_16x16x32_bf16 v[52:55], v[104:107], v[236:239], v[52:55]
    ds_read_b64_tr_b16 v[122:123], v14 offset:29184
    v_mfma_f32_16x16x32_bf16 v[56:59], v[108:111], v[232:235], v[56:59]
    ds_read_b64_tr_b16 v[124:125], v15 offset:28672
    v_mfma_f32_16x16x32_bf16 v[60:63], v[108:111], v[236:239], v[60:63]
    ds_read_b64_tr_b16 v[126:127], v15 offset:29184
    s_waitcnt lgkmcnt(0)
    s_barrier
    v_mfma_f32_16x16x32_bf16 v[64:67], v[112:115], v[232:235], v[64:67]
    ds_read_b128 v[240:243], v4 offset:32768
    ds_read_b128 v[244:247], v4 offset:34816
    v_mfma_f32_16x16x32_bf16 v[68:71], v[112:115], v[236:239], v[68:71]
    ds_read_b64_tr_b16 v[96:97], v12 offset:49152
    ds_read_b64_tr_b16 v[98:99], v12 offset:49664
    v_mfma_f32_16x16x32_bf16 v[72:75], v[116:119], v[232:235], v[72:75]
    ds_read_b64_tr_b16 v[100:101], v13 offset:49152
    v_mfma_f32_16x16x32_bf16 v[76:79], v[116:119], v[236:239], v[76:79]
    ds_read_b64_tr_b16 v[102:103], v13 offset:49664
    v_mfma_f32_16x16x32_bf16 v[80:83], v[120:123], v[232:235], v[80:83]
    ds_read_b64_tr_b16 v[104:105], v14 offset:49152
    v_mfma_f32_16x16x32_bf16 v[84:87], v[120:123], v[236:239], v[84:87]
    ds_read_b64_tr_b16 v[106:107], v14 offset:49664
    v_mfma_f32_16x16x32_bf16 v[88:91], v[124:127], v[232:235], v[88:91]
    ds_read_b64_tr_b16 v[108:109], v15 offset:49152
    v_mfma_f32_16x16x32_bf16 v[92:95], v[124:127], v[236:239], v[92:95]
    ds_read_b64_tr_b16 v[110:111], v15 offset:49664
    s_waitcnt lgkmcnt(4)
    v_mfma_f32_16x16x32_bf16 v[32:35], v[96:99], v[240:243], v[32:35]
    ds_read_b64_tr_b16 v[112:113], v12 offset:57344
    v_mfma_f32_16x16x32_bf16 v[36:39], v[96:99], v[244:247], v[36:39]
    ds_read_b64_tr_b16 v[114:115], v12 offset:57856
    v_mfma_f32_16x16x32_bf16 v[40:43], v[100:103], v[240:243], v[40:43]
    ds_read_b64_tr_b16 v[116:117], v13 offset:57344
    v_mfma_f32_16x16x32_bf16 v[44:47], v[100:103], v[244:247], v[44:47]
    ds_read_b64_tr_b16 v[118:119], v13 offset:57856
    s_waitcnt lgkmcnt(4)
    v_mfma_f32_16x16x32_bf16 v[48:51], v[104:107], v[240:243], v[48:51]
    ds_read_b64_tr_b16 v[120:121], v14 offset:57344
    v_mfma_f32_16x16x32_bf16 v[52:55], v[104:107], v[244:247], v[52:55]
    ds_read_b64_tr_b16 v[122:123], v14 offset:57856
    v_mfma_f32_16x16x32_bf16 v[56:59], v[108:111], v[240:243], v[56:59]
    ds_read_b64_tr_b16 v[124:125], v15 offset:57344
    v_mfma_f32_16x16x32_bf16 v[60:63], v[108:111], v[244:247], v[60:63]
    ds_read_b64_tr_b16 v[126:127], v15 offset:57856
    s_waitcnt lgkmcnt(4)
    v_mfma_f32_16x16x32_bf16 v[64:67], v[112:115], v[240:243], v[64:67]
    ds_read_b128 v[248:251], v5 offset:32768
    ds_read_b128 v[252:255], v5 offset:34816
    v_mfma_f32_16x16x32_bf16 v[68:71], v[112:115], v[244:247], v[68:71]
    ds_read_b64_tr_b16 v[96:97], v12 offset:53248
    ds_read_b64_tr_b16 v[98:99], v12 offset:53760
    v_mfma_f32_16x16x32_bf16 v[72:75], v[116:119], v[240:243], v[72:75]
    ds_read_b64_tr_b16 v[100:101], v13 offset:53248
    v_mfma_f32_16x16x32_bf16 v[76:79], v[116:119], v[244:247], v[76:79]
    ds_read_b64_tr_b16 v[102:103], v13 offset:53760
    s_waitcnt lgkmcnt(6)
    v_mfma_f32_16x16x32_bf16 v[80:83], v[120:123], v[240:243], v[80:83]
    ds_read_b64_tr_b16 v[104:105], v14 offset:53248
    v_mfma_f32_16x16x32_bf16 v[84:87], v[120:123], v[244:247], v[84:87]
    ds_read_b64_tr_b16 v[106:107], v14 offset:53760
    v_mfma_f32_16x16x32_bf16 v[88:91], v[124:127], v[240:243], v[88:91]
    ds_read_b64_tr_b16 v[108:109], v15 offset:53248
    v_mfma_f32_16x16x32_bf16 v[92:95], v[124:127], v[244:247], v[92:95]
    ds_read_b64_tr_b16 v[110:111], v15 offset:53760
    s_waitcnt lgkmcnt(4)
    v_mfma_f32_16x16x32_bf16 v[32:35], v[96:99], v[248:251], v[32:35]
    ds_read_b64_tr_b16 v[112:113], v12 offset:61440
    v_mfma_f32_16x16x32_bf16 v[36:39], v[96:99], v[252:255], v[36:39]
    ds_read_b64_tr_b16 v[114:115], v12 offset:61952
    v_mfma_f32_16x16x32_bf16 v[40:43], v[100:103], v[248:251], v[40:43]
    ds_read_b64_tr_b16 v[116:117], v13 offset:61440
    v_mfma_f32_16x16x32_bf16 v[44:47], v[100:103], v[252:255], v[44:47]
    ds_read_b64_tr_b16 v[118:119], v13 offset:61952
    s_waitcnt lgkmcnt(4)
    v_mfma_f32_16x16x32_bf16 v[48:51], v[104:107], v[248:251], v[48:51]
    ds_read_b64_tr_b16 v[120:121], v14 offset:61440
    v_mfma_f32_16x16x32_bf16 v[52:55], v[104:107], v[252:255], v[52:55]
    ds_read_b64_tr_b16 v[122:123], v14 offset:61952
    v_mfma_f32_16x16x32_bf16 v[56:59], v[108:111], v[248:251], v[56:59]
    ds_read_b64_tr_b16 v[124:125], v15 offset:61440
    v_mfma_f32_16x16x32_bf16 v[60:63], v[108:111], v[252:255], v[60:63]
    ds_read_b64_tr_b16 v[126:127], v15 offset:61952
    s_waitcnt lgkmcnt(4)
    v_mfma_f32_16x16x32_bf16 v[64:67], v[112:115], v[248:251], v[64:67]
    ds_read_b64_tr_b16 v[104:105], v26 offset:1024
    ds_read_b64_tr_b16 v[106:107], v26 offset:1152
    v_mfma_f32_16x16x32_bf16 v[68:71], v[112:115], v[252:255], v[68:71]
    ds_read_b64_tr_b16 v[108:109], v26 offset:1536
    ds_read_b64_tr_b16 v[110:111], v26 offset:1664
    v_mfma_f32_16x16x32_bf16 v[72:75], v[116:119], v[248:251], v[72:75]
    ds_read_b64_tr_b16 v[96:97], v26 offset:0
    ds_read_b64_tr_b16 v[98:99], v26 offset:128
    v_mfma_f32_16x16x32_bf16 v[76:79], v[116:119], v[252:255], v[76:79]
    ds_read_b64_tr_b16 v[100:101], v26 offset:512
    ds_read_b64_tr_b16 v[102:103], v26 offset:640
    s_waitcnt lgkmcnt(8)
    v_mfma_f32_16x16x32_bf16 v[80:83], v[120:123], v[248:251], v[80:83]
    v_mfma_f32_16x16x32_bf16 v[84:87], v[120:123], v[252:255], v[84:87]
    v_mfma_f32_16x16x32_bf16 v[88:91], v[124:127], v[248:251], v[88:91]
    v_mfma_f32_16x16x32_bf16 v[92:95], v[124:127], v[252:255], v[92:95]
    v_cvt_pk_bf16_f32 v112, v32, v33
    v_cvt_pk_bf16_f32 v113, v34, v35
    v_cvt_pk_bf16_f32 v114, v36, v37
    v_cvt_pk_bf16_f32 v115, v38, v39
    ds_write_b128 v24, v[112:115] offset:0
    v_cvt_pk_bf16_f32 v116, v40, v41
    v_cvt_pk_bf16_f32 v117, v42, v43
    v_cvt_pk_bf16_f32 v118, v44, v45
    v_cvt_pk_bf16_f32 v119, v46, v47
    ds_write_b128 v24, v[116:119] offset:8192
    v_cvt_pk_bf16_f32 v120, v48, v49
    v_cvt_pk_bf16_f32 v121, v50, v51
    v_cvt_pk_bf16_f32 v122, v52, v53
    v_cvt_pk_bf16_f32 v123, v54, v55
    v_cvt_pk_bf16_f32 v124, v56, v57
    v_cvt_pk_bf16_f32 v125, v58, v59
    v_cvt_pk_bf16_f32 v126, v60, v61
    v_cvt_pk_bf16_f32 v127, v62, v63
    v_permlane16_swap_b32 v120, v122
    v_permlane16_swap_b32 v121, v123
    s_waitcnt lgkmcnt(2)
    v_permlane16_swap_b32 v124, v126
    v_permlane16_swap_b32 v125, v127
    v_xor_b32 v104, v27, v104
    v_xor_b32 v105, v27, v105
    v_xor_b32 v106, v27, v106
    v_xor_b32 v107, v27, v107
    v_xor_b32 v108, v27, v108
    v_xor_b32 v109, v27, v109
    v_xor_b32 v110, v27, v110
    v_xor_b32 v111, v27, v111
    s_waitcnt lgkmcnt(0)
    s_barrier
    v_mfma_f32_32x32x16_bf16 v[32:47], v[104:107], v[120:123], 0
    v_mfma_f32_32x32x16_bf16 v[48:63], v[108:111], v[124:127], 0
    s_setprio 0
    v_cvt_pk_bf16_f32 v64, v64, v65
    v_cvt_pk_bf16_f32 v65, v66, v67
    v_cvt_pk_bf16_f32 v66, v68, v69
    v_cvt_pk_bf16_f32 v67, v70, v71
    ds_write_b128 v25, v[64:67] offset:0
    v_cvt_pk_bf16_f32 v72, v72, v73
    v_cvt_pk_bf16_f32 v73, v74, v75
    v_cvt_pk_bf16_f32 v74, v76, v77
    v_cvt_pk_bf16_f32 v75, v78, v79
    ds_write_b128 v25, v[72:75] offset:4096
    v_max3_f32 v112, v32, v33, v34
    v_max3_f32 v113, v35, v36, v37
    v_max3_f32 v112, v112, v38, v39
    v_max3_f32 v113, v113, v40, v41
    v_max3_f32 v112, v112, v42, v43
    v_max3_f32 v113, v113, v44, v45
    v_max3_f32 v112, v112, v46, v47
    v_max_f32 v112, v112, v113
    v_mul_f32 v114, 0xbfb8aa3b, v112
    v_pk_fma_f32 v[32:33], v[32:33], s[84:85], v[114:115] op_sel_hi:[1,0,0]
    v_pk_fma_f32 v[34:35], v[34:35], s[84:85], v[114:115] op_sel_hi:[1,0,0]
    v_exp_f32 v32, v32
    v_exp_f32 v33, v33
    v_pk_fma_f32 v[36:37], v[36:37], s[84:85], v[114:115] op_sel_hi:[1,0,0]
    v_exp_f32 v34, v34
    v_exp_f32 v35, v35
    v_pk_fma_f32 v[38:39], v[38:39], s[84:85], v[114:115] op_sel_hi:[1,0,0]
    v_exp_f32 v36, v36
    v_exp_f32 v37, v37
    v_pk_fma_f32 v[40:41], v[40:41], s[84:85], v[114:115] op_sel_hi:[1,0,0]
    v_exp_f32 v38, v38
    v_exp_f32 v39, v39
    v_pk_fma_f32 v[42:43], v[42:43], s[84:85], v[114:115] op_sel_hi:[1,0,0]
    v_exp_f32 v40, v40
    v_cvt_pk_bf16_f32 v80, v80, v81
    v_cvt_pk_bf16_f32 v81, v82, v83
    v_cvt_pk_bf16_f32 v82, v84, v85
    v_cvt_pk_bf16_f32 v83, v86, v87
    ds_write_b128 v25, v[80:83] offset:8192
    v_exp_f32 v41, v41
    v_pk_fma_f32 v[44:45], v[44:45], s[84:85], v[114:115] op_sel_hi:[1,0,0]
    v_exp_f32 v42, v42
    v_exp_f32 v43, v43
    v_pk_fma_f32 v[46:47], v[46:47], s[84:85], v[114:115] op_sel_hi:[1,0,0]
    v_exp_f32 v44, v44
    v_exp_f32 v45, v45
    v_exp_f32 v46, v46
    v_exp_f32 v47, v47
    v_pk_add_f32 v[116:117], v[32:33], v[34:35]
    v_pk_add_f32 v[118:119], v[36:37], v[38:39]
    v_pk_add_f32 v[116:117], v[116:117], v[40:41]
    v_pk_add_f32 v[118:119], v[118:119], v[42:43]
    v_pk_add_f32 v[116:117], v[116:117], v[44:45]
    v_pk_add_f32 v[118:119], v[118:119], v[46:47]
    v_pk_add_f32 v[116:117], v[116:117], v[118:119]
    v_add_f32 v116, v116, v117
    v_rcp_f32 v114, v116
    s_nop 0
    v_pk_mul_f32 v[32:33], v[32:33], v[114:115] op_sel_hi:[1,0]
    v_pk_mul_f32 v[34:35], v[34:35], v[114:115] op_sel_hi:[1,0]
    v_cvt_pk_bf16_f32 v88, v88, v89
    v_cvt_pk_bf16_f32 v89, v90, v91
    v_cvt_pk_bf16_f32 v90, v92, v93
    v_cvt_pk_bf16_f32 v91, v94, v95
    ds_write_b128 v25, v[88:91] offset:12288
    v_cvt_pk_bf16_f32 v32, v32, v33
    v_pk_mul_f32 v[36:37], v[36:37], v[114:115] op_sel_hi:[1,0]
    v_cvt_pk_bf16_f32 v33, v34, v35
    v_pk_mul_f32 v[38:39], v[38:39], v[114:115] op_sel_hi:[1,0]
    v_cvt_pk_bf16_f32 v34, v36, v37
    v_pk_mul_f32 v[40:41], v[40:41], v[114:115] op_sel_hi:[1,0]
    v_cvt_pk_bf16_f32 v35, v38, v39
    v_pk_mul_f32 v[42:43], v[42:43], v[114:115] op_sel_hi:[1,0]
    v_cvt_pk_bf16_f32 v36, v40, v41
    ds_write_b128 v22, v[32:35] offset:16384
    v_pk_mul_f32 v[44:45], v[44:45], v[114:115] op_sel_hi:[1,0]
    v_cvt_pk_bf16_f32 v37, v42, v43
    v_pk_mul_f32 v[46:47], v[46:47], v[114:115] op_sel_hi:[1,0]
    v_cvt_pk_bf16_f32 v38, v44, v45
    v_cvt_pk_bf16_f32 v39, v46, v47
    ds_write_b128 v23, v[36:39] offset:16384
    v_max3_f32 v112, v48, v49, v50
    v_max3_f32 v113, v51, v52, v53
    v_max3_f32 v112, v112, v54, v55
    v_max3_f32 v113, v113, v56, v57
    v_max3_f32 v112, v112, v58, v59
    v_max3_f32 v113, v113, v60, v61
    v_max3_f32 v112, v112, v62, v63
    v_max_f32 v112, v112, v113
    v_mul_f32 v114, 0xbfb8aa3b, v112
    v_pk_fma_f32 v[48:49], v[48:49], s[84:85], v[114:115] op_sel_hi:[1,0,0]
    v_pk_fma_f32 v[50:51], v[50:51], s[84:85], v[114:115] op_sel_hi:[1,0,0]
    v_exp_f32 v48, v48
    v_exp_f32 v49, v49
    v_pk_fma_f32 v[52:53], v[52:53], s[84:85], v[114:115] op_sel_hi:[1,0,0]
    v_exp_f32 v50, v50
    v_exp_f32 v51, v51
    v_pk_fma_f32 v[54:55], v[54:55], s[84:85], v[114:115] op_sel_hi:[1,0,0]
    v_exp_f32 v52, v52
    v_exp_f32 v53, v53
    v_pk_fma_f32 v[56:57], v[56:57], s[84:85], v[114:115] op_sel_hi:[1,0,0]
    v_exp_f32 v54, v54
    v_exp_f32 v55, v55
    v_pk_fma_f32 v[58:59], v[58:59], s[84:85], v[114:115] op_sel_hi:[1,0,0]
    v_exp_f32 v56, v56
    v_exp_f32 v57, v57
    v_pk_fma_f32 v[60:61], v[60:61], s[84:85], v[114:115] op_sel_hi:[1,0,0]
    v_exp_f32 v58, v58
    v_exp_f32 v59, v59
    v_pk_fma_f32 v[62:63], v[62:63], s[84:85], v[114:115] op_sel_hi:[1,0,0]
    v_exp_f32 v60, v60
    v_exp_f32 v61, v61
    v_exp_f32 v62, v62
    v_exp_f32 v63, v63
    v_pk_add_f32 v[116:117], v[48:49], v[50:51]
    v_pk_add_f32 v[118:119], v[52:53], v[54:55]
    v_pk_add_f32 v[116:117], v[116:117], v[56:57]
    v_pk_add_f32 v[118:119], v[118:119], v[58:59]
    v_pk_add_f32 v[116:117], v[116:117], v[60:61]
    v_pk_add_f32 v[118:119], v[118:119], v[62:63]
    v_pk_add_f32 v[116:117], v[116:117], v[118:119]
    v_add_f32 v116, v116, v117
    v_rcp_f32 v114, v116
    s_nop 0
    v_pk_mul_f32 v[48:49], v[48:49], v[114:115] op_sel_hi:[1,0]
    v_pk_mul_f32 v[50:51], v[50:51], v[114:115] op_sel_hi:[1,0]
    v_cvt_pk_bf16_f32 v48, v48, v49
    v_pk_mul_f32 v[52:53], v[52:53], v[114:115] op_sel_hi:[1,0]
    v_cvt_pk_bf16_f32 v49, v50, v51
    v_pk_mul_f32 v[54:55], v[54:55], v[114:115] op_sel_hi:[1,0]
    v_cvt_pk_bf16_f32 v50, v52, v53
    v_pk_mul_f32 v[56:57], v[56:57], v[114:115] op_sel_hi:[1,0]
    v_cvt_pk_bf16_f32 v51, v54, v55
    v_pk_mul_f32 v[58:59], v[58:59], v[114:115] op_sel_hi:[1,0]
    v_cvt_pk_bf16_f32 v52, v56, v57
    ds_write_b128 v22, v[48:51] offset:24576
    v_pk_mul_f32 v[60:61], v[60:61], v[114:115] op_sel_hi:[1,0]
    v_cvt_pk_bf16_f32 v53, v58, v59
    v_pk_mul_f32 v[62:63], v[62:63], v[114:115] op_sel_hi:[1,0]
    v_cvt_pk_bf16_f32 v54, v60, v61
    v_cvt_pk_bf16_f32 v55, v62, v63
    ds_write_b128 v23, v[52:55] offset:24576
    s_waitcnt lgkmcnt(0)
    s_barrier
    s_setprio 2
    ds_read_b64_tr_b16 v[64:65], v16 offset:0
    ds_read_b64_tr_b16 v[66:67], v16 offset:512
    ds_read_b64_tr_b16 v[68:69], v17 offset:0
    ds_read_b64_tr_b16 v[70:71], v17 offset:512
    ds_read_b64_tr_b16 v[72:73], v16 offset:4096
    ds_read_b64_tr_b16 v[74:75], v16 offset:4608
    ds_read_b64_tr_b16 v[76:77], v17 offset:4096
    ds_read_b64_tr_b16 v[78:79], v17 offset:4608
    s_waitcnt lgkmcnt(4)
    v_mfma_f32_16x16x32_bf16 v[32:35], v[64:67], v[128:131], 0
    ds_read_b64_tr_b16 v[80:81], v16 offset:8192
    v_mfma_f32_16x16x32_bf16 v[36:39], v[64:67], v[132:135], 0
    ds_read_b64_tr_b16 v[82:83], v16 offset:8704
    v_mfma_f32_16x16x32_bf16 v[40:43], v[68:71], v[128:131], 0
    ds_read_b64_tr_b16 v[84:85], v17 offset:8192
    v_mfma_f32_16x16x32_bf16 v[44:47], v[68:71], v[132:135], 0
    ds_read_b64_tr_b16 v[86:87], v17 offset:8704
    s_waitcnt lgkmcnt(4)
    v_mfma_f32_16x16x32_bf16 v[32:35], v[72:75], v[136:139], v[32:35]
    ds_read_b64_tr_b16 v[64:65], v16 offset:12288
    v_mfma_f32_16x16x32_bf16 v[36:39], v[72:75], v[140:143], v[36:39]
    ds_read_b64_tr_b16 v[66:67], v16 offset:12800
    v_mfma_f32_16x16x32_bf16 v[40:43], v[76:79], v[136:139], v[40:43]
    ds_read_b64_tr_b16 v[68:69], v17 offset:12288
    v_mfma_f32_16x16x32_bf16 v[44:47], v[76:79], v[140:143], v[44:47]
    ds_read_b64_tr_b16 v[70:71], v17 offset:12800
    s_waitcnt lgkmcnt(4)
    v_mfma_f32_16x16x32_bf16 v[32:35], v[80:83], v[144:147], v[32:35]
    ds_read_b64_tr_b16 v[72:73], v16 offset:16384
    v_mfma_f32_16x16x32_bf16 v[36:39], v[80:83], v[148:151], v[36:39]
    ds_read_b64_tr_b16 v[74:75], v16 offset:16896
    v_mfma_f32_16x16x32_bf16 v[40:43], v[84:87], v[144:147], v[40:43]
    ds_read_b64_tr_b16 v[76:77], v17 offset:16384
    v_mfma_f32_16x16x32_bf16 v[44:47], v[84:87], v[148:151], v[44:47]
    ds_read_b64_tr_b16 v[78:79], v17 offset:16896
    s_waitcnt lgkmcnt(4)
    v_mfma_f32_16x16x32_bf16 v[32:35], v[64:67], v[152:155], v[32:35]
    ds_read_b64_tr_b16 v[80:81], v16 offset:20480
    v_mfma_f32_16x16x32_bf16 v[36:39], v[64:67], v[156:159], v[36:39]
    ds_read_b64_tr_b16 v[82:83], v16 offset:20992
    v_mfma_f32_16x16x32_bf16 v[40:43], v[68:71], v[152:155], v[40:43]
    ds_read_b64_tr_b16 v[84:85], v17 offset:20480
    v_mfma_f32_16x16x32_bf16 v[44:47], v[68:71], v[156:159], v[44:47]
    ds_read_b64_tr_b16 v[86:87], v17 offset:20992
    s_waitcnt lgkmcnt(4)
    v_mfma_f32_16x16x32_bf16 v[32:35], v[72:75], v[160:163], v[32:35]
    ds_read_b64_tr_b16 v[64:65], v8 offset:49152
    v_mfma_f32_16x16x32_bf16 v[36:39], v[72:75], v[164:167], v[36:39]
    ds_read_b64_tr_b16 v[66:67], v8 offset:49664
    v_mfma_f32_16x16x32_bf16 v[40:43], v[76:79], v[160:163], v[40:43]
    ds_read_b64_tr_b16 v[68:69], v9 offset:49152
    v_mfma_f32_16x16x32_bf16 v[44:47], v[76:79], v[164:167], v[44:47]
    ds_read_b64_tr_b16 v[70:71], v9 offset:49664
    s_waitcnt lgkmcnt(4)
    v_mfma_f32_16x16x32_bf16 v[32:35], v[80:83], v[168:171], v[32:35]
    ds_read_b64_tr_b16 v[72:73], v8 offset:53248
    v_mfma_f32_16x16x32_bf16 v[36:39], v[80:83], v[172:175], v[36:39]
    ds_read_b64_tr_b16 v[74:75], v8 offset:53760
    v_mfma_f32_16x16x32_bf16 v[40:43], v[84:87], v[168:171], v[40:43]
    ds_read_b64_tr_b16 v[76:77], v9 offset:53248
    v_mfma_f32_16x16x32_bf16 v[44:47], v[84:87], v[172:175], v[44:47]
    ds_read_b64_tr_b16 v[78:79], v9 offset:53760
    s_waitcnt lgkmcnt(4)
    v_mfma_f32_16x16x32_bf16 v[32:35], v[64:67], v[176:179], v[32:35]
    ds_read_b64_tr_b16 v[80:81], v8 offset:57344
    v_mfma_f32_16x16x32_bf16 v[36:39], v[64:67], v[180:183], v[36:39]
    ds_read_b64_tr_b16 v[82:83], v8 offset:57856
    v_mfma_f32_16x16x32_bf16 v[40:43], v[68:71], v[176:179], v[40:43]
    ds_read_b64_tr_b16 v[84:85], v9 offset:57344
    v_mfma_f32_16x16x32_bf16 v[44:47], v[68:71], v[180:183], v[44:47]
    ds_read_b64_tr_b16 v[86:87], v9 offset:57856
    s_waitcnt lgkmcnt(4)
    v_mfma_f32_16x16x32_bf16 v[32:35], v[72:75], v[184:187], v[32:35]
    ds_read_b64_tr_b16 v[64:65], v8 offset:61440
    v_mfma_f32_16x16x32_bf16 v[36:39], v[72:75], v[188:191], v[36:39]
    ds_read_b64_tr_b16 v[66:67], v8 offset:61952
    v_mfma_f32_16x16x32_bf16 v[40:43], v[76:79], v[184:187], v[40:43]
    ds_read_b64_tr_b16 v[68:69], v9 offset:61440
    v_mfma_f32_16x16x32_bf16 v[44:47], v[76:79], v[188:191], v[44:47]
    ds_read_b64_tr_b16 v[70:71], v9 offset:61952
    s_waitcnt lgkmcnt(4)
    v_mfma_f32_16x16x32_bf16 v[32:35], v[80:83], v[192:195], v[32:35]
    ds_read_b64_tr_b16 v[72:73], v12 offset:40960
    v_mfma_f32_16x16x32_bf16 v[36:39], v[80:83], v[196:199], v[36:39]
    ds_read_b64_tr_b16 v[74:75], v12 offset:41472
    v_mfma_f32_16x16x32_bf16 v[40:43], v[84:87], v[192:195], v[40:43]
    ds_read_b64_tr_b16 v[76:77], v13 offset:40960
    v_mfma_f32_16x16x32_bf16 v[44:47], v[84:87], v[196:199], v[44:47]
    ds_read_b64_tr_b16 v[78:79], v13 offset:41472
    s_waitcnt lgkmcnt(4)
    v_mfma_f32_16x16x32_bf16 v[32:35], v[64:67], v[200:203], v[32:35]
    ds_read_b64_tr_b16 v[80:81], v12 offset:45056
    v_mfma_f32_16x16x32_bf16 v[36:39], v[64:67], v[204:207], v[36:39]
    ds_read_b64_tr_b16 v[82:83], v12 offset:45568
    v_mfma_f32_16x16x32_bf16 v[40:43], v[68:71], v[200:203], v[40:43]
    ds_read_b64_tr_b16 v[84:85], v13 offset:45056
    v_mfma_f32_16x16x32_bf16 v[44:47], v[68:71], v[204:207], v[44:47]
    ds_read_b64_tr_b16 v[86:87], v13 offset:45568
    s_waitcnt lgkmcnt(4)
    v_mfma_f32_16x16x32_bf16 v[32:35], v[72:75], v[208:211], v[32:35]
    ds_read_b64_tr_b16 v[64:65], v12 offset:49152
    v_xor_b32 v96, v27, v96
    v_mfma_f32_16x16x32_bf16 v[36:39], v[72:75], v[212:215], v[36:39]
    ds_read_b64_tr_b16 v[66:67], v12 offset:49664
    v_xor_b32 v97, v27, v97
    v_mfma_f32_16x16x32_bf16 v[40:43], v[76:79], v[208:211], v[40:43]
    ds_read_b64_tr_b16 v[68:69], v13 offset:49152
    v_xor_b32 v98, v27, v98
    v_mfma_f32_16x16x32_bf16 v[44:47], v[76:79], v[212:215], v[44:47]
    ds_read_b64_tr_b16 v[70:71], v13 offset:49664
    v_xor_b32 v99, v27, v99
    s_waitcnt lgkmcnt(4)
    v_mfma_f32_16x16x32_bf16 v[32:35], v[80:83], v[216:219], v[32:35]
    ds_read_b64_tr_b16 v[72:73], v12 offset:53248
    v_xor_b32 v100, v27, v100
    v_mfma_f32_16x16x32_bf16 v[36:39], v[80:83], v[220:223], v[36:39]
    ds_read_b64_tr_b16 v[74:75], v12 offset:53760
    v_xor_b32 v101, v27, v101
    v_mfma_f32_16x16x32_bf16 v[40:43], v[84:87], v[216:219], v[40:43]
    ds_read_b64_tr_b16 v[76:77], v13 offset:53248
    v_xor_b32 v102, v27, v102
    v_mfma_f32_16x16x32_bf16 v[44:47], v[84:87], v[220:223], v[44:47]
    ds_read_b64_tr_b16 v[78:79], v13 offset:53760
    v_xor_b32 v103, v27, v103
    s_waitcnt lgkmcnt(4)
    v_mfma_f32_16x16x32_bf16 v[32:35], v[64:67], v[224:227], v[32:35]
    ds_read_b64_tr_b16 v[80:81], v12 offset:57344
    v_mfma_f32_16x16x32_bf16 v[36:39], v[64:67], v[228:231], v[36:39]
    ds_read_b64_tr_b16 v[82:83], v12 offset:57856
    v_mfma_f32_16x16x32_bf16 v[40:43], v[68:71], v[224:227], v[40:43]
    ds_read_b64_tr_b16 v[84:85], v13 offset:57344
    v_mfma_f32_16x16x32_bf16 v[44:47], v[68:71], v[228:231], v[44:47]
    ds_read_b64_tr_b16 v[86:87], v13 offset:57856
    s_waitcnt lgkmcnt(4)
    v_mfma_f32_16x16x32_bf16 v[32:35], v[72:75], v[232:235], v[32:35]
    ds_read_b64_tr_b16 v[64:65], v12 offset:61440
    v_mfma_f32_16x16x32_bf16 v[36:39], v[72:75], v[236:239], v[36:39]
    ds_read_b64_tr_b16 v[66:67], v12 offset:61952
    v_mfma_f32_16x16x32_bf16 v[40:43], v[76:79], v[232:235], v[40:43]
    ds_read_b64_tr_b16 v[68:69], v13 offset:61440
    v_mfma_f32_16x16x32_bf16 v[44:47], v[76:79], v[236:239], v[44:47]
    ds_read_b64_tr_b16 v[70:71], v13 offset:61952
    s_waitcnt lgkmcnt(4)
    v_mfma_f32_16x16x32_bf16 v[32:35], v[80:83], v[240:243], v[32:35]
    ds_read_b64_tr_b16 v[72:73], v18 offset:0
    v_mfma_f32_16x16x32_bf16 v[36:39], v[80:83], v[244:247], v[36:39]
    ds_read_b64_tr_b16 v[74:75], v18 offset:512
    v_mfma_f32_16x16x32_bf16 v[40:43], v[84:87], v[240:243], v[40:43]
    ds_read_b64_tr_b16 v[76:77], v19 offset:0
    v_mfma_f32_16x16x32_bf16 v[44:47], v[84:87], v[244:247], v[44:47]
    ds_read_b64_tr_b16 v[78:79], v19 offset:512
    s_waitcnt lgkmcnt(4)
    v_mfma_f32_16x16x32_bf16 v[32:35], v[64:67], v[248:251], v[32:35]
    ds_read_b64_tr_b16 v[80:81], v18 offset:4096
    v_mfma_f32_16x16x32_bf16 v[36:39], v[64:67], v[252:255], v[36:39]
    ds_read_b64_tr_b16 v[82:83], v18 offset:4608
    v_mfma_f32_16x16x32_bf16 v[40:43], v[68:71], v[248:251], v[40:43]
    ds_read_b64_tr_b16 v[84:85], v19 offset:4096
    v_mfma_f32_16x16x32_bf16 v[44:47], v[68:71], v[252:255], v[44:47]
    ds_read_b64_tr_b16 v[86:87], v19 offset:4608
    s_waitcnt lgkmcnt(4)
    v_mfma_f32_16x16x32_bf16 v[48:51], v[72:75], v[128:131], 0
    ds_read_b64_tr_b16 v[64:65], v18 offset:8192
    v_mfma_f32_16x16x32_bf16 v[52:55], v[72:75], v[132:135], 0
    ds_read_b64_tr_b16 v[66:67], v18 offset:8704
    v_mfma_f32_16x16x32_bf16 v[56:59], v[76:79], v[128:131], 0
    ds_read_b64_tr_b16 v[68:69], v19 offset:8192
    v_mfma_f32_16x16x32_bf16 v[60:63], v[76:79], v[132:135], 0
    ds_read_b64_tr_b16 v[70:71], v19 offset:8704
    s_waitcnt lgkmcnt(4)
    v_mfma_f32_16x16x32_bf16 v[48:51], v[80:83], v[136:139], v[48:51]
    ds_read_b64_tr_b16 v[72:73], v18 offset:12288
    v_cvt_pk_bf16_f32 v112, v32, v33
    v_mfma_f32_16x16x32_bf16 v[52:55], v[80:83], v[140:143], v[52:55]
    ds_read_b64_tr_b16 v[74:75], v18 offset:12800
    v_cvt_pk_bf16_f32 v113, v34, v35
    v_mfma_f32_16x16x32_bf16 v[56:59], v[84:87], v[136:139], v[56:59]
    ds_read_b64_tr_b16 v[76:77], v19 offset:12288
    v_cvt_pk_bf16_f32 v114, v36, v37
    v_mfma_f32_16x16x32_bf16 v[60:63], v[84:87], v[140:143], v[60:63]
    ds_read_b64_tr_b16 v[78:79], v19 offset:12800
    v_cvt_pk_bf16_f32 v115, v38, v39
    s_waitcnt lgkmcnt(4)
    v_mfma_f32_16x16x32_bf16 v[48:51], v[64:67], v[144:147], v[48:51]
    ds_read_b64_tr_b16 v[80:81], v18 offset:16384
    v_cvt_pk_bf16_f32 v116, v40, v41
    v_mfma_f32_16x16x32_bf16 v[52:55], v[64:67], v[148:151], v[52:55]
    ds_read_b64_tr_b16 v[82:83], v18 offset:16896
    v_cvt_pk_bf16_f32 v117, v42, v43
    v_mfma_f32_16x16x32_bf16 v[56:59], v[68:71], v[144:147], v[56:59]
    ds_read_b64_tr_b16 v[84:85], v19 offset:16384
    v_cvt_pk_bf16_f32 v118, v44, v45
    v_mfma_f32_16x16x32_bf16 v[60:63], v[68:71], v[148:151], v[60:63]
    ds_read_b64_tr_b16 v[86:87], v19 offset:16896
    v_cvt_pk_bf16_f32 v119, v46, v47
    s_waitcnt lgkmcnt(4)
    v_mfma_f32_16x16x32_bf16 v[48:51], v[72:75], v[152:155], v[48:51]
    ds_read_b64_tr_b16 v[64:65], v18 offset:20480
    v_permlane16_swap_b32 v112, v114
    v_mfma_f32_16x16x32_bf16 v[52:55], v[72:75], v[156:159], v[52:55]
    ds_read_b64_tr_b16 v[66:67], v18 offset:20992
    v_permlane16_swap_b32 v113, v115
    v_mfma_f32_16x16x32_bf16 v[56:59], v[76:79], v[152:155], v[56:59]
    ds_read_b64_tr_b16 v[68:69], v19 offset:20480
    v_permlane16_swap_b32 v116, v118
    v_mfma_f32_16x16x32_bf16 v[60:63], v[76:79], v[156:159], v[60:63]
    ds_read_b64_tr_b16 v[70:71], v19 offset:20992
    v_permlane16_swap_b32 v117, v119
    s_waitcnt lgkmcnt(4)
    v_mfma_f32_16x16x32_bf16 v[48:51], v[80:83], v[160:163], v[48:51]
    ds_read_b64_tr_b16 v[72:73], v10 offset:49152
    v_mfma_f32_32x32x16_bf16 v[32:47], v[96:99], v[112:115], 0
    v_mfma_f32_16x16x32_bf16 v[52:55], v[80:83], v[164:167], v[52:55]
    ds_read_b64_tr_b16 v[74:75], v10 offset:49664
    v_mfma_f32_16x16x32_bf16 v[56:59], v[84:87], v[160:163], v[56:59]
    ds_read_b64_tr_b16 v[76:77], v11 offset:49152
    v_mfma_f32_16x16x32_bf16 v[60:63], v[84:87], v[164:167], v[60:63]
    ds_read_b64_tr_b16 v[78:79], v11 offset:49664
    s_waitcnt lgkmcnt(4)
    v_mfma_f32_16x16x32_bf16 v[48:51], v[64:67], v[168:171], v[48:51]
    ds_read_b64_tr_b16 v[80:81], v10 offset:53248
    v_mfma_f32_16x16x32_bf16 v[52:55], v[64:67], v[172:175], v[52:55]
    ds_read_b64_tr_b16 v[82:83], v10 offset:53760
    v_mfma_f32_32x32x16_bf16 v[128:143], v[100:103], v[116:119], 0
    v_mfma_f32_16x16x32_bf16 v[56:59], v[68:71], v[168:171], v[56:59]
    ds_read_b64_tr_b16 v[84:85], v11 offset:53248
    v_max3_f32 v88, v32, v33, v34
    v_mfma_f32_16x16x32_bf16 v[60:63], v[68:71], v[172:175], v[60:63]
    ds_read_b64_tr_b16 v[86:87], v11 offset:53760
    s_waitcnt lgkmcnt(4)
    v_mfma_f32_16x16x32_bf16 v[48:51], v[72:75], v[176:179], v[48:51]
    ds_read_b64_tr_b16 v[64:65], v10 offset:57344
    v_max3_f32 v89, v35, v36, v37
    v_mfma_f32_16x16x32_bf16 v[52:55], v[72:75], v[180:183], v[52:55]
    ds_read_b64_tr_b16 v[66:67], v10 offset:57856
    v_max3_f32 v88, v88, v38, v39
    v_mfma_f32_16x16x32_bf16 v[56:59], v[76:79], v[176:179], v[56:59]
    ds_read_b64_tr_b16 v[68:69], v11 offset:57344
    v_max3_f32 v89, v89, v40, v41
    v_mfma_f32_16x16x32_bf16 v[60:63], v[76:79], v[180:183], v[60:63]
    ds_read_b64_tr_b16 v[70:71], v11 offset:57856
    s_waitcnt lgkmcnt(4)
    v_mfma_f32_16x16x32_bf16 v[48:51], v[80:83], v[184:187], v[48:51]
    ds_read_b64_tr_b16 v[72:73], v10 offset:61440
    v_max3_f32 v88, v88, v42, v43
    v_mfma_f32_16x16x32_bf16 v[52:55], v[80:83], v[188:191], v[52:55]
    ds_read_b64_tr_b16 v[74:75], v10 offset:61952
    v_max3_f32 v89, v89, v44, v45
    v_mfma_f32_16x16x32_bf16 v[56:59], v[84:87], v[184:187], v[56:59]
    ds_read_b64_tr_b16 v[76:77], v11 offset:61440
    v_max3_f32 v88, v88, v46, v47
    v_mfma_f32_16x16x32_bf16 v[60:63], v[84:87], v[188:191], v[60:63]
    ds_read_b64_tr_b16 v[78:79], v11 offset:61952
    s_waitcnt lgkmcnt(4)
    v_mfma_f32_16x16x32_bf16 v[48:51], v[64:67], v[192:195], v[48:51]
    ds_read_b64_tr_b16 v[80:81], v14 offset:40960
    v_max_f32 v88, v88, v89
    v_mfma_f32_16x16x32_bf16 v[52:55], v[64:67], v[196:199], v[52:55]
    ds_read_b64_tr_b16 v[82:83], v14 offset:41472
    v_mul_f32 v90, 0xbfb8aa3b, v88
    v_mfma_f32_16x16x32_bf16 v[56:59], v[68:71], v[192:195], v[56:59]
    ds_read_b64_tr_b16 v[84:85], v15 offset:40960
    v_fmamk_f32 v32, v32, 0x3fb8aa3b, v90
    v_mfma_f32_16x16x32_bf16 v[60:63], v[68:71], v[196:199], v[60:63]
    ds_read_b64_tr_b16 v[86:87], v15 offset:41472
    s_waitcnt lgkmcnt(4)
    v_mfma_f32_16x16x32_bf16 v[48:51], v[72:75], v[200:203], v[48:51]
    ds_read_b64_tr_b16 v[64:65], v14 offset:45056
    v_fmamk_f32 v33, v33, 0x3fb8aa3b, v90
    v_mfma_f32_16x16x32_bf16 v[52:55], v[72:75], v[204:207], v[52:55]
    ds_read_b64_tr_b16 v[66:67], v14 offset:45568
    v_exp_f32 v32, v32
    v_mfma_f32_16x16x32_bf16 v[56:59], v[76:79], v[200:203], v[56:59]
    ds_read_b64_tr_b16 v[68:69], v15 offset:45056
    v_fmamk_f32 v34, v34, 0x3fb8aa3b, v90
    v_mfma_f32_16x16x32_bf16 v[60:63], v[76:79], v[204:207], v[60:63]
    ds_read_b64_tr_b16 v[70:71], v15 offset:45568
    s_waitcnt lgkmcnt(4)
    v_mfma_f32_16x16x32_bf16 v[48:51], v[80:83], v[208:211], v[48:51]
    ds_read_b64_tr_b16 v[72:73], v14 offset:49152
    v_exp_f32 v33, v33
    v_mfma_f32_16x16x32_bf16 v[52:55], v[80:83], v[212:215], v[52:55]
    ds_read_b64_tr_b16 v[74:75], v14 offset:49664
    v_fmamk_f32 v35, v35, 0x3fb8aa3b, v90
    v_mfma_f32_16x16x32_bf16 v[56:59], v[84:87], v[208:211], v[56:59]
    ds_read_b64_tr_b16 v[76:77], v15 offset:49152
    v_exp_f32 v34, v34
    v_mfma_f32_16x16x32_bf16 v[60:63], v[84:87], v[212:215], v[60:63]
    ds_read_b64_tr_b16 v[78:79], v15 offset:49664
    s_waitcnt lgkmcnt(4)
    v_mfma_f32_16x16x32_bf16 v[48:51], v[64:67], v[216:219], v[48:51]
    ds_read_b64_tr_b16 v[80:81], v14 offset:53248
    v_fmamk_f32 v36, v36, 0x3fb8aa3b, v90
    v_mfma_f32_16x16x32_bf16 v[52:55], v[64:67], v[220:223], v[52:55]
    ds_read_b64_tr_b16 v[82:83], v14 offset:53760
    v_exp_f32 v35, v35
    v_mfma_f32_16x16x32_bf16 v[56:59], v[68:71], v[216:219], v[56:59]
    ds_read_b64_tr_b16 v[84:85], v15 offset:53248
    v_fmamk_f32 v37, v37, 0x3fb8aa3b, v90
    v_mfma_f32_16x16x32_bf16 v[60:63], v[68:71], v[220:223], v[60:63]
    ds_read_b64_tr_b16 v[86:87], v15 offset:53760
    s_waitcnt lgkmcnt(4)
    v_mfma_f32_16x16x32_bf16 v[48:51], v[72:75], v[224:227], v[48:51]
    ds_read_b64_tr_b16 v[64:65], v14 offset:57344
    v_exp_f32 v36, v36
    v_mfma_f32_16x16x32_bf16 v[52:55], v[72:75], v[228:231], v[52:55]
    ds_read_b64_tr_b16 v[66:67], v14 offset:57856
    v_fmamk_f32 v38, v38, 0x3fb8aa3b, v90
    v_mfma_f32_16x16x32_bf16 v[56:59], v[76:79], v[224:227], v[56:59]
    ds_read_b64_tr_b16 v[68:69], v15 offset:57344
    v_exp_f32 v37, v37
    v_mfma_f32_16x16x32_bf16 v[60:63], v[76:79], v[228:231], v[60:63]
    ds_read_b64_tr_b16 v[70:71], v15 offset:57856
    s_waitcnt lgkmcnt(4)
    v_mfma_f32_16x16x32_bf16 v[48:51], v[80:83], v[232:235], v[48:51]
    ds_read_b64_tr_b16 v[72:73], v14 offset:61440
    v_fmamk_f32 v39, v39, 0x3fb8aa3b, v90
    v_mfma_f32_16x16x32_bf16 v[52:55], v[80:83], v[236:239], v[52:55]
    ds_read_b64_tr_b16 v[74:75], v14 offset:61952
    v_exp_f32 v38, v38
    v_mfma_f32_16x16x32_bf16 v[56:59], v[84:87], v[232:235], v[56:59]
    ds_read_b64_tr_b16 v[76:77], v15 offset:61440
    v_fmamk_f32 v40, v40, 0x3fb8aa3b, v90
    v_mfma_f32_16x16x32_bf16 v[60:63], v[84:87], v[236:239], v[60:63]
    ds_read_b64_tr_b16 v[78:79], v15 offset:61952
    s_waitcnt lgkmcnt(4)
    v_mfma_f32_16x16x32_bf16 v[48:51], v[64:67], v[240:243], v[48:51]
    v_exp_f32 v39, v39
    v_fmamk_f32 v41, v41, 0x3fb8aa3b, v90
    v_mfma_f32_16x16x32_bf16 v[52:55], v[64:67], v[244:247], v[52:55]
    v_exp_f32 v40, v40
    v_fmamk_f32 v42, v42, 0x3fb8aa3b, v90
    v_mfma_f32_16x16x32_bf16 v[56:59], v[68:71], v[240:243], v[56:59]
    v_exp_f32 v41, v41
    v_fmamk_f32 v43, v43, 0x3fb8aa3b, v90
    v_mfma_f32_16x16x32_bf16 v[60:63], v[68:71], v[244:247], v[60:63]
    s_waitcnt lgkmcnt(0)
    v_mfma_f32_16x16x32_bf16 v[48:51], v[72:75], v[248:251], v[48:51]
    v_exp_f32 v42, v42
    v_fmamk_f32 v44, v44, 0x3fb8aa3b, v90
    v_mfma_f32_16x16x32_bf16 v[52:55], v[72:75], v[252:255], v[52:55]
    v_exp_f32 v43, v43
    v_fmamk_f32 v45, v45, 0x3fb8aa3b, v90
    v_mfma_f32_16x16x32_bf16 v[56:59], v[76:79], v[248:251], v[56:59]
    v_exp_f32 v44, v44
    v_fmamk_f32 v46, v46, 0x3fb8aa3b, v90
    v_mfma_f32_16x16x32_bf16 v[60:63], v[76:79], v[252:255], v[60:63]
    s_waitcnt vmcnt(0)
    s_barrier
    v_exp_f32 v45, v45
    v_fmamk_f32 v47, v47, 0x3fb8aa3b, v90
    v_exp_f32 v46, v46
    v_exp_f32 v47, v47
    v_add_f32 v92, v32, v36
    v_add_f32 v93, v33, v37
    v_add_f32 v94, v34, v38
    v_add_f32 v95, v35, v39
    v_add_f32 v92, v92, v40
    v_add_f32 v93, v93, v41
    v_add_f32 v94, v94, v42
    v_add_f32 v95, v95, v43
    v_cvt_pk_bf16_f32 v120, v48, v49
    v_cvt_pk_bf16_f32 v121, v50, v51
    v_cvt_pk_bf16_f32 v122, v52, v53
    v_cvt_pk_bf16_f32 v123, v54, v55
    v_cvt_pk_bf16_f32 v124, v56, v57
    v_cvt_pk_bf16_f32 v125, v58, v59
    v_cvt_pk_bf16_f32 v126, v60, v61
    v_cvt_pk_bf16_f32 v127, v62, v63
    v_permlane16_swap_b32 v120, v122
    v_permlane16_swap_b32 v121, v123
    v_permlane16_swap_b32 v124, v126
    v_permlane16_swap_b32 v125, v127
    v_mfma_f32_32x32x16_bf16 v[144:159], v[104:107], v[120:123], 0
    s_nop 0
    v_mfma_f32_32x32x16_bf16 v[160:175], v[108:111], v[124:127], 0
    v_add_f32 v92, v92, v44
    v_add_f32 v93, v93, v45
    v_add_f32 v94, v94, v46
    v_add_f32 v95, v95, v47
    v_add_f32 v92, v92, v93
    v_add_f32 v94, v94, v95
    v_add_f32 v92, v92, v94
    v_rcp_f32 v90, v92
    s_nop 0
    v_mul_f32 v32, v32, v90
    v_mul_f32 v33, v33, v90
    v_mul_f32 v34, v34, v90
    v_mul_f32 v35, v35, v90
    v_cvt_pk_bf16_f32 v32, v32, v33
    v_mul_f32 v36, v36, v90
    v_mul_f32 v37, v37, v90
    v_cvt_pk_bf16_f32 v33, v34, v35
    v_mul_f32 v38, v38, v90
    v_mul_f32 v39, v39, v90
    v_cvt_pk_bf16_f32 v34, v36, v37
    v_mul_f32 v40, v40, v90
    v_mul_f32 v41, v41, v90
    v_cvt_pk_bf16_f32 v35, v38, v39
    v_mul_f32 v42, v42, v90
    v_mul_f32 v43, v43, v90
    v_cvt_pk_bf16_f32 v36, v40, v41
    v_mul_f32 v44, v44, v90
    v_mul_f32 v45, v45, v90
    v_cvt_pk_bf16_f32 v37, v42, v43
    v_mul_f32 v46, v46, v90
    v_mul_f32 v47, v47, v90
    v_cvt_pk_bf16_f32 v38, v44, v45
    v_cvt_pk_bf16_f32 v39, v46, v47
    v_max3_f32 v88, v128, v129, v130
    v_max3_f32 v89, v131, v132, v133
    v_max3_f32 v88, v88, v134, v135
    v_max3_f32 v89, v89, v136, v137
    v_max3_f32 v88, v88, v138, v139
    v_max3_f32 v89, v89, v140, v141
    v_max3_f32 v88, v88, v142, v143
    v_max_f32 v88, v88, v89
    v_mul_f32 v90, 0xbfb8aa3b, v88
    v_pk_fma_f32 v[128:129], v[128:129], s[84:85], v[90:91] op_sel_hi:[1,0,0]
    v_pk_fma_f32 v[130:131], v[130:131], s[84:85], v[90:91] op_sel_hi:[1,0,0]
    v_exp_f32 v128, v128
    v_exp_f32 v129, v129
    v_pk_fma_f32 v[132:133], v[132:133], s[84:85], v[90:91] op_sel_hi:[1,0,0]
    v_exp_f32 v130, v130
    v_exp_f32 v131, v131
    v_pk_fma_f32 v[134:135], v[134:135], s[84:85], v[90:91] op_sel_hi:[1,0,0]
    v_exp_f32 v132, v132
    v_exp_f32 v133, v133
    v_pk_fma_f32 v[136:137], v[136:137], s[84:85], v[90:91] op_sel_hi:[1,0,0]
    v_exp_f32 v134, v134
    v_exp_f32 v135, v135
    v_pk_fma_f32 v[138:139], v[138:139], s[84:85], v[90:91] op_sel_hi:[1,0,0]
    v_exp_f32 v136, v136
    v_exp_f32 v137, v137
    v_pk_fma_f32 v[140:141], v[140:141], s[84:85], v[90:91] op_sel_hi:[1,0,0]
    v_exp_f32 v138, v138
    v_exp_f32 v139, v139
    v_pk_fma_f32 v[142:143], v[142:143], s[84:85], v[90:91] op_sel_hi:[1,0,0]
    v_exp_f32 v140, v140
    v_exp_f32 v141, v141
    v_exp_f32 v142, v142
    v_exp_f32 v143, v143
    v_pk_add_f32 v[92:93], v[128:129], v[130:131]
    v_pk_add_f32 v[94:95], v[132:133], v[134:135]
    v_pk_add_f32 v[92:93], v[92:93], v[136:137]
    v_pk_add_f32 v[94:95], v[94:95], v[138:139]
    v_pk_add_f32 v[92:93], v[92:93], v[140:141]
    v_pk_add_f32 v[94:95], v[94:95], v[142:143]
    v_pk_add_f32 v[92:93], v[92:93], v[94:95]
    v_add_f32 v92, v92, v93
    v_rcp_f32 v90, v92
    s_nop 0
    v_pk_mul_f32 v[128:129], v[128:129], v[90:91] op_sel_hi:[1,0]
    v_pk_mul_f32 v[130:131], v[130:131], v[90:91] op_sel_hi:[1,0]
    v_cvt_pk_bf16_f32 v128, v128, v129
    v_pk_mul_f32 v[132:133], v[132:133], v[90:91] op_sel_hi:[1,0]
    v_cvt_pk_bf16_f32 v129, v130, v131
    v_pk_mul_f32 v[134:135], v[134:135], v[90:91] op_sel_hi:[1,0]
    v_cvt_pk_bf16_f32 v130, v132, v133
    v_pk_mul_f32 v[136:137], v[136:137], v[90:91] op_sel_hi:[1,0]
    v_cvt_pk_bf16_f32 v131, v134, v135
    v_pk_mul_f32 v[138:139], v[138:139], v[90:91] op_sel_hi:[1,0]
    v_cvt_pk_bf16_f32 v132, v136, v137
    v_pk_mul_f32 v[140:141], v[140:141], v[90:91] op_sel_hi:[1,0]
    v_cvt_pk_bf16_f32 v133, v138, v139
    v_pk_mul_f32 v[142:143], v[142:143], v[90:91] op_sel_hi:[1,0]
    v_cvt_pk_bf16_f32 v134, v140, v141
    v_cvt_pk_bf16_f32 v135, v142, v143
    v_max3_f32 v88, v144, v145, v146
    v_max3_f32 v80, v160, v161, v162
    v_max3_f32 v89, v147, v148, v149
    v_max3_f32 v81, v163, v164, v165
    v_max3_f32 v88, v88, v150, v151
    v_max3_f32 v80, v80, v166, v167
    v_max3_f32 v89, v89, v152, v153
    v_max3_f32 v81, v81, v168, v169
    v_max3_f32 v88, v88, v154, v155
    v_max3_f32 v80, v80, v170, v171
    v_max3_f32 v89, v89, v156, v157
    v_max3_f32 v81, v81, v172, v173
    v_max3_f32 v88, v88, v158, v159
    v_max3_f32 v80, v80, v174, v175
    v_max_f32 v88, v88, v89
    v_max_f32 v80, v80, v81
    v_mul_f32 v90, 0xbfb8aa3b, v88
    v_mul_f32 v82, 0xbfb8aa3b, v80
    v_pk_fma_f32 v[144:145], v[144:145], s[84:85], v[90:91] op_sel_hi:[1,0,0]
    v_pk_fma_f32 v[160:161], v[160:161], s[84:85], v[82:83] op_sel_hi:[1,0,0]
    v_pk_fma_f32 v[146:147], v[146:147], s[84:85], v[90:91] op_sel_hi:[1,0,0]
    v_pk_fma_f32 v[162:163], v[162:163], s[84:85], v[82:83] op_sel_hi:[1,0,0]
    v_exp_f32 v144, v144
    v_exp_f32 v160, v160
    v_exp_f32 v145, v145
    v_exp_f32 v161, v161
    v_pk_fma_f32 v[148:149], v[148:149], s[84:85], v[90:91] op_sel_hi:[1,0,0]
    v_pk_fma_f32 v[164:165], v[164:165], s[84:85], v[82:83] op_sel_hi:[1,0,0]
    v_exp_f32 v146, v146
    v_exp_f32 v162, v162
    v_exp_f32 v147, v147
    v_exp_f32 v163, v163
    v_pk_fma_f32 v[150:151], v[150:151], s[84:85], v[90:91] op_sel_hi:[1,0,0]
    v_pk_fma_f32 v[166:167], v[166:167], s[84:85], v[82:83] op_sel_hi:[1,0,0]
    v_exp_f32 v148, v148
    v_exp_f32 v164, v164
    v_exp_f32 v149, v149
    v_exp_f32 v165, v165
    v_pk_fma_f32 v[152:153], v[152:153], s[84:85], v[90:91] op_sel_hi:[1,0,0]
    v_pk_fma_f32 v[168:169], v[168:169], s[84:85], v[82:83] op_sel_hi:[1,0,0]
    v_exp_f32 v150, v150
    v_exp_f32 v166, v166
    v_exp_f32 v151, v151
    v_exp_f32 v167, v167
    v_pk_fma_f32 v[154:155], v[154:155], s[84:85], v[90:91] op_sel_hi:[1,0,0]
    v_pk_fma_f32 v[170:171], v[170:171], s[84:85], v[82:83] op_sel_hi:[1,0,0]
    v_exp_f32 v152, v152
    v_exp_f32 v168, v168
    v_exp_f32 v153, v153
    v_exp_f32 v169, v169
    v_pk_fma_f32 v[156:157], v[156:157], s[84:85], v[90:91] op_sel_hi:[1,0,0]
    v_pk_fma_f32 v[172:173], v[172:173], s[84:85], v[82:83] op_sel_hi:[1,0,0]
    v_exp_f32 v154, v154
    v_exp_f32 v170, v170
    v_exp_f32 v155, v155
    v_exp_f32 v171, v171
    v_pk_fma_f32 v[158:159], v[158:159], s[84:85], v[90:91] op_sel_hi:[1,0,0]
    v_pk_fma_f32 v[174:175], v[174:175], s[84:85], v[82:83] op_sel_hi:[1,0,0]
    v_exp_f32 v156, v156
    v_exp_f32 v172, v172
    v_exp_f32 v157, v157
    v_exp_f32 v173, v173
    v_exp_f32 v158, v158
    v_exp_f32 v174, v174
    v_exp_f32 v159, v159
    v_exp_f32 v175, v175
    v_pk_add_f32 v[92:93], v[144:145], v[146:147]
    v_pk_add_f32 v[84:85], v[160:161], v[162:163]
    v_pk_add_f32 v[94:95], v[148:149], v[150:151]
    v_pk_add_f32 v[86:87], v[164:165], v[166:167]
    v_pk_add_f32 v[92:93], v[92:93], v[152:153]
    v_pk_add_f32 v[84:85], v[84:85], v[168:169]
    v_pk_add_f32 v[94:95], v[94:95], v[154:155]
    v_pk_add_f32 v[86:87], v[86:87], v[170:171]
    v_pk_add_f32 v[92:93], v[92:93], v[156:157]
    v_pk_add_f32 v[84:85], v[84:85], v[172:173]
    v_pk_add_f32 v[94:95], v[94:95], v[158:159]
    v_pk_add_f32 v[86:87], v[86:87], v[174:175]
    v_pk_add_f32 v[92:93], v[92:93], v[94:95]
    v_pk_add_f32 v[84:85], v[84:85], v[86:87]
    v_add_f32 v92, v92, v93
    v_add_f32 v84, v84, v85
    v_rcp_f32 v90, v92
    v_rcp_f32 v82, v84
    v_pk_mul_f32 v[144:145], v[144:145], v[90:91] op_sel_hi:[1,0]
    v_pk_mul_f32 v[160:161], v[160:161], v[82:83] op_sel_hi:[1,0]
    v_pk_mul_f32 v[146:147], v[146:147], v[90:91] op_sel_hi:[1,0]
    v_pk_mul_f32 v[162:163], v[162:163], v[82:83] op_sel_hi:[1,0]
    v_cvt_pk_bf16_f32 v144, v144, v145
    v_cvt_pk_bf16_f32 v160, v160, v161
    v_pk_mul_f32 v[148:149], v[148:149], v[90:91] op_sel_hi:[1,0]
    v_pk_mul_f32 v[164:165], v[164:165], v[82:83] op_sel_hi:[1,0]
    v_cvt_pk_bf16_f32 v145, v146, v147
    v_cvt_pk_bf16_f32 v161, v162, v163
    v_pk_mul_f32 v[150:151], v[150:151], v[90:91] op_sel_hi:[1,0]
    v_pk_mul_f32 v[166:167], v[166:167], v[82:83] op_sel_hi:[1,0]
    v_cvt_pk_bf16_f32 v146, v148, v149
    v_cvt_pk_bf16_f32 v162, v164, v165
    v_pk_mul_f32 v[152:153], v[152:153], v[90:91] op_sel_hi:[1,0]
    v_pk_mul_f32 v[168:169], v[168:169], v[82:83] op_sel_hi:[1,0]
    v_cvt_pk_bf16_f32 v147, v150, v151
    v_cvt_pk_bf16_f32 v163, v166, v167
    v_pk_mul_f32 v[154:155], v[154:155], v[90:91] op_sel_hi:[1,0]
    v_pk_mul_f32 v[170:171], v[170:171], v[82:83] op_sel_hi:[1,0]
    v_cvt_pk_bf16_f32 v148, v152, v153
    v_cvt_pk_bf16_f32 v164, v168, v169
    v_pk_mul_f32 v[156:157], v[156:157], v[90:91] op_sel_hi:[1,0]
    v_pk_mul_f32 v[172:173], v[172:173], v[82:83] op_sel_hi:[1,0]
    v_cvt_pk_bf16_f32 v149, v154, v155
    v_cvt_pk_bf16_f32 v165, v170, v171
    v_pk_mul_f32 v[158:159], v[158:159], v[90:91] op_sel_hi:[1,0]
    v_pk_mul_f32 v[174:175], v[174:175], v[82:83] op_sel_hi:[1,0]
    v_cvt_pk_bf16_f32 v150, v156, v157
    v_cvt_pk_bf16_f32 v166, v172, v173
    v_cvt_pk_bf16_f32 v151, v158, v159
    v_cvt_pk_bf16_f32 v167, v174, v175
    s_barrier
    ds_read_b128 v[176:179], v28 offset:0
    ds_read_b128 v[180:183], v28 offset:16
    ds_read_b128 v[184:187], v28 offset:1360
    ds_read_b128 v[188:191], v28 offset:1376
    ds_read_b128 v[192:195], v28 offset:2720
    ds_read_b128 v[196:199], v28 offset:2736
    ds_read_b128 v[200:203], v28 offset:4080
    ds_read_b128 v[204:207], v28 offset:4096
    s_waitcnt lgkmcnt(6)
    v_mfma_f32_32x32x16_bf16 v[48:63], v[176:179], v[32:35], 0
    v_mfma_f32_32x32x16_bf16 v[48:63], v[180:183], v[36:39], v[48:63]
    s_waitcnt lgkmcnt(4)
    v_mfma_f32_32x32x16_bf16 v[64:79], v[184:187], v[128:131], 0
    v_mfma_f32_32x32x16_bf16 v[64:79], v[188:191], v[132:135], v[64:79]
    s_waitcnt lgkmcnt(2)
    v_mfma_f32_32x32x16_bf16 v[80:95], v[192:195], v[144:147], 0
    s_nop 6
    v_add_f32 v56, 0x358637bd, v56
    v_rcp_f32 v56, v56
    s_nop 0
    v_mul_f32 v48, v48, v56
    v_mul_f32 v49, v49, v56
    v_mul_f32 v50, v50, v56
    v_mfma_f32_32x32x16_bf16 v[80:95], v[196:199], v[148:151], v[80:95]
    v_mul_f32 v51, v51, v56
    v_mul_f32 v52, v52, v56
    v_mul_f32 v53, v53, v56
    v_mul_f32 v54, v54, v56
    v_mul_f32 v55, v55, v56
    v_cvt_pk_bf16_f32 v48, v48, v49
    s_waitcnt lgkmcnt(0)
    v_mfma_f32_32x32x16_bf16 v[96:111], v[200:203], v[160:163], 0
    v_cvt_pk_bf16_f32 v49, v50, v51
    v_cvt_pk_bf16_f32 v50, v52, v53
    v_cvt_pk_bf16_f32 v51, v54, v55
    buffer_store_dwordx4 v[48:51], v0, s[20:23], 0 offen offset:0 sc1
    v_add_f32 v72, 0x358637bd, v72
    v_mfma_f32_32x32x16_bf16 v[96:111], v[204:207], v[164:167], v[96:111]
    v_rcp_f32 v72, v72
    s_nop 0
    v_mul_f32 v64, v64, v72
    v_mul_f32 v65, v65, v72
    v_mul_f32 v66, v66, v72
    v_mul_f32 v67, v67, v72
    v_mul_f32 v68, v68, v72
    v_mul_f32 v69, v69, v72
    v_mul_f32 v70, v70, v72
    v_mul_f32 v71, v71, v72
    v_cvt_pk_bf16_f32 v64, v64, v65
    v_cvt_pk_bf16_f32 v65, v66, v67
    v_cvt_pk_bf16_f32 v66, v68, v69
    v_cvt_pk_bf16_f32 v67, v70, v71
    buffer_store_dwordx4 v[64:67], v0, s[20:23], 0 offen offset:1024 sc1
    v_add_f32 v88, 0x358637bd, v88
    v_rcp_f32 v88, v88
    s_nop 0
    v_pk_mul_f32 v[80:81], v[80:81], v[88:89] op_sel_hi:[1,0]
    v_pk_mul_f32 v[82:83], v[82:83], v[88:89] op_sel_hi:[1,0]
    v_pk_mul_f32 v[84:85], v[84:85], v[88:89] op_sel_hi:[1,0]
    v_pk_mul_f32 v[86:87], v[86:87], v[88:89] op_sel_hi:[1,0]
    v_cvt_pk_bf16_f32 v80, v80, v81
    v_cvt_pk_bf16_f32 v81, v82, v83
    v_cvt_pk_bf16_f32 v82, v84, v85
    v_cvt_pk_bf16_f32 v83, v86, v87
    buffer_store_dwordx4 v[80:83], v0, s[20:23], 0 offen offset:2048 sc1
    v_add_f32 v104, 0x358637bd, v104
    v_rcp_f32 v104, v104
    s_nop 0
    v_pk_mul_f32 v[96:97], v[96:97], v[104:105] op_sel_hi:[1,0]
    v_pk_mul_f32 v[98:99], v[98:99], v[104:105] op_sel_hi:[1,0]
    v_pk_mul_f32 v[100:101], v[100:101], v[104:105] op_sel_hi:[1,0]
    v_pk_mul_f32 v[102:103], v[102:103], v[104:105] op_sel_hi:[1,0]
    v_cvt_pk_bf16_f32 v96, v96, v97
    v_cvt_pk_bf16_f32 v97, v98, v99
    v_cvt_pk_bf16_f32 v98, v100, v101
    v_cvt_pk_bf16_f32 v99, v102, v103
    buffer_store_dwordx4 v[96:99], v0, s[20:23], 0 offen offset:3072 sc1
    s_atomic_add s35, s[20:21], s99
    s_add_u32 s99, s99, 64
    v_add_u32 v2, s65, v8
    v_xor_b32 v3, 32, v2
    v_xor_b32 v4, 64, v2
    v_xor_b32 v5, 0x60, v2
    v_lshlrev_b32 v112, 4, v1
    v_add_u32 v21, s94, v112
    v_xor_b32 v20, 0x1000, v21
    v_lshlrev_b32 v112, 2, v1
    v_add_u32 v23, s95, v112
    v_xor_b32 v24, 0x100, v23
    v_mov_b32 v113, -1
    v_and_b32 v22, 15, v1
    v_lshrrev_b32 v112, 4, v1
    v_lshlrev_b32 v19, 9, v112
    v_lshl_or_b32 v6, v22, 4, v19
    v_add_u32 v6, s67, v6
    v_xor_b32 v7, 0x100, v6
    v_lshl_or_b32 v19, v22, 2, v19
    v_or_b32 v19, s71, v19
    v_lshlrev_b32 v22, 11, v22
    v_and_b32 v112, 1, v112
    v_lshl_or_b32 v22, v112, 5, v22
    v_lshrrev_b32 v112, 5, v1
    v_lshl_or_b32 v22, v112, 4, v22
    s_mov_b32 s72, 0
    s_xor_b32 s73, s72, 4096
    s_xor_b32 s74, s72, 8192
    s_xor_b32 s75, s72, 12288
    v_add_u32 v20, 49152, v20
    s_barrier
    ds_read_b64_tr_b16 v[128:129], v2 offset:0
    ds_read_b64_tr_b16 v[130:131], v2 offset:512
    ds_read_b64_tr_b16 v[132:133], v3 offset:0
    ds_read_b64_tr_b16 v[134:135], v3 offset:512
    ds_read_b64_tr_b16 v[136:137], v4 offset:0
    ds_read_b64_tr_b16 v[138:139], v4 offset:512
    ds_read_b64_tr_b16 v[140:141], v5 offset:0
    ds_read_b64_tr_b16 v[142:143], v5 offset:512
    s_mov_b32 s34, 0
    s_atomic_or s34, s[20:21], s70 glc
    ds_read_b64_tr_b16 v[144:145], v2 offset:4096
    ds_read_b64_tr_b16 v[146:147], v2 offset:4608
    ds_read_b64_tr_b16 v[148:149], v3 offset:4096
    ds_read_b64_tr_b16 v[150:151], v3 offset:4608
    ds_read_b64_tr_b16 v[152:153], v4 offset:4096
    ds_read_b64_tr_b16 v[154:155], v4 offset:4608
    ds_read_b64_tr_b16 v[156:157], v5 offset:4096
    ds_read_b64_tr_b16 v[158:159], v5 offset:4608
    ds_read_b64_tr_b16 v[160:161], v2 offset:8192
    ds_read_b64_tr_b16 v[162:163], v2 offset:8704
    ds_read_b64_tr_b16 v[164:165], v3 offset:8192
    ds_read_b64_tr_b16 v[166:167], v3 offset:8704
    ds_read_b64_tr_b16 v[168:169], v4 offset:8192
    ds_read_b64_tr_b16 v[170:171], v4 offset:8704
    ds_read_b64_tr_b16 v[172:173], v5 offset:8192
    ds_read_b64_tr_b16 v[174:175], v5 offset:8704
    ds_read_b64_tr_b16 v[176:177], v2 offset:12288
    ds_read_b64_tr_b16 v[178:179], v2 offset:12800
    ds_read_b64_tr_b16 v[180:181], v3 offset:12288
    ds_read_b64_tr_b16 v[182:183], v3 offset:12800
    ds_read_b64_tr_b16 v[184:185], v4 offset:12288
    ds_read_b64_tr_b16 v[186:187], v4 offset:12800
    ds_read_b64_tr_b16 v[188:189], v5 offset:12288
    ds_read_b64_tr_b16 v[190:191], v5 offset:12800
    v_add_u32 v2, s66, v2
    ds_read_b64_tr_b16 v[192:193], v2 offset:0
    ds_read_b64_tr_b16 v[194:195], v2 offset:512
    v_add_u32 v3, s66, v3
    ds_read_b64_tr_b16 v[196:197], v3 offset:0
    ds_read_b64_tr_b16 v[198:199], v3 offset:512
    v_add_u32 v4, s66, v4
    ds_read_b64_tr_b16 v[200:201], v4 offset:0
    ds_read_b64_tr_b16 v[202:203], v4 offset:512
    v_add_u32 v5, s66, v5
    ds_read_b64_tr_b16 v[204:205], v5 offset:0
    ds_read_b64_tr_b16 v[206:207], v5 offset:512
    ds_read_b64_tr_b16 v[208:209], v2 offset:4096
    ds_read_b64_tr_b16 v[210:211], v2 offset:4608
    ds_read_b64_tr_b16 v[212:213], v3 offset:4096
    ds_read_b64_tr_b16 v[214:215], v3 offset:4608
    ds_read_b64_tr_b16 v[216:217], v4 offset:4096
    ds_read_b64_tr_b16 v[218:219], v4 offset:4608
    ds_read_b64_tr_b16 v[220:221], v5 offset:4096
    ds_read_b64_tr_b16 v[222:223], v5 offset:4608
    ds_read_b64_tr_b16 v[224:225], v2 offset:8192
    ds_read_b64_tr_b16 v[226:227], v2 offset:8704
    ds_read_b64_tr_b16 v[228:229], v3 offset:8192
    ds_read_b64_tr_b16 v[230:231], v3 offset:8704
    ds_read_b64_tr_b16 v[232:233], v4 offset:8192
    ds_read_b64_tr_b16 v[234:235], v4 offset:8704
    ds_read_b64_tr_b16 v[236:237], v5 offset:8192
    ds_read_b64_tr_b16 v[238:239], v5 offset:8704
    ds_read_b64_tr_b16 v[240:241], v2 offset:12288
    ds_read_b64_tr_b16 v[242:243], v2 offset:12800
    ds_read_b64_tr_b16 v[244:245], v3 offset:12288
    ds_read_b64_tr_b16 v[246:247], v3 offset:12800
    ds_read_b64_tr_b16 v[248:249], v4 offset:12288
    ds_read_b64_tr_b16 v[250:251], v4 offset:12800
    ds_read_b64_tr_b16 v[252:253], v5 offset:12288
    ds_read_b64_tr_b16 v[254:255], v5 offset:12800
    s_waitcnt vmcnt(0) lgkmcnt(0)
    s_atomic_add s35, s[20:21], s99
    s_cmp_ge_u32 s34, 8
    s_cbranch_scc1 L_p2go
    s_mov_b32 s34, 0
    s_atomic_or s34, s[20:21], s70 glc
    s_branch L_p2chk
L_roleB:
    s_and_b32 s87, s2, 6
    v_lshrrev_b32 v13, 3, v0
    s_bfe_u32 s83, s2, 0x10006
    v_and_b32 v12, 16, v0
    s_or_b32 s87, s87, s83
    s_mul_i32 s72, s64, 1536
    s_mov_b64 s[8:9], s[16:17]
    v_lshlrev_b32 v9, 4, v9
    s_lshl_b32 s83, s87, 7
    v_lshlrev_b32 v12, 2, v12
    s_mov_b32 s11, s7
    v_xor_b32 v12, v12, v9
    v_mul_u32_u24 v14, 3072, v13
    s_mov_b32 s10, 1572864
    v_add3_u32 v6, v14, v12, s83
    s_lshl_b32 s81, s88, 10
    v_add_u32 v4, 1024, v6
    s_and_b32 s83, s88, 1
    s_lshl_b32 s83, s83, 5
    v_xor_b32 v6, s83, v6
    v_add_u32 v34, 98304, v6
    s_load_dwordx2 s[28:29], s[0:1], 56
    s_load_dwordx2 s[20:21], s[0:1], 80
    s_load_dwordx2 s[12:13], s[0:1], 24
    s_load_dwordx2 s[16:17], s[0:1], 48
    s_load_dwordx2 s[24:25], s[0:1], 64
    s_load_dwordx2 s[32:33], s[0:1], 72
    v_and_b32 v1, 63, v0
    v_add_u32 v5, 2048, v6
    s_lshl_b32 s83, s82, 7
    v_lshl_add_u32 v31, v13, 10, v12
    s_and_b32 s89, s88, 1
    v_add_u32 v31, s83, v31
    s_lshl_b32 s89, s89, 5
    v_xor_b32 v31, s89, v31
    s_and_b32 s89, s88, 3
    s_lshr_b32 s90, s88, 2
    s_mov_b32 s22, 33554432
    s_mov_b32 s23, 0x20000
    s_mov_b32 s30, 1024
    s_mov_b32 s31, 0x20000
    s_and_b32 s92, s88, 1
    s_lshl_b32 s92, s92, 1
    s_xor_b32 s89, s90, 1
    s_add_u32 s89, s89, s92
    s_bfe_u32 s90, s88, 0x10001
    s_lshl_b32 s82, s88, 1
    s_lshl_b32 s92, s88, 12
    s_add_u32 s92, s92, s98
    s_sub_u32 s92, s92, 0x4000
    v_and_b32 v7, 7, v1
    v_xor_b32 v7, s82, v7
    v_lshlrev_b32 v7, 4, v7
    v_lshl_or_b32 v7, v8, 11, v7
    v_add_u32 v7, s92, v7
    s_lshl_b32 s101, s88, 8
    s_add_u32 m0, s101, 40960
    s_mov_b64 exec, 0xffff
    buffer_load_dwordx4 v7, s[4:7], s64 offen lds
    s_mov_b64 exec, -1
    s_waitcnt lgkmcnt(0)
    v_lshrrev_b32 v228, 5, v1
    v_lshlrev_b32 v228, 4, v228
    s_lshl_b32 s92, s87, 7
    buffer_load_dwordx4 v[96:99], v228, s[28:31], s92 offen offset:0
    buffer_load_dwordx4 v[100:103], v228, s[28:31], s92 offen offset:32
    buffer_load_dwordx4 v[104:107], v228, s[28:31], s92 offen offset:64
    buffer_load_dwordx4 v[108:111], v228, s[28:31], s92 offen offset:96
    s_sub_u32 s100, s87, s91
    s_and_b32 s100, s100, 7
    v_and_b32 v8, 31, v1
    v_lshrrev_b32 v220, 5, v1
    v_bfe_u32 v221, v1, 1, 3
    v_lshlrev_b32 v8, 7, v8
    v_xor_b32 v220, v220, v221
    s_lshl_b32 s92, s88, 12
    v_lshl_or_b32 v8, v220, 4, v8
    v_add_u32 v8, s92, v8
    v_lshrrev_b32 v220, 4, v1
    v_bfe_u32 v221, v1, 2, 2
    v_lshl_add_u32 v221, v220, 3, v221
    v_lshlrev_b32 v18, 7, v221
    v_and_b32 v221, 3, v1
    v_lshl_or_b32 v18, v221, 3, v18
    v_bfe_u32 v221, v1, 3, 1
    v_lshl_or_b32 v18, v221, 6, v18
    v_and_b32 v221, 1, v220
    v_lshl_or_b32 v18, v221, 5, v18
    s_lshl_b32 s92, s88, 5
    v_xor_b32 v18, s92, v18
    v_add_u32 v19, 0x10000, v18
    v_and_b32 v221, 7, v1
    v_and_b32 v222, 6, v1
    v_xor_b32 v222, v222, v220
    v_lshlrev_b32 v20, 7, v221
    v_lshl_or_b32 v20, v222, 4, v20
    v_xor_b32 v21, 64, v20
    v_add_u32 v12, 0x10000, v20
    v_add_u32 v13, 0x10000, v21
    v_lshlrev_b32 v25, 5, v221
    v_lshl_or_b32 v25, v220, 3, v25
    s_mul_i32 s92, s88, 4352
    s_add_u32 s92, s92, 125952
    v_add_u32 v25, s92, v25
    s_lshl_b32 s92, s88, 8
    s_add_u32 s92, s92, 162304
    v_lshlrev_b32 v23, 2, v1
    v_add_u32 v23, s92, v23
    s_mov_b32 s14, 524288
    s_mov_b32 s15, 0x20000
    s_mov_b32 s18, 524288
    s_mov_b32 s19, 0x20000
    s_mov_b32 s26, 2097152
    s_mov_b32 s27, 0x20000
    s_mov_b32 s84, 0x3fb8aa3b
    s_mov_b32 s85, 0x3fb8aa3b
    s_mov_b32 s35, 1
    v_and_b32 v221, 7, v1
    s_lshl_b32 s92, s86, 3
    s_add_u32 s92, s92, s87
    s_lshl_b32 s92, s92, 9
    s_lshl_b32 s82, s89, 7
    s_add_u32 s92, s92, s82
    s_add_u32 s92, s92, 5963776
    v_lshlrev_b32 v30, 2, v1
    v_add_u32 v29, s92, v30
    v_mov_b32 v224, 0x7ffffff0
    s_cmp_eq_u32 s90, 0
    s_cselect_b32 s92, 32, 0
    v_cmp_gt_u32 vcc, s92, v1
    s_nop 1
    v_cndmask_b32 v29, v224, v29, vcc
    s_lshl_b32 s92, s89, 8
    s_add_u32 s92, s92, 162304
    v_add_u32 v30, s92, v30
    s_mul_i32 s92, s90, 8704
    s_lshl_b32 s82, s89, 10
    s_add_u32 s92, s92, s82
    s_add_u32 s92, s92, 125952
    v_lshrrev_b32 v222, 5, v1
    v_and_b32 v223, 31, v1
    v_lshlrev_b32 v24, 5, v223
    v_lshl_or_b32 v24, v222, 4, v24
    v_add_u32 v24, s92, v24
    v_lshlrev_b32 v26, 5, v221
    v_lshl_or_b32 v26, v222, 4, v26
    v_add_u32 v26, s92, v26
    v_and_b32 v224, 4, v1
    v_lshlrev_b32 v224, 2, v224
    v_xor_b32 v24, v24, v224
    v_xor_b32 v26, v26, v224
    v_bfe_u32 v224, v1, 2, 2
    v_lshl_add_u32 v224, v222, 2, v224
    v_lshlrev_b32 v27, 5, v224
    v_and_b32 v224, 1, v1
    v_lshl_or_b32 v27, v224, 4, v27
    v_bfe_u32 v224, v1, 1, 1
    v_lshl_or_b32 v27, v224, 3, v27
    v_lshlrev_b32 v224, 4, v222
    v_xor_b32 v27, v27, v224
    v_bfe_u32 v224, v1, 4, 1
    v_mul_u32_u24 v224, 4352, v224
    v_add3_u32 v27, v27, v224, s92
    s_and_b32 s92, s88, 3
    s_lshl_b32 s92, s92, 11
    s_add_u32 s92, s92, 32768
    v_lshlrev_b32 v22, 4, v1
    v_add_u32 v22, s92, v22
    s_lshl_b32 s92, s86, 2
    s_add_u32 s92, s92, s89
    s_lshl_b32 s82, s87, 1
    s_add_u32 s82, s82, s90
    s_mul_i32 s83, s92, 41984
    s_lshl_b32 s93, s82, 11
    s_add_u32 s83, s83, s93
    s_add_u32 s83, s83, 2686976
    v_lshlrev_b32 v28, 4, v1
    v_add_u32 v28, s83, v28
    s_lshl_b32 s92, s92, 8
    s_lshr_b32 s83, s87, 2
    s_lshl_b32 s83, s83, 7
    s_add_u32 s92, s92, s83
    s_add_u32 s99, s92, 6049792
    v_lshlrev_b32 v222, 2, v222
    v_sub_u32 v222, v223, v222
    s_lshr_b32 s92, s86, 1
    s_or_b32 s92, s92, s89
    s_cmp_eq_u32 s92, 0
    s_cselect_b32 s92, 1000, 8
    v_add_u32 v223, s92, v222
    v_mov_b32 v224, 0xf149f2ca
    v_mov_b32 v225, 0xffff
    v_mov_b32 v226, 0xffff0000
    v_mov_b32 v230, 0
    v_subrev_u32 v228, 0, v222
    v_cmp_ge_u32 vcc, 7, v228
    s_nop 1
    v_cndmask_b32 v188, v224, v230, vcc
    v_cndmask_b32 v208, 0, v225, vcc
    v_subrev_u32 v228, 1, v222
    v_cmp_ge_u32 vcc, 7, v228
    s_nop 1
    v_cndmask_b32 v189, v224, v230, vcc
    v_cndmask_b32 v229, 0, v226, vcc
    v_or_b32 v208, v208, v229
    v_subrev_u32 v228, 2, v222
    v_cmp_ge_u32 vcc, 7, v228
    s_nop 1
    v_cndmask_b32 v190, v224, v230, vcc
    v_cndmask_b32 v209, 0, v225, vcc
    v_subrev_u32 v228, 3, v222
    v_cmp_ge_u32 vcc, 7, v228
    s_nop 1
    v_cndmask_b32 v191, v224, v230, vcc
    v_cndmask_b32 v229, 0, v226, vcc
    v_or_b32 v209, v209, v229
    v_subrev_u32 v228, 8, v222
    v_cmp_ge_u32 vcc, 7, v228
    s_nop 1
    v_cndmask_b32 v192, v224, v230, vcc
    v_cndmask_b32 v210, 0, v225, vcc
    v_subrev_u32 v228, 9, v222
    v_cmp_ge_u32 vcc, 7, v228
    s_nop 1
    v_cndmask_b32 v193, v224, v230, vcc
    v_cndmask_b32 v229, 0, v226, vcc
    v_or_b32 v210, v210, v229
    v_subrev_u32 v228, 10, v222
    v_cmp_ge_u32 vcc, 7, v228
    s_nop 1
    v_cndmask_b32 v194, v224, v230, vcc
    v_cndmask_b32 v211, 0, v225, vcc
    v_subrev_u32 v228, 11, v222
    v_cmp_ge_u32 vcc, 7, v228
    s_nop 1
    v_cndmask_b32 v195, v224, v230, vcc
    v_cndmask_b32 v229, 0, v226, vcc
    v_or_b32 v211, v211, v229
    v_subrev_u32 v228, 16, v222
    v_cmp_ge_u32 vcc, 7, v228
    s_nop 1
    v_cndmask_b32 v196, v224, v230, vcc
    v_cndmask_b32 v212, 0, v225, vcc
    v_subrev_u32 v228, 17, v222
    v_cmp_ge_u32 vcc, 7, v228
    s_nop 1
    v_cndmask_b32 v197, v224, v230, vcc
    v_cndmask_b32 v229, 0, v226, vcc
    v_or_b32 v212, v212, v229
    v_subrev_u32 v228, 18, v222
    v_cmp_ge_u32 vcc, 7, v228
    s_nop 1
    v_cndmask_b32 v198, v224, v230, vcc
    v_cndmask_b32 v213, 0, v225, vcc
    v_subrev_u32 v228, 19, v222
    v_cmp_ge_u32 vcc, 7, v228
    s_nop 1
    v_cndmask_b32 v199, v224, v230, vcc
    v_cndmask_b32 v229, 0, v226, vcc
    v_or_b32 v213, v213, v229
    v_subrev_u32 v228, 24, v222
    v_cmp_ge_u32 vcc, 7, v228
    s_nop 1
    v_cndmask_b32 v200, v224, v230, vcc
    v_cndmask_b32 v214, 0, v225, vcc
    v_subrev_u32 v228, 25, v222
    v_cmp_ge_u32 vcc, 7, v228
    s_nop 1
    v_cndmask_b32 v201, v224, v230, vcc
    v_cndmask_b32 v229, 0, v226, vcc
    v_or_b32 v214, v214, v229
    v_subrev_u32 v228, 26, v222
    v_cmp_ge_u32 vcc, 7, v228
    s_nop 1
    v_cndmask_b32 v202, v224, v230, vcc
    v_cndmask_b32 v215, 0, v225, vcc
    v_subrev_u32 v228, 27, v222
    v_cmp_ge_u32 vcc, 7, v228
    s_nop 1
    v_cndmask_b32 v203, v224, v230, vcc
    v_cndmask_b32 v229, 0, v226, vcc
    v_or_b32 v215, v215, v229
    v_subrev_u32 v228, 0, v223
    v_cmp_ge_u32 vcc, 7, v228
    s_nop 1
    v_cndmask_b32 v204, v224, v230, vcc
    v_cndmask_b32 v216, 0, v225, vcc
    v_subrev_u32 v228, 1, v223
    v_cmp_ge_u32 vcc, 7, v228
    s_nop 1
    v_cndmask_b32 v205, v224, v230, vcc
    v_cndmask_b32 v229, 0, v226, vcc
    v_or_b32 v216, v216, v229
    v_subrev_u32 v228, 2, v223
    v_cmp_ge_u32 vcc, 7, v228
    s_nop 1
    v_cndmask_b32 v206, v224, v230, vcc
    v_cndmask_b32 v217, 0, v225, vcc
    v_subrev_u32 v228, 3, v223
    v_cmp_ge_u32 vcc, 7, v228
    s_nop 1
    v_cndmask_b32 v207, v224, v230, vcc
    v_cndmask_b32 v229, 0, v226, vcc
    v_or_b32 v217, v217, v229
    s_and_b32 s94, s2, 7
    s_lshr_b32 s92, s2, 7
    s_lshl1_add_u32 s94, s94, s92
    s_bfe_u32 s95, s2, 0x10006
    s_bfe_u32 s92, s88, 0x10001
    s_lshl1_add_u32 s95, s95, s92
    s_and_b32 s71, s88, 1
    s_mov_b32 s3, 1
    s_mul_i32 s65, s71, -90112
    s_add_u32 s65, s65, 90112
    s_mul_i32 s66, s71, -90112
    s_add_u32 s66, s66, 106496
    s_mov_b32 s83, 2686976
    s_lshl_b32 s92, s94, 2
    s_add_u32 s92, s92, s95
    s_mul_i32 s82, s92, 41984
    s_add_u32 s83, s83, s82
    s_lshl_b32 s82, s71, 14
    s_add_u32 s67, s83, s82
    s_lshl_b32 s92, s92, 8
    s_lshl_b32 s82, s3, 14
    s_add_u32 s92, s92, s82
    s_lshl_b32 s82, s71, 7
    s_add_u32 s92, s92, s82
    s_add_u32 s70, s92, 6033408
    s_lshl_b32 s92, s94, 1
    s_add_u32 s92, s92, s71
    s_lshl_b32 s92, s92, 11
    s_lshl_b32 s82, s95, 7
    s_add_u32 s92, s92, s82
    s_add_u32 s68, s92, 5963776
    s_lshr_b32 s92, s94, 1
    s_lshl_b32 s92, s92, 8
    s_and_b32 s82, s94, 1
    s_add_u32 m0, s81, 16384
    s_nop 0
    buffer_load_dwordx4 v6, s[8:11], s72 offen offset:0 lds
    s_add_u32 m0, s81, 20480
    s_nop 0
    buffer_load_dwordx4 v34, s[8:11], s72 offen offset:0 lds
    s_add_u32 m0, s81, 23552
    s_nop 0
    buffer_load_dwordx4 v6, s[8:11], s72 offen offset:1024 lds
    s_add_u32 m0, s81, 27648
    s_nop 0
    buffer_load_dwordx4 v34, s[8:11], s72 offen offset:1024 lds
    s_add_u32 m0, s81, 30720
    s_nop 0
    buffer_load_dwordx4 v6, s[8:11], s72 offen offset:2048 lds
    s_add_u32 m0, s81, 34816
    s_nop 0
    buffer_load_dwordx4 v34, s[8:11], s72 offen offset:2048 lds
    s_or_b32 s92, s92, s82
    s_lshl_b32 s82, s95, 6
    s_add_u32 s92, s92, s82
    s_lshl_b32 s92, s92, 10
    s_bfe_u32 s82, s2, 0x30003
    s_lshl_b32 s82, s82, 7
    s_add_u32 s92, s92, s82
    s_lshl_b32 s82, s71, 15
    s_add_u32 s69, s92, s82
    s_lshl_b32 s82, s71, 8
    s_add_u32 s67, s67, s82
    s_sub_u32 s66, s66, s65
    s_lshl_b32 s71, s71, 6
    s_and_b32 s92, s88, 3
    s_lshl_b32 s94, s92, 12
    s_add_u32 s94, s94, 0
    s_lshl_b32 s92, s92, 8
    s_add_u32 s95, s92, 161280
    v_lshrrev_b32 v220, 4, v1
    v_bfe_u32 v221, v1, 2, 2
    v_lshl_add_u32 v221, v220, 3, v221
    v_lshlrev_b32 v222, 7, v221
    v_and_b32 v221, 3, v1
    v_lshl_or_b32 v222, v221, 3, v222
    v_bfe_u32 v221, v1, 3, 1
    v_lshl_or_b32 v222, v221, 6, v222
    v_and_b32 v221, 1, v220
    v_lshl_or_b32 v222, v221, 5, v222
    v_add_u32 v240, s65, v222
    v_xor_b32 v241, 32, v240
    v_xor_b32 v242, 64, v240
    v_xor_b32 v243, 0x60, v240
    v_lshlrev_b32 v220, 4, v1
    v_add_u32 v248, s94, v220
    v_xor_b32 v247, 0x1000, v248
    v_lshlrev_b32 v220, 2, v1
    v_add_u32 v250, s95, v220
    v_xor_b32 v251, 0x100, v250
    v_mov_b32 v221, -1
    ds_write_b32 v250, v221
    v_and_b32 v249, 15, v1
    v_lshrrev_b32 v220, 4, v1
    v_lshlrev_b32 v246, 9, v220
    v_lshl_or_b32 v244, v249, 4, v246
    v_add_u32 v244, s67, v244
    v_xor_b32 v245, 0x100, v244
    v_lshl_or_b32 v246, v249, 2, v246
    v_or_b32 v246, s71, v246
    v_lshlrev_b32 v249, 11, v249
    v_and_b32 v220, 1, v220
    v_lshl_or_b32 v249, v220, 5, v249
    v_lshrrev_b32 v220, 5, v1
    v_lshl_or_b32 v249, v220, 4, v249
    s_lshl_b32 s92, s86, 2
    s_add_u32 s92, s92, s88
    s_mul_i32 s82, s92, 41984
    s_lshl_b32 s83, s87, 12
    s_add_u32 s82, s82, s83
    s_add_u32 s82, s82, 2686976
    v_lshlrev_b32 v40, 4, v1
    v_add_u32 v35, s82, v40
    s_lshl_b32 s92, s86, 3
    s_add_u32 s92, s92, s87
    s_lshl_b32 s92, s92, 9
    s_lshl_b32 s82, s88, 7
    s_add_u32 s92, s92, s82
    s_add_u32 s92, s92, 5963776
    v_add_u32 v40, s92, v40
    v_mov_b32 v36, -1
    v_mov_b32 v37, -1
    v_mov_b32 v38, -1
    v_mov_b32 v39, -1
    s_add_u32 s64, s64, 128
    s_and_b32 s64, s64, 1023
    s_mul_i32 s73, s64, 1536
    s_add_u32 m0, s80, 41984
    s_nop 0
    buffer_load_dwordx4 v2, s[4:7], s64 offen lds
    s_add_u32 m0, s80, 43008
    s_nop 0
    buffer_load_dwordx4 v3, s[4:7], s64 offen lds
    s_add_u32 m0, s80, 50176
    s_nop 0
    buffer_load_dwordx4 v32, s[4:7], s64 offen lds
    s_add_u32 m0, s80, 51200
    s_nop 0
    buffer_load_dwordx4 v33, s[4:7], s64 offen lds
    s_add_u32 m0, s81, 58368
    s_nop 0
    buffer_load_dwordx4 v6, s[8:11], s73 offen offset:0 lds
    s_add_u32 m0, s81, 62464
    s_nop 0
    buffer_load_dwordx4 v34, s[8:11], s73 offen offset:0 lds
    s_add_u32 m0, s81, 65536
    s_nop 0
    buffer_load_dwordx4 v6, s[8:11], s73 offen offset:1024 lds
    s_add_u32 m0, s81, 69632
    s_nop 0
    buffer_load_dwordx4 v34, s[8:11], s73 offen offset:1024 lds
    s_add_u32 m0, s81, 72704
    s_nop 0
    buffer_load_dwordx4 v6, s[8:11], s73 offen offset:2048 lds
    s_add_u32 m0, s81, 76800
    s_nop 0
    buffer_load_dwordx4 v34, s[8:11], s73 offen offset:2048 lds
    s_add_u32 m0, s101, 82944
    s_mov_b64 exec, 0xffff
    buffer_load_dwordx4 v7, s[4:7], s64 offen lds
    s_mov_b64 exec, -1
    s_setprio 3
    s_waitcnt vmcnt(11)
    s_barrier
    s_add_u32 s64, s64, 128
    s_and_b32 s64, s64, 1023
    s_mul_i32 s74, s64, 1536
    s_add_u32 m0, s80, 83968
    s_nop 0
    buffer_load_dwordx4 v2, s[4:7], s64 offen lds
    s_add_u32 m0, s80, 84992
    s_nop 0
    buffer_load_dwordx4 v3, s[4:7], s64 offen lds
    s_add_u32 m0, s80, 92160
    s_nop 0
    buffer_load_dwordx4 v32, s[4:7], s64 offen lds
    s_add_u32 m0, s80, 93184
    s_nop 0
    buffer_load_dwordx4 v33, s[4:7], s64 offen lds
    s_add_u32 m0, s81, 100352
    s_nop 0
    buffer_load_dwordx4 v6, s[8:11], s74 offen offset:0 lds
    s_add_u32 m0, s81, 104448
    s_nop 0
    buffer_load_dwordx4 v34, s[8:11], s74 offen offset:0 lds
    s_add_u32 m0, s81, 107520
    s_nop 0
    buffer_load_dwordx4 v6, s[8:11], s74 offen offset:1024 lds
    s_add_u32 m0, s81, 111616
    s_nop 0
    buffer_load_dwordx4 v34, s[8:11], s74 offen offset:1024 lds
    s_add_u32 m0, s81, 114688
    s_nop 0
    buffer_load_dwordx4 v6, s[8:11], s74 offen offset:2048 lds
    s_add_u32 m0, s81, 118784
    s_nop 0
    buffer_load_dwordx4 v34, s[8:11], s74 offen offset:2048 lds
    s_add_u32 m0, s101, 124928
    s_mov_b64 exec, 0xffff
    buffer_load_dwordx4 v7, s[4:7], s64 offen lds
    s_mov_b64 exec, -1
    s_cmp_eq_u32 s100, 0
    s_cbranch_scc0 L_nog7
    v_add_u32 v8, 0, v8
    ds_read_b128 v[112:115], v8
    v_xor_b32 v9, 32, v8
    ds_read_b128 v[116:119], v9
    v_xor_b32 v9, 64, v8
    ds_read_b128 v[120:123], v9
    v_xor_b32 v9, 96, v8
    ds_read_b128 v[124:127], v9
    s_waitcnt lgkmcnt(0)
    v_mfma_f32_32x32x16_bf16 v[48:63], v[96:99], v[112:115], 0
    v_mfma_f32_32x32x16_bf16 v[48:63], v[100:103], v[116:119], v[48:63]
    v_mfma_f32_32x32x16_bf16 v[48:63], v[104:107], v[120:123], v[48:63]
    v_mfma_f32_32x32x16_bf16 v[48:63], v[108:111], v[124:127], v[48:63]
L_nog7:
    s_waitcnt vmcnt(11)
    s_barrier
    s_add_u32 s64, s64, 128
    s_and_b32 s64, s64, 1023
    s_mul_i32 s75, s64, 1536
    s_add_u32 m0, s80, 0
    s_nop 0
    buffer_load_dwordx4 v2, s[4:7], s64 offen lds
    s_add_u32 m0, s80, 1024
    s_nop 0
    buffer_load_dwordx4 v3, s[4:7], s64 offen lds
    s_add_u32 m0, s80, 8192
    s_nop 0
    buffer_load_dwordx4 v32, s[4:7], s64 offen lds
    s_add_u32 m0, s80, 9216
    s_nop 0
    buffer_load_dwordx4 v33, s[4:7], s64 offen lds
    s_add_u32 m0, s81, 16384
    s_nop 0
    buffer_load_dwordx4 v6, s[8:11], s75 offen offset:0 lds
    s_add_u32 m0, s81, 20480
    s_nop 0
    buffer_load_dwordx4 v34, s[8:11], s75 offen offset:0 lds
    s_add_u32 m0, s81, 23552
    s_nop 0
    buffer_load_dwordx4 v6, s[8:11], s75 offen offset:1024 lds
    s_add_u32 m0, s81, 27648
    s_nop 0
    buffer_load_dwordx4 v34, s[8:11], s75 offen offset:1024 lds
    s_add_u32 m0, s81, 30720
    s_nop 0
    buffer_load_dwordx4 v6, s[8:11], s75 offen offset:2048 lds
    s_add_u32 m0, s81, 34816
    s_nop 0
    buffer_load_dwordx4 v34, s[8:11], s75 offen offset:2048 lds
    s_add_u32 m0, s101, 40960
    s_mov_b64 exec, 0xffff
    buffer_load_dwordx4 v7, s[4:7], s64 offen lds
    s_mov_b64 exec, -1
    s_cmp_eq_u32 s100, 1
    s_cbranch_scc0 L_nog8
    v_add_u32 v8, 41984, v8
    ds_read_b128 v[112:115], v8
    v_xor_b32 v9, 32, v8
    ds_read_b128 v[116:119], v9
    v_xor_b32 v9, 64, v8
    ds_read_b128 v[120:123], v9
    v_xor_b32 v9, 96, v8
    ds_read_b128 v[124:127], v9
    s_waitcnt lgkmcnt(0)
    v_mfma_f32_32x32x16_bf16 v[48:63], v[96:99], v[112:115], 0
    v_mfma_f32_32x32x16_bf16 v[48:63], v[100:103], v[116:119], v[48:63]
    v_mfma_f32_32x32x16_bf16 v[48:63], v[104:107], v[120:123], v[48:63]
    v_mfma_f32_32x32x16_bf16 v[48:63], v[108:111], v[124:127], v[48:63]
L_nog8:
    s_waitcnt vmcnt(11)
    s_barrier
    s_add_u32 s64, s64, 128
    s_and_b32 s64, s64, 1023
    s_mul_i32 s76, s64, 1536
    s_add_u32 m0, s80, 41984
    s_nop 0
    buffer_load_dwordx4 v2, s[4:7], s64 offen lds
    s_add_u32 m0, s80, 43008
    s_nop 0
    buffer_load_dwordx4 v3, s[4:7], s64 offen lds
    s_add_u32 m0, s80, 50176
    s_nop 0
    buffer_load_dwordx4 v32, s[4:7], s64 offen lds
    s_add_u32 m0, s80, 51200
    s_nop 0
    buffer_load_dwordx4 v33, s[4:7], s64 offen lds
    s_add_u32 m0, s81, 58368
    s_nop 0
    buffer_load_dwordx4 v6, s[8:11], s76 offen offset:0 lds
    s_add_u32 m0, s81, 62464
    s_nop 0
    buffer_load_dwordx4 v34, s[8:11], s76 offen offset:0 lds
    s_add_u32 m0, s81, 65536
    s_nop 0
    buffer_load_dwordx4 v6, s[8:11], s76 offen offset:1024 lds
    s_add_u32 m0, s81, 69632
    s_nop 0
    buffer_load_dwordx4 v34, s[8:11], s76 offen offset:1024 lds
    s_add_u32 m0, s81, 72704
    s_nop 0
    buffer_load_dwordx4 v6, s[8:11], s76 offen offset:2048 lds
    s_add_u32 m0, s81, 76800
    s_nop 0
    buffer_load_dwordx4 v34, s[8:11], s76 offen offset:2048 lds
    s_add_u32 m0, s101, 82944
    s_mov_b64 exec, 0xffff
    buffer_load_dwordx4 v7, s[4:7], s64 offen lds
    s_mov_b64 exec, -1
    s_cmp_eq_u32 s100, 2
    s_cbranch_scc0 L_nog9
    v_add_u32 v8, 83968, v8
    ds_read_b128 v[112:115], v8
    v_xor_b32 v9, 32, v8
    ds_read_b128 v[116:119], v9
    v_xor_b32 v9, 64, v8
    ds_read_b128 v[120:123], v9
    v_xor_b32 v9, 96, v8
    ds_read_b128 v[124:127], v9
    s_waitcnt lgkmcnt(0)
    v_mfma_f32_32x32x16_bf16 v[48:63], v[96:99], v[112:115], 0
    v_mfma_f32_32x32x16_bf16 v[48:63], v[100:103], v[116:119], v[48:63]
    v_mfma_f32_32x32x16_bf16 v[48:63], v[104:107], v[120:123], v[48:63]
    v_mfma_f32_32x32x16_bf16 v[48:63], v[108:111], v[124:127], v[48:63]
L_nog9:
    s_waitcnt vmcnt(11)
    s_barrier
    s_add_u32 s64, s64, 128
    s_and_b32 s64, s64, 1023
    s_mul_i32 s77, s64, 1536
    s_add_u32 m0, s80, 83968
    s_nop 0
    buffer_load_dwordx4 v2, s[4:7], s64 offen lds
    s_add_u32 m0, s80, 84992
    s_nop 0
    buffer_load_dwordx4 v3, s[4:7], s64 offen lds
    s_add_u32 m0, s80, 92160
    s_nop 0
    buffer_load_dwordx4 v32, s[4:7], s64 offen lds
    s_add_u32 m0, s80, 93184
    s_nop 0
    buffer_load_dwordx4 v33, s[4:7], s64 offen lds
    s_add_u32 m0, s81, 100352
    s_nop 0
    buffer_load_dwordx4 v6, s[8:11], s77 offen offset:0 lds
    s_add_u32 m0, s81, 104448
    s_nop 0
    buffer_load_dwordx4 v34, s[8:11], s77 offen offset:0 lds
    s_add_u32 m0, s81, 107520
    s_nop 0
    buffer_load_dwordx4 v6, s[8:11], s77 offen offset:1024 lds
    s_add_u32 m0, s81, 111616
    s_nop 0
    buffer_load_dwordx4 v34, s[8:11], s77 offen offset:1024 lds
    s_add_u32 m0, s81, 114688
    s_nop 0
    buffer_load_dwordx4 v6, s[8:11], s77 offen offset:2048 lds
    s_add_u32 m0, s81, 118784
    s_nop 0
    buffer_load_dwordx4 v34, s[8:11], s77 offen offset:2048 lds
    s_add_u32 m0, s101, 124928
    s_mov_b64 exec, 0xffff
    buffer_load_dwordx4 v7, s[4:7], s64 offen lds
    s_mov_b64 exec, -1
    s_cmp_eq_u32 s100, 3
    s_cbranch_scc0 L_nog10
    v_add_u32 v8, 0, v8
    ds_read_b128 v[112:115], v8
    v_xor_b32 v9, 32, v8
    ds_read_b128 v[116:119], v9
    v_xor_b32 v9, 64, v8
    ds_read_b128 v[120:123], v9
    v_xor_b32 v9, 96, v8
    ds_read_b128 v[124:127], v9
    s_waitcnt lgkmcnt(0)
    v_mfma_f32_32x32x16_bf16 v[48:63], v[96:99], v[112:115], 0
    v_mfma_f32_32x32x16_bf16 v[48:63], v[100:103], v[116:119], v[48:63]
    v_mfma_f32_32x32x16_bf16 v[48:63], v[104:107], v[120:123], v[48:63]
    v_mfma_f32_32x32x16_bf16 v[48:63], v[108:111], v[124:127], v[48:63]
L_nog10:
    s_waitcnt vmcnt(11)
    s_barrier
    s_add_u32 s64, s64, 128
    s_and_b32 s64, s64, 1023
    s_mul_i32 s78, s64, 1536
    s_add_u32 m0, s80, 0
    s_nop 0
    buffer_load_dwordx4 v2, s[4:7], s64 offen lds
    s_add_u32 m0, s80, 1024
    s_nop 0
    buffer_load_dwordx4 v3, s[4:7], s64 offen lds
    s_add_u32 m0, s80, 8192
    s_nop 0
    buffer_load_dwordx4 v32, s[4:7], s64 offen lds
    s_add_u32 m0, s80, 9216
    s_nop 0
    buffer_load_dwordx4 v33, s[4:7], s64 offen lds
    s_add_u32 m0, s81, 16384
    s_nop 0
    buffer_load_dwordx4 v6, s[8:11], s78 offen offset:0 lds
    s_add_u32 m0, s81, 20480
    s_nop 0
    buffer_load_dwordx4 v34, s[8:11], s78 offen offset:0 lds
    s_add_u32 m0, s81, 23552
    s_nop 0
    buffer_load_dwordx4 v6, s[8:11], s78 offen offset:1024 lds
    s_add_u32 m0, s81, 27648
    s_nop 0
    buffer_load_dwordx4 v34, s[8:11], s78 offen offset:1024 lds
    s_add_u32 m0, s81, 30720
    s_nop 0
    buffer_load_dwordx4 v6, s[8:11], s78 offen offset:2048 lds
    s_add_u32 m0, s81, 34816
    s_nop 0
    buffer_load_dwordx4 v34, s[8:11], s78 offen offset:2048 lds
    s_add_u32 m0, s101, 40960
    s_mov_b64 exec, 0xffff
    buffer_load_dwordx4 v7, s[4:7], s64 offen lds
    s_mov_b64 exec, -1
    s_cmp_eq_u32 s100, 4
    s_cbranch_scc0 L_nog11
    v_add_u32 v8, 41984, v8
    ds_read_b128 v[112:115], v8
    v_xor_b32 v9, 32, v8
    ds_read_b128 v[116:119], v9
    v_xor_b32 v9, 64, v8
    ds_read_b128 v[120:123], v9
    v_xor_b32 v9, 96, v8
    ds_read_b128 v[124:127], v9
    s_waitcnt lgkmcnt(0)
    v_mfma_f32_32x32x16_bf16 v[48:63], v[96:99], v[112:115], 0
    v_mfma_f32_32x32x16_bf16 v[48:63], v[100:103], v[116:119], v[48:63]
    v_mfma_f32_32x32x16_bf16 v[48:63], v[104:107], v[120:123], v[48:63]
    v_mfma_f32_32x32x16_bf16 v[48:63], v[108:111], v[124:127], v[48:63]
L_nog11:
    s_waitcnt vmcnt(11)
    s_barrier
    s_add_u32 s64, s64, 128
    s_and_b32 s64, s64, 1023
    s_mul_i32 s79, s64, 1536
    s_add_u32 m0, s80, 41984
    s_nop 0
    buffer_load_dwordx4 v2, s[4:7], s64 offen lds
    s_add_u32 m0, s80, 43008
    s_nop 0
    buffer_load_dwordx4 v3, s[4:7], s64 offen lds
    s_add_u32 m0, s80, 50176
    s_nop 0
    buffer_load_dwordx4 v32, s[4:7], s64 offen lds
    s_add_u32 m0, s80, 51200
    s_nop 0
    buffer_load_dwordx4 v33, s[4:7], s64 offen lds
    s_add_u32 m0, s81, 58368
    s_nop 0
    buffer_load_dwordx4 v6, s[8:11], s79 offen offset:0 lds
    s_add_u32 m0, s81, 62464
    s_nop 0
    buffer_load_dwordx4 v34, s[8:11], s79 offen offset:0 lds
    s_add_u32 m0, s81, 65536
    s_nop 0
    buffer_load_dwordx4 v6, s[8:11], s79 offen offset:1024 lds
    s_add_u32 m0, s81, 69632
    s_nop 0
    buffer_load_dwordx4 v34, s[8:11], s79 offen offset:1024 lds
    s_add_u32 m0, s81, 72704
    s_nop 0
    buffer_load_dwordx4 v6, s[8:11], s79 offen offset:2048 lds
    s_add_u32 m0, s81, 76800
    s_nop 0
    buffer_load_dwordx4 v34, s[8:11], s79 offen offset:2048 lds
    s_add_u32 m0, s101, 82944
    s_mov_b64 exec, 0xffff
    buffer_load_dwordx4 v7, s[4:7], s64 offen lds
    s_mov_b64 exec, -1
    s_cmp_eq_u32 s100, 5
    s_cbranch_scc0 L_nog12
    v_add_u32 v8, 83968, v8
    ds_read_b128 v[112:115], v8
    v_xor_b32 v9, 32, v8
    ds_read_b128 v[116:119], v9
    v_xor_b32 v9, 64, v8
    ds_read_b128 v[120:123], v9
    v_xor_b32 v9, 96, v8
    ds_read_b128 v[124:127], v9
    s_waitcnt lgkmcnt(0)
    v_mfma_f32_32x32x16_bf16 v[48:63], v[96:99], v[112:115], 0
    v_mfma_f32_32x32x16_bf16 v[48:63], v[100:103], v[116:119], v[48:63]
    v_mfma_f32_32x32x16_bf16 v[48:63], v[104:107], v[120:123], v[48:63]
    v_mfma_f32_32x32x16_bf16 v[48:63], v[108:111], v[124:127], v[48:63]
L_nog12:
    s_waitcnt vmcnt(11)
    s_barrier
    s_add_u32 m0, s81, 90112
    s_mov_b32 s96, 0
    buffer_load_dwordx4 v31, s[16:19], s96 offen lds
    s_add_u32 m0, s81, 94208
    s_mov_b32 s96, 32768
    buffer_load_dwordx4 v31, s[16:19], s96 offen lds
    s_add_u32 m0, s81, 98304
    s_mov_b32 s96, 65536
    buffer_load_dwordx4 v31, s[16:19], s96 offen lds
    s_add_u32 m0, s81, 102400
    s_mov_b32 s96, 98304
    buffer_load_dwordx4 v31, s[16:19], s96 offen lds
    s_add_u32 m0, s81, 106496
    s_mov_b32 s96, 131072
    buffer_load_dwordx4 v31, s[16:19], s96 offen lds
    s_add_u32 m0, s81, 110592
    s_mov_b32 s96, 163840
    buffer_load_dwordx4 v31, s[16:19], s96 offen lds
    s_add_u32 m0, s81, 114688
    s_mov_b32 s96, 196608
    buffer_load_dwordx4 v31, s[16:19], s96 offen lds
    s_add_u32 m0, s81, 118784
    s_mov_b32 s96, 229376
    buffer_load_dwordx4 v31, s[16:19], s96 offen lds
    s_cmp_eq_u32 s100, 6
    s_cbranch_scc0 L_nog13
    v_add_u32 v8, 0, v8
    ds_read_b128 v[112:115], v8
    v_xor_b32 v9, 32, v8
    ds_read_b128 v[116:119], v9
    v_xor_b32 v9, 64, v8
    ds_read_b128 v[120:123], v9
    v_xor_b32 v9, 96, v8
    ds_read_b128 v[124:127], v9
    s_waitcnt lgkmcnt(0)
    v_mfma_f32_32x32x16_bf16 v[48:63], v[96:99], v[112:115], 0
    v_mfma_f32_32x32x16_bf16 v[48:63], v[100:103], v[116:119], v[48:63]
    v_mfma_f32_32x32x16_bf16 v[48:63], v[104:107], v[120:123], v[48:63]
    v_mfma_f32_32x32x16_bf16 v[48:63], v[108:111], v[124:127], v[48:63]
L_nog13:
    s_load_dword s34, s[32:33], 0x0
    s_waitcnt vmcnt(8)
    s_barrier
    s_add_u32 m0, s81, 0
    s_mov_b32 s96, 262144
    buffer_load_dwordx4 v31, s[16:19], s96 offen lds
    s_add_u32 m0, s81, 4096
    s_mov_b32 s96, 294912
    buffer_load_dwordx4 v31, s[16:19], s96 offen lds
    s_add_u32 m0, s81, 8192
    s_mov_b32 s96, 327680
    buffer_load_dwordx4 v31, s[16:19], s96 offen lds
    s_add_u32 m0, s81, 12288
    s_mov_b32 s96, 360448
    buffer_load_dwordx4 v31, s[16:19], s96 offen lds
    s_add_u32 m0, s81, 16384
    s_mov_b32 s96, 393216
    buffer_load_dwordx4 v31, s[16:19], s96 offen lds
    s_add_u32 m0, s81, 20480
    s_mov_b32 s96, 425984
    buffer_load_dwordx4 v31, s[16:19], s96 offen lds
    s_add_u32 m0, s81, 24576
    s_mov_b32 s96, 458752
    buffer_load_dwordx4 v31, s[16:19], s96 offen lds
    s_add_u32 m0, s81, 28672
    s_mov_b32 s96, 491520
    buffer_load_dwordx4 v31, s[16:19], s96 offen lds
    buffer_store_dwordx4 v[36:39], v35, s[20:23], 0 offen offset:0 sc1
    buffer_store_dwordx4 v[36:39], v35, s[20:23], 0 offen offset:1024 sc1
    buffer_store_dwordx4 v[36:39], v35, s[20:23], 0 offen offset:2048 sc1
    buffer_store_dwordx4 v[36:39], v35, s[20:23], 0 offen offset:3072 sc1
    s_mov_b64 exec, 0xff
    buffer_store_dwordx4 v[36:39], v40, s[20:23], 0 offen sc1
    s_mov_b64 exec, -1
    s_cmp_eq_u32 s100, 7
    s_cbranch_scc0 L_nog14
    v_add_u32 v8, 41984, v8
    ds_read_b128 v[112:115], v8
    v_xor_b32 v9, 32, v8
    ds_read_b128 v[116:119], v9
    v_xor_b32 v9, 64, v8
    ds_read_b128 v[120:123], v9
    v_xor_b32 v9, 96, v8
    ds_read_b128 v[124:127], v9
    s_waitcnt lgkmcnt(0)
    v_mfma_f32_32x32x16_bf16 v[48:63], v[96:99], v[112:115], 0
    v_mfma_f32_32x32x16_bf16 v[48:63], v[100:103], v[116:119], v[48:63]
    v_mfma_f32_32x32x16_bf16 v[48:63], v[104:107], v[120:123], v[48:63]
    v_mfma_f32_32x32x16_bf16 v[48:63], v[108:111], v[124:127], v[48:63]
L_nog14:
    s_waitcnt lgkmcnt(0)
    s_setprio 0
    s_nop 9
    ds_write_b32 v23, v48
    s_waitcnt lgkmcnt(0)
    s_cmp_ge_u32 s34, 1
    s_cbranch_scc1 L_rdy15
    s_mov_b32 s97, 0
L_spin16:
    v_mov_b32 v220, 0
    global_load_dword v220, v220, s[32:33] sc1
    s_waitcnt vmcnt(0)
    v_cmp_eq_u32 vcc, 0, v220
    s_cbranch_vccz L_spun17
    s_add_u32 s97, s97, 1
    s_cmp_lt_u32 s97, 1048576
    s_cbranch_scc1 L_spin16
L_spun17:
L_rdy15:
    s_waitcnt lgkmcnt(0)
    s_barrier
    ds_read_b128 v[128:131], v22 offset:0
    ds_read_b128 v[136:139], v24 offset:256
    ds_read_b128 v[132:135], v22 offset:1024
    ds_read_b128 v[140:143], v24 offset:4608
    s_add_u32 m0, s81, 65536
    s_mov_b32 s96, 131072
    buffer_load_dwordx4 v31, s[12:15], s96 offen lds
    s_add_u32 m0, s81, 69632
    s_mov_b32 s96, 163840
    buffer_load_dwordx4 v31, s[12:15], s96 offen lds
    s_add_u32 m0, s81, 73728
    s_mov_b32 s96, 196608
    buffer_load_dwordx4 v31, s[12:15], s96 offen lds
    s_add_u32 m0, s81, 77824
    s_mov_b32 s96, 229376
    buffer_load_dwordx4 v31, s[12:15], s96 offen lds
    s_add_u32 m0, s81, 40960
    s_mov_b32 s96, 65536
    buffer_load_dwordx4 v31, s[12:15], s96 offen lds
    s_add_u32 m0, s81, 45056
    s_mov_b32 s96, 98304
    buffer_load_dwordx4 v31, s[12:15], s96 offen lds
    s_branch L_battn
L_bcomp:
    s_waitcnt lgkmcnt(0)
    s_and_b32 s87, s2, 6
    v_lshrrev_b32 v13, 3, v0
    s_bfe_u32 s83, s2, 0x10006
    v_and_b32 v12, 16, v0
    s_or_b32 s87, s87, s83
    s_mul_i32 s72, s64, 1536
    s_mov_b64 s[8:9], s[16:17]
    v_lshlrev_b32 v9, 4, v9
    s_lshl_b32 s83, s87, 7
    v_lshlrev_b32 v12, 2, v12
    s_mov_b32 s11, s7
    v_xor_b32 v12, v12, v9
    v_mul_u32_u24 v14, 3072, v13
    s_mov_b32 s10, 1572864
    v_add3_u32 v6, v14, v12, s83
    s_lshl_b32 s81, s88, 10
    v_add_u32 v4, 1024, v6
    s_load_dwordx2 s[28:29], s[0:1], 56
    s_load_dwordx2 s[20:21], s[0:1], 80
    s_load_dwordx2 s[12:13], s[0:1], 24
    s_load_dwordx2 s[16:17], s[0:1], 48
    s_load_dwordx2 s[24:25], s[0:1], 64
    s_load_dwordx2 s[32:33], s[0:1], 72
    v_and_b32 v1, 63, v0
    v_add_u32 v5, 2048, v6
    s_lshl_b32 s83, s82, 7
    v_lshl_add_u32 v31, v13, 10, v12
    s_and_b32 s89, s88, 1
    v_add_u32 v31, s83, v31
    s_lshl_b32 s89, s89, 5
    v_xor_b32 v31, s89, v31
    s_and_b32 s89, s88, 3
    s_lshr_b32 s90, s88, 2
    s_mov_b32 s22, 33554432
    s_mov_b32 s23, 0x20000
    s_mov_b32 s30, 1024
    s_mov_b32 s31, 0x20000
    s_and_b32 s92, s88, 1
    s_lshl_b32 s92, s92, 1
    s_xor_b32 s89, s90, 1
    s_add_u32 s89, s89, s92
    s_bfe_u32 s90, s88, 0x10001
    s_and_b32 s93, s88, 1
    s_lshl_b32 s93, s93, 13
    v_and_b32 v8, 15, v1
    v_lshrrev_b32 v220, 4, v1
    v_bfe_u32 v221, v1, 1, 3
    v_lshlrev_b32 v8, 7, v8
    v_xor_b32 v220, v220, v221
    v_lshl_or_b32 v8, v220, 4, v8
    v_add_u32 v8, s93, v8
    v_xor_b32 v9, 64, v8
    v_add_u32 v10, 0x10000, v8
    v_add_u32 v11, 0x10000, v9
    v_lshrrev_b32 v220, 4, v1
    v_bfe_u32 v221, v1, 2, 2
    v_lshl_add_u32 v221, v220, 3, v221
    v_lshlrev_b32 v16, 7, v221
    v_and_b32 v221, 3, v1
    v_lshl_or_b32 v16, v221, 3, v16
    v_bfe_u32 v221, v1, 3, 1
    v_lshl_or_b32 v16, v221, 6, v16
    v_and_b32 v221, 1, v220
    v_lshl_or_b32 v16, v221, 5, v16
    s_lshl_b32 s92, s90, 6
    v_xor_b32 v16, s92, v16
    v_xor_b32 v17, 32, v16
    v_add_u32 v18, 0x10000, v16
    v_add_u32 v19, 0x10000, v17
    s_waitcnt lgkmcnt(0)
    s_lshl_b32 s100, s88, 8
    s_add_u32 s100, s100, s2
    s_cmp_eq_u32 s100, 1920
    s_cbranch_scc0 L_noclear
    v_mov_b32 v220, 0
    v_lshlrev_b32 v224, 7, v1
    s_mov_b32 s92, 6029312
    buffer_store_dword v220, v224, s[20:23], s92 offen sc1
    buffer_store_dword v220, v224, s[20:23], s92 offen offset:64 sc1
    s_mov_b32 s92, 6037504
    buffer_store_dword v220, v224, s[20:23], s92 offen sc1
    buffer_store_dword v220, v224, s[20:23], s92 offen offset:64 sc1
    s_mov_b32 s92, 6045696
    buffer_store_dword v220, v224, s[20:23], s92 offen sc1
    buffer_store_dword v220, v224, s[20:23], s92 offen offset:64 sc1
    s_mov_b32 s92, 6053888
    buffer_store_dword v220, v224, s[20:23], s92 offen sc1
    buffer_store_dword v220, v224, s[20:23], s92 offen offset:64 sc1
    s_mov_b32 s92, 6062080
    buffer_store_dword v220, v224, s[20:23], s92 offen sc1
    buffer_store_dword v220, v224, s[20:23], s92 offen offset:64 sc1
L_noclear:
    s_mov_b32 s14, 524288
    s_mov_b32 s15, 0x20000
    s_mov_b32 s18, 524288
    s_mov_b32 s19, 0x20000
    s_and_b32 s92, s86, 7
    s_lshl_b32 s92, s92, 6
    v_add_u32 v220, s92, v1
    s_lshl_b32 s82, s87, 7
    v_lshlrev_b32 v220, 10, v220
    s_lshr_b32 s92, s86, 3
    s_add_u32 s92, s92, 5
    s_cmp_eq_u32 s88, s92
    s_cbranch_scc0 L_warm4
    s_cmp_eq_u32 s88, 5
    s_cbranch_scc1 L_warm3
    buffer_load_dword v231, v220, s[16:19], s82 offen
    s_branch L_warm4
L_warm3:
    buffer_load_dword v231, v220, s[12:15], s82 offen
L_warm4:
    s_mov_b32 s35, 1
    s_mov_b32 s14, 524288
    s_mov_b32 s15, 0x20000
    s_mov_b32 s18, 524288
    s_mov_b32 s19, 0x20000
    s_mov_b32 s26, 2097152
    s_mov_b32 s27, 0x20000
    s_mov_b32 s84, 0x3fb8aa3b
    s_mov_b32 s85, 0x3fb8aa3b
    s_mov_b32 s35, 1
    v_and_b32 v221, 7, v1
    s_lshl_b32 s92, s86, 3
    s_add_u32 s92, s92, s87
    s_lshl_b32 s92, s92, 9
    s_lshl_b32 s82, s89, 7
    s_add_u32 s92, s92, s82
    s_add_u32 s92, s92, 5963776
    v_lshlrev_b32 v30, 2, v1
    v_add_u32 v29, s92, v30
    v_mov_b32 v224, 0x7ffffff0
    s_cmp_eq_u32 s90, 0
    s_cselect_b32 s92, 32, 0
    v_cmp_gt_u32 vcc, s92, v1
    s_nop 1
    v_cndmask_b32 v29, v224, v29, vcc
    s_lshl_b32 s92, s89, 8
    s_add_u32 s92, s92, 162304
    v_add_u32 v30, s92, v30
    s_mul_i32 s92, s90, 8704
    s_lshl_b32 s82, s89, 10
    s_add_u32 s92, s92, s82
    s_add_u32 s92, s92, 125952
    v_lshrrev_b32 v222, 5, v1
    v_and_b32 v223, 31, v1
    v_lshlrev_b32 v24, 5, v223
    v_lshl_or_b32 v24, v222, 4, v24
    v_add_u32 v24, s92, v24
    v_lshlrev_b32 v26, 5, v221
    v_lshl_or_b32 v26, v222, 4, v26
    v_add_u32 v26, s92, v26
    v_and_b32 v224, 4, v1
    v_lshlrev_b32 v224, 2, v224
    v_xor_b32 v24, v24, v224
    v_xor_b32 v26, v26, v224
    v_bfe_u32 v224, v1, 2, 2
    v_lshl_add_u32 v224, v222, 2, v224
    v_lshlrev_b32 v27, 5, v224
    v_and_b32 v224, 1, v1
    v_lshl_or_b32 v27, v224, 4, v27
    v_bfe_u32 v224, v1, 1, 1
    v_lshl_or_b32 v27, v224, 3, v27
    v_lshlrev_b32 v224, 4, v222
    v_xor_b32 v27, v27, v224
    v_bfe_u32 v224, v1, 4, 1
    v_mul_u32_u24 v224, 4352, v224
    v_add3_u32 v27, v27, v224, s92
    s_and_b32 s92, s88, 3
    s_lshl_b32 s92, s92, 11
    s_add_u32 s92, s92, 32768
    v_lshlrev_b32 v22, 4, v1
    v_add_u32 v22, s92, v22
    s_lshl_b32 s92, s86, 2
    s_add_u32 s92, s92, s89
    s_lshl_b32 s82, s87, 1
    s_add_u32 s82, s82, s90
    s_mul_i32 s83, s92, 41984
    s_lshl_b32 s93, s82, 11
    s_add_u32 s83, s83, s93
    s_add_u32 s83, s83, 2686976
    v_lshlrev_b32 v28, 4, v1
    v_add_u32 v28, s83, v28
    s_lshl_b32 s92, s92, 8
    s_lshr_b32 s83, s87, 2
    s_lshl_b32 s83, s83, 7
    s_add_u32 s92, s92, s83
    s_add_u32 s99, s92, 6049792
    v_lshlrev_b32 v222, 2, v222
    v_sub_u32 v222, v223, v222
    s_lshr_b32 s92, s86, 1
    s_or_b32 s92, s92, s89
    s_cmp_eq_u32 s92, 0
    s_cselect_b32 s92, 1000, 8
    v_add_u32 v223, s92, v222
    v_mov_b32 v224, 0xf149f2ca
    v_mov_b32 v225, 0xffff
    v_mov_b32 v226, 0xffff0000
    v_mov_b32 v230, 0
    v_subrev_u32 v228, 0, v222
    v_cmp_ge_u32 vcc, 7, v228
    s_nop 1
    v_cndmask_b32 v188, v224, v230, vcc
    v_cndmask_b32 v208, 0, v225, vcc
    v_subrev_u32 v228, 1, v222
    v_cmp_ge_u32 vcc, 7, v228
    s_nop 1
    v_cndmask_b32 v189, v224, v230, vcc
    v_cndmask_b32 v229, 0, v226, vcc
    v_or_b32 v208, v208, v229
    v_subrev_u32 v228, 2, v222
    v_cmp_ge_u32 vcc, 7, v228
    s_nop 1
    v_cndmask_b32 v190, v224, v230, vcc
    v_cndmask_b32 v209, 0, v225, vcc
    v_subrev_u32 v228, 3, v222
    v_cmp_ge_u32 vcc, 7, v228
    s_nop 1
    v_cndmask_b32 v191, v224, v230, vcc
    v_cndmask_b32 v229, 0, v226, vcc
    v_or_b32 v209, v209, v229
    v_subrev_u32 v228, 8, v222
    v_cmp_ge_u32 vcc, 7, v228
    s_nop 1
    v_cndmask_b32 v192, v224, v230, vcc
    v_cndmask_b32 v210, 0, v225, vcc
    v_subrev_u32 v228, 9, v222
    v_cmp_ge_u32 vcc, 7, v228
    s_nop 1
    v_cndmask_b32 v193, v224, v230, vcc
    v_cndmask_b32 v229, 0, v226, vcc
    v_or_b32 v210, v210, v229
    v_subrev_u32 v228, 10, v222
    v_cmp_ge_u32 vcc, 7, v228
    s_nop 1
    v_cndmask_b32 v194, v224, v230, vcc
    v_cndmask_b32 v211, 0, v225, vcc
    v_subrev_u32 v228, 11, v222
    v_cmp_ge_u32 vcc, 7, v228
    s_nop 1
    v_cndmask_b32 v195, v224, v230, vcc
    v_cndmask_b32 v229, 0, v226, vcc
    v_or_b32 v211, v211, v229
    v_subrev_u32 v228, 16, v222
    v_cmp_ge_u32 vcc, 7, v228
    s_nop 1
    v_cndmask_b32 v196, v224, v230, vcc
    v_cndmask_b32 v212, 0, v225, vcc
    v_subrev_u32 v228, 17, v222
    v_cmp_ge_u32 vcc, 7, v228
    s_nop 1
    v_cndmask_b32 v197, v224, v230, vcc
    v_cndmask_b32 v229, 0, v226, vcc
    v_or_b32 v212, v212, v229
    v_subrev_u32 v228, 18, v222
    v_cmp_ge_u32 vcc, 7, v228
    s_nop 1
    v_cndmask_b32 v198, v224, v230, vcc
    v_cndmask_b32 v213, 0, v225, vcc
    v_subrev_u32 v228, 19, v222
    v_cmp_ge_u32 vcc, 7, v228
    s_nop 1
    v_cndmask_b32 v199, v224, v230, vcc
    v_cndmask_b32 v229, 0, v226, vcc
    v_or_b32 v213, v213, v229
    v_subrev_u32 v228, 24, v222
    v_cmp_ge_u32 vcc, 7, v228
    s_nop 1
    v_cndmask_b32 v200, v224, v230, vcc
    v_cndmask_b32 v214, 0, v225, vcc
    v_subrev_u32 v228, 25, v222
    v_cmp_ge_u32 vcc, 7, v228
    s_nop 1
    v_cndmask_b32 v201, v224, v230, vcc
    v_cndmask_b32 v229, 0, v226, vcc
    v_or_b32 v214, v214, v229
    v_subrev_u32 v228, 26, v222
    v_cmp_ge_u32 vcc, 7, v228
    s_nop 1
    v_cndmask_b32 v202, v224, v230, vcc
    v_cndmask_b32 v215, 0, v225, vcc
    v_subrev_u32 v228, 27, v222
    v_cmp_ge_u32 vcc, 7, v228
    s_nop 1
    v_cndmask_b32 v203, v224, v230, vcc
    v_cndmask_b32 v229, 0, v226, vcc
    v_or_b32 v215, v215, v229
    v_subrev_u32 v228, 0, v223
    v_cmp_ge_u32 vcc, 7, v228
    s_nop 1
    v_cndmask_b32 v204, v224, v230, vcc
    v_cndmask_b32 v216, 0, v225, vcc
    v_subrev_u32 v228, 1, v223
    v_cmp_ge_u32 vcc, 7, v228
    s_nop 1
    v_cndmask_b32 v205, v224, v230, vcc
    v_cndmask_b32 v229, 0, v226, vcc
    v_or_b32 v216, v216, v229
    v_subrev_u32 v228, 2, v223
    v_cmp_ge_u32 vcc, 7, v228
    s_nop 1
    v_cndmask_b32 v206, v224, v230, vcc
    v_cndmask_b32 v217, 0, v225, vcc
    v_subrev_u32 v228, 3, v223
    v_cmp_ge_u32 vcc, 7, v228
    s_nop 1
    v_cndmask_b32 v207, v224, v230, vcc
    v_cndmask_b32 v229, 0, v226, vcc
    v_or_b32 v217, v217, v229
    s_and_b32 s94, s2, 7
    s_lshr_b32 s92, s2, 7
    s_lshl1_add_u32 s94, s94, s92
    s_bfe_u32 s95, s2, 0x10006
    s_bfe_u32 s92, s88, 0x10001
    s_lshl1_add_u32 s95, s95, s92
    s_and_b32 s71, s88, 1
    s_mov_b32 s3, 0
    s_mul_i32 s65, s71, 90112
    s_add_u32 s65, s65, 32768
    s_mul_i32 s66, s71, 73728
    s_add_u32 s66, s66, 65536
    s_mov_b32 s83, 0
    s_lshl_b32 s92, s94, 2
    s_add_u32 s92, s92, s95
    s_mul_i32 s82, s92, 41984
    s_add_u32 s83, s83, s82
    s_lshl_b32 s82, s71, 14
    s_add_u32 s67, s83, s82
    s_lshl_b32 s92, s92, 8
    s_lshl_b32 s82, s3, 14
    s_add_u32 s92, s92, s82
    s_lshl_b32 s82, s71, 7
    s_add_u32 s92, s92, s82
    s_add_u32 s70, s92, 6033408
    s_lshl_b32 s92, s94, 1
    s_add_u32 s92, s92, s71
    s_lshl_b32 s92, s92, 11
    s_lshl_b32 s82, s95, 7
    s_add_u32 s92, s92, s82
    s_add_u32 s68, s92, 5963776
    s_lshr_b32 s92, s94, 1
    s_lshl_b32 s92, s92, 8
    s_and_b32 s82, s94, 1
    s_or_b32 s92, s92, s82
    s_lshl_b32 s82, s95, 6
    s_add_u32 s92, s92, s82
    s_lshl_b32 s92, s92, 10
    s_bfe_u32 s82, s2, 0x30003
    s_lshl_b32 s82, s82, 7
    s_add_u32 s92, s92, s82
    s_lshl_b32 s82, s71, 15
    s_add_u32 s69, s92, s82
    s_lshl_b32 s82, s71, 8
    s_add_u32 s67, s67, s82
    s_sub_u32 s66, s66, s65
    s_lshl_b32 s71, s71, 6
    s_and_b32 s92, s88, 3
    s_lshl_b32 s94, s92, 12
    s_add_u32 s94, s94, 0
    s_lshl_b32 s92, s92, 8
    s_add_u32 s95, s92, 161280
    v_lshrrev_b32 v220, 4, v1
    v_bfe_u32 v221, v1, 2, 2
    v_lshl_add_u32 v221, v220, 3, v221
    v_lshlrev_b32 v222, 7, v221
    v_and_b32 v221, 3, v1
    v_lshl_or_b32 v222, v221, 3, v222
    v_bfe_u32 v221, v1, 3, 1
    v_lshl_or_b32 v222, v221, 6, v222
    v_and_b32 v221, 1, v220
    v_lshl_or_b32 v222, v221, 5, v222
    v_add_u32 v240, s65, v222
    v_xor_b32 v241, 32, v240
    v_xor_b32 v242, 64, v240
    v_xor_b32 v243, 0x60, v240
    v_lshlrev_b32 v220, 4, v1
    v_add_u32 v248, s94, v220
    v_xor_b32 v247, 0x1000, v248
    v_lshlrev_b32 v220, 2, v1
    v_add_u32 v250, s95, v220
    v_xor_b32 v251, 0x100, v250
    v_mov_b32 v221, -1
    ds_write_b32 v250, v221
    v_and_b32 v249, 15, v1
    v_lshrrev_b32 v220, 4, v1
    v_lshlrev_b32 v246, 9, v220
    v_lshl_or_b32 v244, v249, 4, v246
    v_add_u32 v244, s67, v244
    v_xor_b32 v245, 0x100, v244
    v_lshl_or_b32 v246, v249, 2, v246
    v_or_b32 v246, s71, v246
    v_lshlrev_b32 v249, 11, v249
    v_and_b32 v220, 1, v220
    v_lshl_or_b32 v249, v220, 5, v249
    v_lshrrev_b32 v220, 5, v1
    v_lshl_or_b32 v249, v220, 4, v249
    v_lshrrev_b32 v220, 4, v1
    v_and_b32 v221, 7, v1
    v_and_b32 v222, 6, v1
    v_xor_b32 v222, v222, v220
    v_lshlrev_b32 v12, 7, v221
    v_lshl_or_b32 v12, v222, 4, v12
    v_xor_b32 v13, 64, v12
    v_add_u32 v14, 0x10000, v12
    v_add_u32 v15, 0x10000, v13
    v_lshlrev_b32 v25, 5, v221
    v_lshl_or_b32 v25, v220, 3, v25
    s_and_b32 s92, s88, 3
    s_mul_i32 s92, s92, 4352
    s_add_u32 s92, s92, 125952
    v_add_u32 v25, s92, v25
    v_and_b32 v220, 4, v1
    v_lshlrev_b32 v220, 2, v220
    v_xor_b32 v25, v25, v220
    s_bitcmp1_b32 s88, 0
    s_cbranch_scc1 L_bodd
    s_barrier
    s_setprio 2
    ds_read_b128 v[128:131], v8 offset:0
    ds_read_b128 v[132:135], v8 offset:2048
    ds_read_b64_tr_b16 v[160:161], v16 offset:24576
    ds_read_b64_tr_b16 v[162:163], v16 offset:25088
    ds_read_b128 v[136:139], v8 offset:4096
    ds_read_b128 v[140:143], v8 offset:6144
    ds_read_b64_tr_b16 v[164:165], v17 offset:24576
    ds_read_b64_tr_b16 v[166:167], v17 offset:25088
    ds_read_b64_tr_b16 v[168:169], v16 offset:16384
    ds_read_b64_tr_b16 v[170:171], v16 offset:16896
    ds_read_b64_tr_b16 v[172:173], v17 offset:16384
    ds_read_b64_tr_b16 v[174:175], v17 offset:16896
    s_waitcnt lgkmcnt(4)
    v_mfma_f32_16x16x32_bf16 v[64:67], v[160:163], v[128:131], 0
    ds_read_b128 v[184:187], v12 offset:40960
    v_mfma_f32_16x16x32_bf16 v[68:71], v[160:163], v[132:135], 0
    ds_read_b64_tr_b16 v[176:177], v16 offset:32768
    v_mfma_f32_16x16x32_bf16 v[80:83], v[160:163], v[136:139], 0
    ds_read_b64_tr_b16 v[178:179], v16 offset:33280
    v_mfma_f32_16x16x32_bf16 v[84:87], v[160:163], v[140:143], 0
    ds_read_b64_tr_b16 v[180:181], v17 offset:32768
    v_mfma_f32_16x16x32_bf16 v[72:75], v[164:167], v[128:131], 0
    ds_read_b64_tr_b16 v[182:183], v17 offset:33280
    v_mfma_f32_16x16x32_bf16 v[76:79], v[164:167], v[132:135], 0
    v_mfma_f32_16x16x32_bf16 v[88:91], v[164:167], v[136:139], 0
    v_mfma_f32_16x16x32_bf16 v[92:95], v[164:167], v[140:143], 0
    s_waitcnt lgkmcnt(4)
    v_mfma_f32_16x16x32_bf16 v[232:235], v[160:163], v[184:187], 0
    v_mfma_f32_16x16x32_bf16 v[32:35], v[168:171], v[128:131], 0
    ds_read_b128 v[144:147], v9 offset:0
    v_mfma_f32_16x16x32_bf16 v[36:39], v[168:171], v[132:135], 0
    ds_read_b128 v[148:151], v9 offset:2048
    v_mfma_f32_16x16x32_bf16 v[48:51], v[168:171], v[136:139], 0
    ds_read_b64_tr_b16 v[160:161], v16 offset:28672
    v_mfma_f32_16x16x32_bf16 v[52:55], v[168:171], v[140:143], 0
    ds_read_b64_tr_b16 v[162:163], v16 offset:29184
    v_mfma_f32_16x16x32_bf16 v[40:43], v[172:175], v[128:131], 0
    ds_read_b128 v[152:155], v9 offset:4096
    v_mfma_f32_16x16x32_bf16 v[44:47], v[172:175], v[132:135], 0
    ds_read_b128 v[156:159], v9 offset:6144
    v_mfma_f32_16x16x32_bf16 v[56:59], v[172:175], v[136:139], 0
    ds_read_b64_tr_b16 v[164:165], v17 offset:28672
    v_mfma_f32_16x16x32_bf16 v[60:63], v[172:175], v[140:143], 0
    ds_read_b64_tr_b16 v[166:167], v17 offset:29184
    s_waitcnt lgkmcnt(8)
    v_mfma_f32_16x16x32_bf16 v[96:99], v[176:179], v[128:131], 0
    ds_read_b64_tr_b16 v[168:169], v16 offset:20480
    v_mfma_f32_16x16x32_bf16 v[100:103], v[176:179], v[132:135], 0
    ds_read_b64_tr_b16 v[170:171], v16 offset:20992
    v_mfma_f32_16x16x32_bf16 v[112:115], v[176:179], v[136:139], 0
    v_mfma_f32_16x16x32_bf16 v[116:119], v[176:179], v[140:143], 0
    v_mfma_f32_16x16x32_bf16 v[104:107], v[180:183], v[128:131], 0
    ds_read_b64_tr_b16 v[172:173], v17 offset:20480
    v_mfma_f32_16x16x32_bf16 v[108:111], v[180:183], v[132:135], 0
    ds_read_b64_tr_b16 v[174:175], v17 offset:20992
    v_mfma_f32_16x16x32_bf16 v[120:123], v[180:183], v[136:139], 0
    v_mfma_f32_16x16x32_bf16 v[124:127], v[180:183], v[140:143], 0
    v_mfma_f32_16x16x32_bf16 v[236:239], v[176:179], v[184:187], 0
    s_waitcnt lgkmcnt(4)
    v_mfma_f32_16x16x32_bf16 v[64:67], v[160:163], v[144:147], v[64:67]
    ds_read_b128 v[184:187], v13 offset:40960
    v_mfma_f32_16x16x32_bf16 v[68:71], v[160:163], v[148:151], v[68:71]
    ds_read_b64_tr_b16 v[176:177], v16 offset:36864
    v_mfma_f32_16x16x32_bf16 v[80:83], v[160:163], v[152:155], v[80:83]
    ds_read_b64_tr_b16 v[178:179], v16 offset:37376
    v_mfma_f32_16x16x32_bf16 v[84:87], v[160:163], v[156:159], v[84:87]
    ds_read_b64_tr_b16 v[180:181], v17 offset:36864
    v_mfma_f32_16x16x32_bf16 v[72:75], v[164:167], v[144:147], v[72:75]
    ds_read_b64_tr_b16 v[182:183], v17 offset:37376
    v_mfma_f32_16x16x32_bf16 v[76:79], v[164:167], v[148:151], v[76:79]
    v_mfma_f32_16x16x32_bf16 v[88:91], v[164:167], v[152:155], v[88:91]
    v_mfma_f32_16x16x32_bf16 v[92:95], v[164:167], v[156:159], v[92:95]
    s_waitcnt lgkmcnt(4)
    v_mfma_f32_16x16x32_bf16 v[232:235], v[160:163], v[184:187], v[232:235]
    s_waitcnt lgkmcnt(0)
    s_barrier
    v_mfma_f32_16x16x32_bf16 v[32:35], v[168:171], v[144:147], v[32:35]
    ds_read_b128 v[128:131], v8 offset:41984
    v_mfma_f32_16x16x32_bf16 v[36:39], v[168:171], v[148:151], v[36:39]
    ds_read_b128 v[132:135], v8 offset:44032
    v_mfma_f32_16x16x32_bf16 v[48:51], v[168:171], v[152:155], v[48:51]
    ds_read_b64_tr_b16 v[160:161], v18 offset:1024
    v_mfma_f32_16x16x32_bf16 v[52:55], v[168:171], v[156:159], v[52:55]
    ds_read_b64_tr_b16 v[162:163], v18 offset:1536
    v_mfma_f32_16x16x32_bf16 v[40:43], v[172:175], v[144:147], v[40:43]
    ds_read_b128 v[136:139], v8 offset:46080
    v_mfma_f32_16x16x32_bf16 v[44:47], v[172:175], v[148:151], v[44:47]
    ds_read_b128 v[140:143], v8 offset:48128
    v_mfma_f32_16x16x32_bf16 v[56:59], v[172:175], v[152:155], v[56:59]
    ds_read_b64_tr_b16 v[164:165], v19 offset:1024
    v_mfma_f32_16x16x32_bf16 v[60:63], v[172:175], v[156:159], v[60:63]
    ds_read_b64_tr_b16 v[166:167], v19 offset:1536
    v_mfma_f32_16x16x32_bf16 v[96:99], v[176:179], v[144:147], v[96:99]
    ds_read_b64_tr_b16 v[168:169], v16 offset:58368
    v_mfma_f32_16x16x32_bf16 v[100:103], v[176:179], v[148:151], v[100:103]
    ds_read_b64_tr_b16 v[170:171], v16 offset:58880
    v_mfma_f32_16x16x32_bf16 v[112:115], v[176:179], v[152:155], v[112:115]
    v_mfma_f32_16x16x32_bf16 v[116:119], v[176:179], v[156:159], v[116:119]
    v_mfma_f32_16x16x32_bf16 v[104:107], v[180:183], v[144:147], v[104:107]
    ds_read_b64_tr_b16 v[172:173], v17 offset:58368
    v_mfma_f32_16x16x32_bf16 v[108:111], v[180:183], v[148:151], v[108:111]
    ds_read_b64_tr_b16 v[174:175], v17 offset:58880
    v_mfma_f32_16x16x32_bf16 v[120:123], v[180:183], v[152:155], v[120:123]
    v_mfma_f32_16x16x32_bf16 v[124:127], v[180:183], v[156:159], v[124:127]
    v_mfma_f32_16x16x32_bf16 v[236:239], v[176:179], v[184:187], v[236:239]
    s_waitcnt lgkmcnt(4)
    v_mfma_f32_16x16x32_bf16 v[64:67], v[160:163], v[128:131], v[64:67]
    ds_read_b128 v[184:187], v14 offset:17408
    v_mfma_f32_16x16x32_bf16 v[68:71], v[160:163], v[132:135], v[68:71]
    ds_read_b64_tr_b16 v[176:177], v18 offset:9216
    v_mfma_f32_16x16x32_bf16 v[80:83], v[160:163], v[136:139], v[80:83]
    ds_read_b64_tr_b16 v[178:179], v18 offset:9728
    v_mfma_f32_16x16x32_bf16 v[84:87], v[160:163], v[140:143], v[84:87]
    ds_read_b64_tr_b16 v[180:181], v19 offset:9216
    v_mfma_f32_16x16x32_bf16 v[72:75], v[164:167], v[128:131], v[72:75]
    ds_read_b64_tr_b16 v[182:183], v19 offset:9728
    v_mfma_f32_16x16x32_bf16 v[76:79], v[164:167], v[132:135], v[76:79]
    v_mfma_f32_16x16x32_bf16 v[88:91], v[164:167], v[136:139], v[88:91]
    v_mfma_f32_16x16x32_bf16 v[92:95], v[164:167], v[140:143], v[92:95]
    s_waitcnt lgkmcnt(4)
    v_mfma_f32_16x16x32_bf16 v[232:235], v[160:163], v[184:187], v[232:235]
    v_mfma_f32_16x16x32_bf16 v[32:35], v[168:171], v[128:131], v[32:35]
    ds_read_b128 v[144:147], v9 offset:41984
    v_mfma_f32_16x16x32_bf16 v[36:39], v[168:171], v[132:135], v[36:39]
    ds_read_b128 v[148:151], v9 offset:44032
    v_mfma_f32_16x16x32_bf16 v[48:51], v[168:171], v[136:139], v[48:51]
    ds_read_b64_tr_b16 v[160:161], v18 offset:5120
    v_mfma_f32_16x16x32_bf16 v[52:55], v[168:171], v[140:143], v[52:55]
    ds_read_b64_tr_b16 v[162:163], v18 offset:5632
    v_mfma_f32_16x16x32_bf16 v[40:43], v[172:175], v[128:131], v[40:43]
    ds_read_b128 v[152:155], v9 offset:46080
    v_mfma_f32_16x16x32_bf16 v[44:47], v[172:175], v[132:135], v[44:47]
    ds_read_b128 v[156:159], v9 offset:48128
    v_mfma_f32_16x16x32_bf16 v[56:59], v[172:175], v[136:139], v[56:59]
    ds_read_b64_tr_b16 v[164:165], v19 offset:5120
    v_mfma_f32_16x16x32_bf16 v[60:63], v[172:175], v[140:143], v[60:63]
    ds_read_b64_tr_b16 v[166:167], v19 offset:5632
    s_waitcnt lgkmcnt(8)
    v_mfma_f32_16x16x32_bf16 v[96:99], v[176:179], v[128:131], v[96:99]
    ds_read_b64_tr_b16 v[168:169], v16 offset:62464
    v_mfma_f32_16x16x32_bf16 v[100:103], v[176:179], v[132:135], v[100:103]
    ds_read_b64_tr_b16 v[170:171], v16 offset:62976
    v_mfma_f32_16x16x32_bf16 v[112:115], v[176:179], v[136:139], v[112:115]
    v_mfma_f32_16x16x32_bf16 v[116:119], v[176:179], v[140:143], v[116:119]
    v_mfma_f32_16x16x32_bf16 v[104:107], v[180:183], v[128:131], v[104:107]
    ds_read_b64_tr_b16 v[172:173], v17 offset:62464
    v_mfma_f32_16x16x32_bf16 v[108:111], v[180:183], v[132:135], v[108:111]
    ds_read_b64_tr_b16 v[174:175], v17 offset:62976
    v_mfma_f32_16x16x32_bf16 v[120:123], v[180:183], v[136:139], v[120:123]
    v_mfma_f32_16x16x32_bf16 v[124:127], v[180:183], v[140:143], v[124:127]
    v_mfma_f32_16x16x32_bf16 v[236:239], v[176:179], v[184:187], v[236:239]
    s_waitcnt lgkmcnt(4)
    v_mfma_f32_16x16x32_bf16 v[64:67], v[160:163], v[144:147], v[64:67]
    ds_read_b128 v[184:187], v15 offset:17408
    v_mfma_f32_16x16x32_bf16 v[68:71], v[160:163], v[148:151], v[68:71]
    ds_read_b64_tr_b16 v[176:177], v18 offset:13312
    v_mfma_f32_16x16x32_bf16 v[80:83], v[160:163], v[152:155], v[80:83]
    ds_read_b64_tr_b16 v[178:179], v18 offset:13824
    v_mfma_f32_16x16x32_bf16 v[84:87], v[160:163], v[156:159], v[84:87]
    ds_read_b64_tr_b16 v[180:181], v19 offset:13312
    v_mfma_f32_16x16x32_bf16 v[72:75], v[164:167], v[144:147], v[72:75]
    ds_read_b64_tr_b16 v[182:183], v19 offset:13824
    v_mfma_f32_16x16x32_bf16 v[76:79], v[164:167], v[148:151], v[76:79]
    v_mfma_f32_16x16x32_bf16 v[88:91], v[164:167], v[152:155], v[88:91]
    v_mfma_f32_16x16x32_bf16 v[92:95], v[164:167], v[156:159], v[92:95]
    s_waitcnt lgkmcnt(4)
    v_mfma_f32_16x16x32_bf16 v[232:235], v[160:163], v[184:187], v[232:235]
    s_waitcnt lgkmcnt(0)
    s_barrier
    v_mfma_f32_16x16x32_bf16 v[32:35], v[168:171], v[144:147], v[32:35]
    ds_read_b128 v[128:131], v10 offset:18432
    v_mfma_f32_16x16x32_bf16 v[36:39], v[168:171], v[148:151], v[36:39]
    ds_read_b128 v[132:135], v10 offset:20480
    v_mfma_f32_16x16x32_bf16 v[48:51], v[168:171], v[152:155], v[48:51]
    ds_read_b64_tr_b16 v[160:161], v18 offset:43008
    v_mfma_f32_16x16x32_bf16 v[52:55], v[168:171], v[156:159], v[52:55]
    ds_read_b64_tr_b16 v[162:163], v18 offset:43520
    v_mfma_f32_16x16x32_bf16 v[40:43], v[172:175], v[144:147], v[40:43]
    ds_read_b128 v[136:139], v10 offset:22528
    v_mfma_f32_16x16x32_bf16 v[44:47], v[172:175], v[148:151], v[44:47]
    ds_read_b128 v[140:143], v10 offset:24576
    v_mfma_f32_16x16x32_bf16 v[56:59], v[172:175], v[152:155], v[56:59]
    ds_read_b64_tr_b16 v[164:165], v19 offset:43008
    v_mfma_f32_16x16x32_bf16 v[60:63], v[172:175], v[156:159], v[60:63]
    ds_read_b64_tr_b16 v[166:167], v19 offset:43520
    v_mfma_f32_16x16x32_bf16 v[96:99], v[176:179], v[144:147], v[96:99]
    ds_read_b64_tr_b16 v[168:169], v18 offset:34816
    v_mfma_f32_16x16x32_bf16 v[100:103], v[176:179], v[148:151], v[100:103]
    ds_read_b64_tr_b16 v[170:171], v18 offset:35328
    v_mfma_f32_16x16x32_bf16 v[112:115], v[176:179], v[152:155], v[112:115]
    v_mfma_f32_16x16x32_bf16 v[116:119], v[176:179], v[156:159], v[116:119]
    v_mfma_f32_16x16x32_bf16 v[104:107], v[180:183], v[144:147], v[104:107]
    ds_read_b64_tr_b16 v[172:173], v19 offset:34816
    v_mfma_f32_16x16x32_bf16 v[108:111], v[180:183], v[148:151], v[108:111]
    ds_read_b64_tr_b16 v[174:175], v19 offset:35328
    v_mfma_f32_16x16x32_bf16 v[120:123], v[180:183], v[152:155], v[120:123]
    v_mfma_f32_16x16x32_bf16 v[124:127], v[180:183], v[156:159], v[124:127]
    v_mfma_f32_16x16x32_bf16 v[236:239], v[176:179], v[184:187], v[236:239]
    s_waitcnt lgkmcnt(4)
    v_mfma_f32_16x16x32_bf16 v[64:67], v[160:163], v[128:131], v[64:67]
    ds_read_b128 v[184:187], v14 offset:59392
    v_mfma_f32_16x16x32_bf16 v[68:71], v[160:163], v[132:135], v[68:71]
    ds_read_b64_tr_b16 v[176:177], v18 offset:51200
    v_mfma_f32_16x16x32_bf16 v[80:83], v[160:163], v[136:139], v[80:83]
    ds_read_b64_tr_b16 v[178:179], v18 offset:51712
    v_mfma_f32_16x16x32_bf16 v[84:87], v[160:163], v[140:143], v[84:87]
    ds_read_b64_tr_b16 v[180:181], v19 offset:51200
    v_mfma_f32_16x16x32_bf16 v[72:75], v[164:167], v[128:131], v[72:75]
    ds_read_b64_tr_b16 v[182:183], v19 offset:51712
    v_mfma_f32_16x16x32_bf16 v[76:79], v[164:167], v[132:135], v[76:79]
    v_mfma_f32_16x16x32_bf16 v[88:91], v[164:167], v[136:139], v[88:91]
    v_mfma_f32_16x16x32_bf16 v[92:95], v[164:167], v[140:143], v[92:95]
    s_waitcnt lgkmcnt(4)
    v_mfma_f32_16x16x32_bf16 v[232:235], v[160:163], v[184:187], v[232:235]
    v_mfma_f32_16x16x32_bf16 v[32:35], v[168:171], v[128:131], v[32:35]
    ds_read_b128 v[144:147], v11 offset:18432
    v_mfma_f32_16x16x32_bf16 v[36:39], v[168:171], v[132:135], v[36:39]
    ds_read_b128 v[148:151], v11 offset:20480
    v_mfma_f32_16x16x32_bf16 v[48:51], v[168:171], v[136:139], v[48:51]
    ds_read_b64_tr_b16 v[160:161], v18 offset:47104
    v_mfma_f32_16x16x32_bf16 v[52:55], v[168:171], v[140:143], v[52:55]
    ds_read_b64_tr_b16 v[162:163], v18 offset:47616
    v_mfma_f32_16x16x32_bf16 v[40:43], v[172:175], v[128:131], v[40:43]
    ds_read_b128 v[152:155], v11 offset:22528
    v_mfma_f32_16x16x32_bf16 v[44:47], v[172:175], v[132:135], v[44:47]
    ds_read_b128 v[156:159], v11 offset:24576
    v_mfma_f32_16x16x32_bf16 v[56:59], v[172:175], v[136:139], v[56:59]
    ds_read_b64_tr_b16 v[164:165], v19 offset:47104
    v_mfma_f32_16x16x32_bf16 v[60:63], v[172:175], v[140:143], v[60:63]
    ds_read_b64_tr_b16 v[166:167], v19 offset:47616
    s_waitcnt lgkmcnt(8)
    v_mfma_f32_16x16x32_bf16 v[96:99], v[176:179], v[128:131], v[96:99]
    ds_read_b64_tr_b16 v[168:169], v18 offset:38912
    v_mfma_f32_16x16x32_bf16 v[100:103], v[176:179], v[132:135], v[100:103]
    ds_read_b64_tr_b16 v[170:171], v18 offset:39424
    v_mfma_f32_16x16x32_bf16 v[112:115], v[176:179], v[136:139], v[112:115]
    v_mfma_f32_16x16x32_bf16 v[116:119], v[176:179], v[140:143], v[116:119]
    v_mfma_f32_16x16x32_bf16 v[104:107], v[180:183], v[128:131], v[104:107]
    ds_read_b64_tr_b16 v[172:173], v19 offset:38912
    v_mfma_f32_16x16x32_bf16 v[108:111], v[180:183], v[132:135], v[108:111]
    ds_read_b64_tr_b16 v[174:175], v19 offset:39424
    v_mfma_f32_16x16x32_bf16 v[120:123], v[180:183], v[136:139], v[120:123]
    v_mfma_f32_16x16x32_bf16 v[124:127], v[180:183], v[140:143], v[124:127]
    v_mfma_f32_16x16x32_bf16 v[236:239], v[176:179], v[184:187], v[236:239]
    s_waitcnt lgkmcnt(4)
    v_mfma_f32_16x16x32_bf16 v[64:67], v[160:163], v[144:147], v[64:67]
    ds_read_b128 v[184:187], v15 offset:59392
    v_mfma_f32_16x16x32_bf16 v[68:71], v[160:163], v[148:151], v[68:71]
    ds_read_b64_tr_b16 v[176:177], v18 offset:55296
    v_mfma_f32_16x16x32_bf16 v[80:83], v[160:163], v[152:155], v[80:83]
    ds_read_b64_tr_b16 v[178:179], v18 offset:55808
    v_mfma_f32_16x16x32_bf16 v[84:87], v[160:163], v[156:159], v[84:87]
    ds_read_b64_tr_b16 v[180:181], v19 offset:55296
    v_mfma_f32_16x16x32_bf16 v[72:75], v[164:167], v[144:147], v[72:75]
    ds_read_b64_tr_b16 v[182:183], v19 offset:55808
    v_mfma_f32_16x16x32_bf16 v[76:79], v[164:167], v[148:151], v[76:79]
    v_mfma_f32_16x16x32_bf16 v[88:91], v[164:167], v[152:155], v[88:91]
    v_mfma_f32_16x16x32_bf16 v[92:95], v[164:167], v[156:159], v[92:95]
    s_waitcnt lgkmcnt(4)
    v_mfma_f32_16x16x32_bf16 v[232:235], v[160:163], v[184:187], v[232:235]
    s_waitcnt lgkmcnt(0)
    s_barrier
    v_mfma_f32_16x16x32_bf16 v[32:35], v[168:171], v[144:147], v[32:35]
    ds_read_b128 v[128:131], v8 offset:0
    v_mfma_f32_16x16x32_bf16 v[36:39], v[168:171], v[148:151], v[36:39]
    ds_read_b128 v[132:135], v8 offset:2048
    v_mfma_f32_16x16x32_bf16 v[48:51], v[168:171], v[152:155], v[48:51]
    ds_read_b64_tr_b16 v[160:161], v16 offset:24576
    v_mfma_f32_16x16x32_bf16 v[52:55], v[168:171], v[156:159], v[52:55]
    ds_read_b64_tr_b16 v[162:163], v16 offset:25088
    v_mfma_f32_16x16x32_bf16 v[40:43], v[172:175], v[144:147], v[40:43]
    ds_read_b128 v[136:139], v8 offset:4096
    v_mfma_f32_16x16x32_bf16 v[44:47], v[172:175], v[148:151], v[44:47]
    ds_read_b128 v[140:143], v8 offset:6144
    v_mfma_f32_16x16x32_bf16 v[56:59], v[172:175], v[152:155], v[56:59]
    ds_read_b64_tr_b16 v[164:165], v17 offset:24576
    v_mfma_f32_16x16x32_bf16 v[60:63], v[172:175], v[156:159], v[60:63]
    ds_read_b64_tr_b16 v[166:167], v17 offset:25088
    v_mfma_f32_16x16x32_bf16 v[96:99], v[176:179], v[144:147], v[96:99]
    ds_read_b64_tr_b16 v[168:169], v16 offset:16384
    v_mfma_f32_16x16x32_bf16 v[100:103], v[176:179], v[148:151], v[100:103]
    ds_read_b64_tr_b16 v[170:171], v16 offset:16896
    v_mfma_f32_16x16x32_bf16 v[112:115], v[176:179], v[152:155], v[112:115]
    v_mfma_f32_16x16x32_bf16 v[116:119], v[176:179], v[156:159], v[116:119]
    v_mfma_f32_16x16x32_bf16 v[104:107], v[180:183], v[144:147], v[104:107]
    ds_read_b64_tr_b16 v[172:173], v17 offset:16384
    v_mfma_f32_16x16x32_bf16 v[108:111], v[180:183], v[148:151], v[108:111]
    ds_read_b64_tr_b16 v[174:175], v17 offset:16896
    v_mfma_f32_16x16x32_bf16 v[120:123], v[180:183], v[152:155], v[120:123]
    v_mfma_f32_16x16x32_bf16 v[124:127], v[180:183], v[156:159], v[124:127]
    v_mfma_f32_16x16x32_bf16 v[236:239], v[176:179], v[184:187], v[236:239]
    s_waitcnt lgkmcnt(4)
    v_mfma_f32_16x16x32_bf16 v[64:67], v[160:163], v[128:131], v[64:67]
    ds_read_b128 v[184:187], v12 offset:40960
    v_mfma_f32_16x16x32_bf16 v[68:71], v[160:163], v[132:135], v[68:71]
    ds_read_b64_tr_b16 v[176:177], v16 offset:32768
    v_mfma_f32_16x16x32_bf16 v[80:83], v[160:163], v[136:139], v[80:83]
    ds_read_b64_tr_b16 v[178:179], v16 offset:33280
    v_mfma_f32_16x16x32_bf16 v[84:87], v[160:163], v[140:143], v[84:87]
    ds_read_b64_tr_b16 v[180:181], v17 offset:32768
    v_mfma_f32_16x16x32_bf16 v[72:75], v[164:167], v[128:131], v[72:75]
    ds_read_b64_tr_b16 v[182:183], v17 offset:33280
    v_mfma_f32_16x16x32_bf16 v[76:79], v[164:167], v[132:135], v[76:79]
    v_mfma_f32_16x16x32_bf16 v[88:91], v[164:167], v[136:139], v[88:91]
    v_mfma_f32_16x16x32_bf16 v[92:95], v[164:167], v[140:143], v[92:95]
    s_waitcnt lgkmcnt(4)
    v_mfma_f32_16x16x32_bf16 v[232:235], v[160:163], v[184:187], v[232:235]
    v_mfma_f32_16x16x32_bf16 v[32:35], v[168:171], v[128:131], v[32:35]
    ds_read_b128 v[144:147], v9 offset:0
    v_mfma_f32_16x16x32_bf16 v[36:39], v[168:171], v[132:135], v[36:39]
    ds_read_b128 v[148:151], v9 offset:2048
    v_mfma_f32_16x16x32_bf16 v[48:51], v[168:171], v[136:139], v[48:51]
    ds_read_b64_tr_b16 v[160:161], v16 offset:28672
    v_mfma_f32_16x16x32_bf16 v[52:55], v[168:171], v[140:143], v[52:55]
    ds_read_b64_tr_b16 v[162:163], v16 offset:29184
    v_mfma_f32_16x16x32_bf16 v[40:43], v[172:175], v[128:131], v[40:43]
    ds_read_b128 v[152:155], v9 offset:4096
    v_mfma_f32_16x16x32_bf16 v[44:47], v[172:175], v[132:135], v[44:47]
    ds_read_b128 v[156:159], v9 offset:6144
    v_mfma_f32_16x16x32_bf16 v[56:59], v[172:175], v[136:139], v[56:59]
    ds_read_b64_tr_b16 v[164:165], v17 offset:28672
    v_mfma_f32_16x16x32_bf16 v[60:63], v[172:175], v[140:143], v[60:63]
    ds_read_b64_tr_b16 v[166:167], v17 offset:29184
    s_waitcnt lgkmcnt(8)
    v_mfma_f32_16x16x32_bf16 v[96:99], v[176:179], v[128:131], v[96:99]
    ds_read_b64_tr_b16 v[168:169], v16 offset:20480
    v_mfma_f32_16x16x32_bf16 v[100:103], v[176:179], v[132:135], v[100:103]
    ds_read_b64_tr_b16 v[170:171], v16 offset:20992
    v_mfma_f32_16x16x32_bf16 v[112:115], v[176:179], v[136:139], v[112:115]
    v_mfma_f32_16x16x32_bf16 v[116:119], v[176:179], v[140:143], v[116:119]
    v_mfma_f32_16x16x32_bf16 v[104:107], v[180:183], v[128:131], v[104:107]
    ds_read_b64_tr_b16 v[172:173], v17 offset:20480
    v_mfma_f32_16x16x32_bf16 v[108:111], v[180:183], v[132:135], v[108:111]
    ds_read_b64_tr_b16 v[174:175], v17 offset:20992
    v_mfma_f32_16x16x32_bf16 v[120:123], v[180:183], v[136:139], v[120:123]
    v_mfma_f32_16x16x32_bf16 v[124:127], v[180:183], v[140:143], v[124:127]
    v_mfma_f32_16x16x32_bf16 v[236:239], v[176:179], v[184:187], v[236:239]
    s_waitcnt lgkmcnt(4)
    v_mfma_f32_16x16x32_bf16 v[64:67], v[160:163], v[144:147], v[64:67]
    ds_read_b128 v[184:187], v13 offset:40960
    v_mfma_f32_16x16x32_bf16 v[68:71], v[160:163], v[148:151], v[68:71]
    ds_read_b64_tr_b16 v[176:177], v16 offset:36864
    v_mfma_f32_16x16x32_bf16 v[80:83], v[160:163], v[152:155], v[80:83]
    ds_read_b64_tr_b16 v[178:179], v16 offset:37376
    v_mfma_f32_16x16x32_bf16 v[84:87], v[160:163], v[156:159], v[84:87]
    ds_read_b64_tr_b16 v[180:181], v17 offset:36864
    v_mfma_f32_16x16x32_bf16 v[72:75], v[164:167], v[144:147], v[72:75]
    ds_read_b64_tr_b16 v[182:183], v17 offset:37376
    v_mfma_f32_16x16x32_bf16 v[76:79], v[164:167], v[148:151], v[76:79]
    v_mfma_f32_16x16x32_bf16 v[88:91], v[164:167], v[152:155], v[88:91]
    v_mfma_f32_16x16x32_bf16 v[92:95], v[164:167], v[156:159], v[92:95]
    s_waitcnt lgkmcnt(4)
    v_mfma_f32_16x16x32_bf16 v[232:235], v[160:163], v[184:187], v[232:235]
    s_waitcnt lgkmcnt(0)
    s_barrier
    v_mfma_f32_16x16x32_bf16 v[32:35], v[168:171], v[144:147], v[32:35]
    ds_read_b128 v[128:131], v8 offset:41984
    v_mfma_f32_16x16x32_bf16 v[36:39], v[168:171], v[148:151], v[36:39]
    ds_read_b128 v[132:135], v8 offset:44032
    v_mfma_f32_16x16x32_bf16 v[48:51], v[168:171], v[152:155], v[48:51]
    ds_read_b64_tr_b16 v[160:161], v18 offset:1024
    v_mfma_f32_16x16x32_bf16 v[52:55], v[168:171], v[156:159], v[52:55]
    ds_read_b64_tr_b16 v[162:163], v18 offset:1536
    v_mfma_f32_16x16x32_bf16 v[40:43], v[172:175], v[144:147], v[40:43]
    ds_read_b128 v[136:139], v8 offset:46080
    v_mfma_f32_16x16x32_bf16 v[44:47], v[172:175], v[148:151], v[44:47]
    ds_read_b128 v[140:143], v8 offset:48128
    v_mfma_f32_16x16x32_bf16 v[56:59], v[172:175], v[152:155], v[56:59]
    ds_read_b64_tr_b16 v[164:165], v19 offset:1024
    v_mfma_f32_16x16x32_bf16 v[60:63], v[172:175], v[156:159], v[60:63]
    ds_read_b64_tr_b16 v[166:167], v19 offset:1536
    v_mfma_f32_16x16x32_bf16 v[96:99], v[176:179], v[144:147], v[96:99]
    ds_read_b64_tr_b16 v[168:169], v16 offset:58368
    v_mfma_f32_16x16x32_bf16 v[100:103], v[176:179], v[148:151], v[100:103]
    ds_read_b64_tr_b16 v[170:171], v16 offset:58880
    v_mfma_f32_16x16x32_bf16 v[112:115], v[176:179], v[152:155], v[112:115]
    v_mfma_f32_16x16x32_bf16 v[116:119], v[176:179], v[156:159], v[116:119]
    v_mfma_f32_16x16x32_bf16 v[104:107], v[180:183], v[144:147], v[104:107]
    ds_read_b64_tr_b16 v[172:173], v17 offset:58368
    v_mfma_f32_16x16x32_bf16 v[108:111], v[180:183], v[148:151], v[108:111]
    ds_read_b64_tr_b16 v[174:175], v17 offset:58880
    v_mfma_f32_16x16x32_bf16 v[120:123], v[180:183], v[152:155], v[120:123]
    v_mfma_f32_16x16x32_bf16 v[124:127], v[180:183], v[156:159], v[124:127]
    v_mfma_f32_16x16x32_bf16 v[236:239], v[176:179], v[184:187], v[236:239]
    s_waitcnt lgkmcnt(4)
    v_mfma_f32_16x16x32_bf16 v[64:67], v[160:163], v[128:131], v[64:67]
    ds_read_b128 v[184:187], v14 offset:17408
    v_mfma_f32_16x16x32_bf16 v[68:71], v[160:163], v[132:135], v[68:71]
    ds_read_b64_tr_b16 v[176:177], v18 offset:9216
    v_mfma_f32_16x16x32_bf16 v[80:83], v[160:163], v[136:139], v[80:83]
    ds_read_b64_tr_b16 v[178:179], v18 offset:9728
    v_mfma_f32_16x16x32_bf16 v[84:87], v[160:163], v[140:143], v[84:87]
    ds_read_b64_tr_b16 v[180:181], v19 offset:9216
    v_mfma_f32_16x16x32_bf16 v[72:75], v[164:167], v[128:131], v[72:75]
    ds_read_b64_tr_b16 v[182:183], v19 offset:9728
    v_mfma_f32_16x16x32_bf16 v[76:79], v[164:167], v[132:135], v[76:79]
    v_mfma_f32_16x16x32_bf16 v[88:91], v[164:167], v[136:139], v[88:91]
    v_mfma_f32_16x16x32_bf16 v[92:95], v[164:167], v[140:143], v[92:95]
    s_waitcnt lgkmcnt(4)
    v_mfma_f32_16x16x32_bf16 v[232:235], v[160:163], v[184:187], v[232:235]
    v_mfma_f32_16x16x32_bf16 v[32:35], v[168:171], v[128:131], v[32:35]
    ds_read_b128 v[144:147], v9 offset:41984
    v_mfma_f32_16x16x32_bf16 v[36:39], v[168:171], v[132:135], v[36:39]
    ds_read_b128 v[148:151], v9 offset:44032
    v_mfma_f32_16x16x32_bf16 v[48:51], v[168:171], v[136:139], v[48:51]
    ds_read_b64_tr_b16 v[160:161], v18 offset:5120
    v_mfma_f32_16x16x32_bf16 v[52:55], v[168:171], v[140:143], v[52:55]
    ds_read_b64_tr_b16 v[162:163], v18 offset:5632
    v_mfma_f32_16x16x32_bf16 v[40:43], v[172:175], v[128:131], v[40:43]
    ds_read_b128 v[152:155], v9 offset:46080
    v_mfma_f32_16x16x32_bf16 v[44:47], v[172:175], v[132:135], v[44:47]
    ds_read_b128 v[156:159], v9 offset:48128
    v_mfma_f32_16x16x32_bf16 v[56:59], v[172:175], v[136:139], v[56:59]
    ds_read_b64_tr_b16 v[164:165], v19 offset:5120
    v_mfma_f32_16x16x32_bf16 v[60:63], v[172:175], v[140:143], v[60:63]
    ds_read_b64_tr_b16 v[166:167], v19 offset:5632
    s_waitcnt lgkmcnt(8)
    v_mfma_f32_16x16x32_bf16 v[96:99], v[176:179], v[128:131], v[96:99]
    ds_read_b64_tr_b16 v[168:169], v16 offset:62464
    v_mfma_f32_16x16x32_bf16 v[100:103], v[176:179], v[132:135], v[100:103]
    ds_read_b64_tr_b16 v[170:171], v16 offset:62976
    v_mfma_f32_16x16x32_bf16 v[112:115], v[176:179], v[136:139], v[112:115]
    v_mfma_f32_16x16x32_bf16 v[116:119], v[176:179], v[140:143], v[116:119]
    v_mfma_f32_16x16x32_bf16 v[104:107], v[180:183], v[128:131], v[104:107]
    ds_read_b64_tr_b16 v[172:173], v17 offset:62464
    v_mfma_f32_16x16x32_bf16 v[108:111], v[180:183], v[132:135], v[108:111]
    ds_read_b64_tr_b16 v[174:175], v17 offset:62976
    v_mfma_f32_16x16x32_bf16 v[120:123], v[180:183], v[136:139], v[120:123]
    v_mfma_f32_16x16x32_bf16 v[124:127], v[180:183], v[140:143], v[124:127]
    v_mfma_f32_16x16x32_bf16 v[236:239], v[176:179], v[184:187], v[236:239]
    s_waitcnt lgkmcnt(4)
    v_mfma_f32_16x16x32_bf16 v[64:67], v[160:163], v[144:147], v[64:67]
    ds_read_b128 v[184:187], v15 offset:17408
    v_mfma_f32_16x16x32_bf16 v[68:71], v[160:163], v[148:151], v[68:71]
    ds_read_b64_tr_b16 v[176:177], v18 offset:13312
    v_mfma_f32_16x16x32_bf16 v[80:83], v[160:163], v[152:155], v[80:83]
    ds_read_b64_tr_b16 v[178:179], v18 offset:13824
    v_mfma_f32_16x16x32_bf16 v[84:87], v[160:163], v[156:159], v[84:87]
    ds_read_b64_tr_b16 v[180:181], v19 offset:13312
    v_mfma_f32_16x16x32_bf16 v[72:75], v[164:167], v[144:147], v[72:75]
    ds_read_b64_tr_b16 v[182:183], v19 offset:13824
    v_mfma_f32_16x16x32_bf16 v[76:79], v[164:167], v[148:151], v[76:79]
    v_mfma_f32_16x16x32_bf16 v[88:91], v[164:167], v[152:155], v[88:91]
    v_mfma_f32_16x16x32_bf16 v[92:95], v[164:167], v[156:159], v[92:95]
    s_waitcnt lgkmcnt(4)
    v_mfma_f32_16x16x32_bf16 v[232:235], v[160:163], v[184:187], v[232:235]
    s_waitcnt lgkmcnt(0)
    s_barrier
    v_mfma_f32_16x16x32_bf16 v[32:35], v[168:171], v[144:147], v[32:35]
    ds_read_b128 v[128:131], v10 offset:18432
    v_mfma_f32_16x16x32_bf16 v[36:39], v[168:171], v[148:151], v[36:39]
    ds_read_b128 v[132:135], v10 offset:20480
    v_mfma_f32_16x16x32_bf16 v[48:51], v[168:171], v[152:155], v[48:51]
    ds_read_b64_tr_b16 v[160:161], v18 offset:43008
    v_mfma_f32_16x16x32_bf16 v[52:55], v[168:171], v[156:159], v[52:55]
    ds_read_b64_tr_b16 v[162:163], v18 offset:43520
    v_mfma_f32_16x16x32_bf16 v[40:43], v[172:175], v[144:147], v[40:43]
    ds_read_b128 v[136:139], v10 offset:22528
    v_mfma_f32_16x16x32_bf16 v[44:47], v[172:175], v[148:151], v[44:47]
    ds_read_b128 v[140:143], v10 offset:24576
    v_mfma_f32_16x16x32_bf16 v[56:59], v[172:175], v[152:155], v[56:59]
    ds_read_b64_tr_b16 v[164:165], v19 offset:43008
    v_mfma_f32_16x16x32_bf16 v[60:63], v[172:175], v[156:159], v[60:63]
    ds_read_b64_tr_b16 v[166:167], v19 offset:43520
    v_mfma_f32_16x16x32_bf16 v[96:99], v[176:179], v[144:147], v[96:99]
    ds_read_b64_tr_b16 v[168:169], v18 offset:34816
    v_mfma_f32_16x16x32_bf16 v[100:103], v[176:179], v[148:151], v[100:103]
    ds_read_b64_tr_b16 v[170:171], v18 offset:35328
    v_mfma_f32_16x16x32_bf16 v[112:115], v[176:179], v[152:155], v[112:115]
    v_mfma_f32_16x16x32_bf16 v[116:119], v[176:179], v[156:159], v[116:119]
    v_mfma_f32_16x16x32_bf16 v[104:107], v[180:183], v[144:147], v[104:107]
    ds_read_b64_tr_b16 v[172:173], v19 offset:34816
    v_mfma_f32_16x16x32_bf16 v[108:111], v[180:183], v[148:151], v[108:111]
    ds_read_b64_tr_b16 v[174:175], v19 offset:35328
    v_mfma_f32_16x16x32_bf16 v[120:123], v[180:183], v[152:155], v[120:123]
    v_mfma_f32_16x16x32_bf16 v[124:127], v[180:183], v[156:159], v[124:127]
    v_mfma_f32_16x16x32_bf16 v[236:239], v[176:179], v[184:187], v[236:239]
    s_waitcnt lgkmcnt(4)
    v_mfma_f32_16x16x32_bf16 v[64:67], v[160:163], v[128:131], v[64:67]
    ds_read_b128 v[184:187], v14 offset:59392
    v_mfma_f32_16x16x32_bf16 v[68:71], v[160:163], v[132:135], v[68:71]
    ds_read_b64_tr_b16 v[176:177], v18 offset:51200
    v_mfma_f32_16x16x32_bf16 v[80:83], v[160:163], v[136:139], v[80:83]
    ds_read_b64_tr_b16 v[178:179], v18 offset:51712
    v_mfma_f32_16x16x32_bf16 v[84:87], v[160:163], v[140:143], v[84:87]
    ds_read_b64_tr_b16 v[180:181], v19 offset:51200
    v_mfma_f32_16x16x32_bf16 v[72:75], v[164:167], v[128:131], v[72:75]
    ds_read_b64_tr_b16 v[182:183], v19 offset:51712
    v_mfma_f32_16x16x32_bf16 v[76:79], v[164:167], v[132:135], v[76:79]
    v_mfma_f32_16x16x32_bf16 v[88:91], v[164:167], v[136:139], v[88:91]
    v_mfma_f32_16x16x32_bf16 v[92:95], v[164:167], v[140:143], v[92:95]
    s_waitcnt lgkmcnt(4)
    v_mfma_f32_16x16x32_bf16 v[232:235], v[160:163], v[184:187], v[232:235]
    v_mfma_f32_16x16x32_bf16 v[32:35], v[168:171], v[128:131], v[32:35]
    ds_read_b128 v[144:147], v11 offset:18432
    v_mfma_f32_16x16x32_bf16 v[36:39], v[168:171], v[132:135], v[36:39]
    ds_read_b128 v[148:151], v11 offset:20480
    v_mfma_f32_16x16x32_bf16 v[48:51], v[168:171], v[136:139], v[48:51]
    ds_read_b64_tr_b16 v[160:161], v18 offset:47104
    v_mfma_f32_16x16x32_bf16 v[52:55], v[168:171], v[140:143], v[52:55]
    ds_read_b64_tr_b16 v[162:163], v18 offset:47616
    v_mfma_f32_16x16x32_bf16 v[40:43], v[172:175], v[128:131], v[40:43]
    ds_read_b128 v[152:155], v11 offset:22528
    v_mfma_f32_16x16x32_bf16 v[44:47], v[172:175], v[132:135], v[44:47]
    ds_read_b128 v[156:159], v11 offset:24576
    v_mfma_f32_16x16x32_bf16 v[56:59], v[172:175], v[136:139], v[56:59]
    ds_read_b64_tr_b16 v[164:165], v19 offset:47104
    v_mfma_f32_16x16x32_bf16 v[60:63], v[172:175], v[140:143], v[60:63]
    ds_read_b64_tr_b16 v[166:167], v19 offset:47616
    s_waitcnt lgkmcnt(8)
    v_mfma_f32_16x16x32_bf16 v[96:99], v[176:179], v[128:131], v[96:99]
    ds_read_b64_tr_b16 v[168:169], v18 offset:38912
    v_mfma_f32_16x16x32_bf16 v[100:103], v[176:179], v[132:135], v[100:103]
    ds_read_b64_tr_b16 v[170:171], v18 offset:39424
    v_mfma_f32_16x16x32_bf16 v[112:115], v[176:179], v[136:139], v[112:115]
    v_mfma_f32_16x16x32_bf16 v[116:119], v[176:179], v[140:143], v[116:119]
    v_mfma_f32_16x16x32_bf16 v[104:107], v[180:183], v[128:131], v[104:107]
    ds_read_b64_tr_b16 v[172:173], v19 offset:38912
    v_mfma_f32_16x16x32_bf16 v[108:111], v[180:183], v[132:135], v[108:111]
    ds_read_b64_tr_b16 v[174:175], v19 offset:39424
    v_mfma_f32_16x16x32_bf16 v[120:123], v[180:183], v[136:139], v[120:123]
    v_mfma_f32_16x16x32_bf16 v[124:127], v[180:183], v[140:143], v[124:127]
    v_mfma_f32_16x16x32_bf16 v[236:239], v[176:179], v[184:187], v[236:239]
    s_waitcnt lgkmcnt(4)
    v_mfma_f32_16x16x32_bf16 v[64:67], v[160:163], v[144:147], v[64:67]
    ds_read_b128 v[184:187], v15 offset:59392
    v_mfma_f32_16x16x32_bf16 v[68:71], v[160:163], v[148:151], v[68:71]
    ds_read_b64_tr_b16 v[176:177], v18 offset:55296
    v_mfma_f32_16x16x32_bf16 v[80:83], v[160:163], v[152:155], v[80:83]
    ds_read_b64_tr_b16 v[178:179], v18 offset:55808
    v_mfma_f32_16x16x32_bf16 v[84:87], v[160:163], v[156:159], v[84:87]
    ds_read_b64_tr_b16 v[180:181], v19 offset:55296
    v_mfma_f32_16x16x32_bf16 v[72:75], v[164:167], v[144:147], v[72:75]
    ds_read_b64_tr_b16 v[182:183], v19 offset:55808
    v_mfma_f32_16x16x32_bf16 v[76:79], v[164:167], v[148:151], v[76:79]
    v_mfma_f32_16x16x32_bf16 v[88:91], v[164:167], v[152:155], v[88:91]
    v_mfma_f32_16x16x32_bf16 v[92:95], v[164:167], v[156:159], v[92:95]
    s_waitcnt lgkmcnt(4)
    v_mfma_f32_16x16x32_bf16 v[232:235], v[160:163], v[184:187], v[232:235]
    s_waitcnt lgkmcnt(0)
    s_barrier
    v_mfma_f32_16x16x32_bf16 v[32:35], v[168:171], v[144:147], v[32:35]
    ds_read_b128 v[128:131], v8 offset:0
    v_mfma_f32_16x16x32_bf16 v[36:39], v[168:171], v[148:151], v[36:39]
    ds_read_b128 v[132:135], v8 offset:2048
    v_mfma_f32_16x16x32_bf16 v[48:51], v[168:171], v[152:155], v[48:51]
    ds_read_b64_tr_b16 v[160:161], v16 offset:24576
    v_mfma_f32_16x16x32_bf16 v[52:55], v[168:171], v[156:159], v[52:55]
    ds_read_b64_tr_b16 v[162:163], v16 offset:25088
    v_mfma_f32_16x16x32_bf16 v[40:43], v[172:175], v[144:147], v[40:43]
    ds_read_b128 v[136:139], v8 offset:4096
    v_mfma_f32_16x16x32_bf16 v[44:47], v[172:175], v[148:151], v[44:47]
    ds_read_b128 v[140:143], v8 offset:6144
    v_mfma_f32_16x16x32_bf16 v[56:59], v[172:175], v[152:155], v[56:59]
    ds_read_b64_tr_b16 v[164:165], v17 offset:24576
    v_mfma_f32_16x16x32_bf16 v[60:63], v[172:175], v[156:159], v[60:63]
    ds_read_b64_tr_b16 v[166:167], v17 offset:25088
    v_mfma_f32_16x16x32_bf16 v[96:99], v[176:179], v[144:147], v[96:99]
    ds_read_b64_tr_b16 v[168:169], v16 offset:16384
    v_mfma_f32_16x16x32_bf16 v[100:103], v[176:179], v[148:151], v[100:103]
    ds_read_b64_tr_b16 v[170:171], v16 offset:16896
    v_mfma_f32_16x16x32_bf16 v[112:115], v[176:179], v[152:155], v[112:115]
    v_mfma_f32_16x16x32_bf16 v[116:119], v[176:179], v[156:159], v[116:119]
    v_mfma_f32_16x16x32_bf16 v[104:107], v[180:183], v[144:147], v[104:107]
    ds_read_b64_tr_b16 v[172:173], v17 offset:16384
    v_mfma_f32_16x16x32_bf16 v[108:111], v[180:183], v[148:151], v[108:111]
    ds_read_b64_tr_b16 v[174:175], v17 offset:16896
    v_mfma_f32_16x16x32_bf16 v[120:123], v[180:183], v[152:155], v[120:123]
    v_mfma_f32_16x16x32_bf16 v[124:127], v[180:183], v[156:159], v[124:127]
    v_mfma_f32_16x16x32_bf16 v[236:239], v[176:179], v[184:187], v[236:239]
    s_waitcnt lgkmcnt(4)
    v_mfma_f32_16x16x32_bf16 v[64:67], v[160:163], v[128:131], v[64:67]
    ds_read_b128 v[184:187], v12 offset:40960
    v_mfma_f32_16x16x32_bf16 v[68:71], v[160:163], v[132:135], v[68:71]
    ds_read_b64_tr_b16 v[176:177], v16 offset:32768
    v_mfma_f32_16x16x32_bf16 v[80:83], v[160:163], v[136:139], v[80:83]
    ds_read_b64_tr_b16 v[178:179], v16 offset:33280
    v_mfma_f32_16x16x32_bf16 v[84:87], v[160:163], v[140:143], v[84:87]
    ds_read_b64_tr_b16 v[180:181], v17 offset:32768
    v_mfma_f32_16x16x32_bf16 v[72:75], v[164:167], v[128:131], v[72:75]
    ds_read_b64_tr_b16 v[182:183], v17 offset:33280
    v_mfma_f32_16x16x32_bf16 v[76:79], v[164:167], v[132:135], v[76:79]
    v_mfma_f32_16x16x32_bf16 v[88:91], v[164:167], v[136:139], v[88:91]
    v_mfma_f32_16x16x32_bf16 v[92:95], v[164:167], v[140:143], v[92:95]
    s_waitcnt lgkmcnt(4)
    v_mfma_f32_16x16x32_bf16 v[232:235], v[160:163], v[184:187], v[232:235]
    v_mfma_f32_16x16x32_bf16 v[32:35], v[168:171], v[128:131], v[32:35]
    ds_read_b128 v[144:147], v9 offset:0
    v_mfma_f32_16x16x32_bf16 v[36:39], v[168:171], v[132:135], v[36:39]
    ds_read_b128 v[148:151], v9 offset:2048
    v_mfma_f32_16x16x32_bf16 v[48:51], v[168:171], v[136:139], v[48:51]
    ds_read_b64_tr_b16 v[160:161], v16 offset:28672
    v_mfma_f32_16x16x32_bf16 v[52:55], v[168:171], v[140:143], v[52:55]
    ds_read_b64_tr_b16 v[162:163], v16 offset:29184
    v_mfma_f32_16x16x32_bf16 v[40:43], v[172:175], v[128:131], v[40:43]
    ds_read_b128 v[152:155], v9 offset:4096
    v_mfma_f32_16x16x32_bf16 v[44:47], v[172:175], v[132:135], v[44:47]
    ds_read_b128 v[156:159], v9 offset:6144
    v_mfma_f32_16x16x32_bf16 v[56:59], v[172:175], v[136:139], v[56:59]
    ds_read_b64_tr_b16 v[164:165], v17 offset:28672
    v_mfma_f32_16x16x32_bf16 v[60:63], v[172:175], v[140:143], v[60:63]
    ds_read_b64_tr_b16 v[166:167], v17 offset:29184
    s_waitcnt lgkmcnt(8)
    v_mfma_f32_16x16x32_bf16 v[96:99], v[176:179], v[128:131], v[96:99]
    ds_read_b64_tr_b16 v[168:169], v16 offset:20480
    v_mfma_f32_16x16x32_bf16 v[100:103], v[176:179], v[132:135], v[100:103]
    ds_read_b64_tr_b16 v[170:171], v16 offset:20992
    v_mfma_f32_16x16x32_bf16 v[112:115], v[176:179], v[136:139], v[112:115]
    v_mfma_f32_16x16x32_bf16 v[116:119], v[176:179], v[140:143], v[116:119]
    v_mfma_f32_16x16x32_bf16 v[104:107], v[180:183], v[128:131], v[104:107]
    ds_read_b64_tr_b16 v[172:173], v17 offset:20480
    v_mfma_f32_16x16x32_bf16 v[108:111], v[180:183], v[132:135], v[108:111]
    ds_read_b64_tr_b16 v[174:175], v17 offset:20992
    v_mfma_f32_16x16x32_bf16 v[120:123], v[180:183], v[136:139], v[120:123]
    v_mfma_f32_16x16x32_bf16 v[124:127], v[180:183], v[140:143], v[124:127]
    v_mfma_f32_16x16x32_bf16 v[236:239], v[176:179], v[184:187], v[236:239]
    s_waitcnt lgkmcnt(4)
    v_mfma_f32_16x16x32_bf16 v[64:67], v[160:163], v[144:147], v[64:67]
    ds_read_b128 v[184:187], v13 offset:40960
    v_mfma_f32_16x16x32_bf16 v[68:71], v[160:163], v[148:151], v[68:71]
    ds_read_b64_tr_b16 v[176:177], v16 offset:36864
    v_mfma_f32_16x16x32_bf16 v[80:83], v[160:163], v[152:155], v[80:83]
    ds_read_b64_tr_b16 v[178:179], v16 offset:37376
    v_mfma_f32_16x16x32_bf16 v[84:87], v[160:163], v[156:159], v[84:87]
    ds_read_b64_tr_b16 v[180:181], v17 offset:36864
    v_mfma_f32_16x16x32_bf16 v[72:75], v[164:167], v[144:147], v[72:75]
    ds_read_b64_tr_b16 v[182:183], v17 offset:37376
    v_mfma_f32_16x16x32_bf16 v[76:79], v[164:167], v[148:151], v[76:79]
    v_mfma_f32_16x16x32_bf16 v[88:91], v[164:167], v[152:155], v[88:91]
    v_mfma_f32_16x16x32_bf16 v[92:95], v[164:167], v[156:159], v[92:95]
    s_waitcnt lgkmcnt(4)
    v_mfma_f32_16x16x32_bf16 v[232:235], v[160:163], v[184:187], v[232:235]
    s_waitcnt lgkmcnt(0)
    s_barrier
    v_mfma_f32_16x16x32_bf16 v[32:35], v[168:171], v[144:147], v[32:35]
    ds_read_b128 v[128:131], v8 offset:41984
    v_mfma_f32_16x16x32_bf16 v[36:39], v[168:171], v[148:151], v[36:39]
    ds_read_b128 v[132:135], v8 offset:44032
    v_mfma_f32_16x16x32_bf16 v[48:51], v[168:171], v[152:155], v[48:51]
    ds_read_b64_tr_b16 v[160:161], v18 offset:1024
    v_mfma_f32_16x16x32_bf16 v[52:55], v[168:171], v[156:159], v[52:55]
    ds_read_b64_tr_b16 v[162:163], v18 offset:1536
    v_mfma_f32_16x16x32_bf16 v[40:43], v[172:175], v[144:147], v[40:43]
    ds_read_b128 v[136:139], v8 offset:46080
    v_mfma_f32_16x16x32_bf16 v[44:47], v[172:175], v[148:151], v[44:47]
    ds_read_b128 v[140:143], v8 offset:48128
    v_mfma_f32_16x16x32_bf16 v[56:59], v[172:175], v[152:155], v[56:59]
    ds_read_b64_tr_b16 v[164:165], v19 offset:1024
    v_mfma_f32_16x16x32_bf16 v[60:63], v[172:175], v[156:159], v[60:63]
    ds_read_b64_tr_b16 v[166:167], v19 offset:1536
    v_mfma_f32_16x16x32_bf16 v[96:99], v[176:179], v[144:147], v[96:99]
    ds_read_b64_tr_b16 v[168:169], v16 offset:58368
    v_mfma_f32_16x16x32_bf16 v[100:103], v[176:179], v[148:151], v[100:103]
    ds_read_b64_tr_b16 v[170:171], v16 offset:58880
    v_mfma_f32_16x16x32_bf16 v[112:115], v[176:179], v[152:155], v[112:115]
    v_mfma_f32_16x16x32_bf16 v[116:119], v[176:179], v[156:159], v[116:119]
    v_mfma_f32_16x16x32_bf16 v[104:107], v[180:183], v[144:147], v[104:107]
    ds_read_b64_tr_b16 v[172:173], v17 offset:58368
    v_mfma_f32_16x16x32_bf16 v[108:111], v[180:183], v[148:151], v[108:111]
    ds_read_b64_tr_b16 v[174:175], v17 offset:58880
    v_mfma_f32_16x16x32_bf16 v[120:123], v[180:183], v[152:155], v[120:123]
    v_mfma_f32_16x16x32_bf16 v[124:127], v[180:183], v[156:159], v[124:127]
    v_mfma_f32_16x16x32_bf16 v[236:239], v[176:179], v[184:187], v[236:239]
    s_waitcnt lgkmcnt(4)
    v_mfma_f32_16x16x32_bf16 v[64:67], v[160:163], v[128:131], v[64:67]
    ds_read_b128 v[184:187], v14 offset:17408
    v_mfma_f32_16x16x32_bf16 v[68:71], v[160:163], v[132:135], v[68:71]
    ds_read_b64_tr_b16 v[176:177], v18 offset:9216
    v_mfma_f32_16x16x32_bf16 v[80:83], v[160:163], v[136:139], v[80:83]
    ds_read_b64_tr_b16 v[178:179], v18 offset:9728
    v_mfma_f32_16x16x32_bf16 v[84:87], v[160:163], v[140:143], v[84:87]
    ds_read_b64_tr_b16 v[180:181], v19 offset:9216
    v_mfma_f32_16x16x32_bf16 v[72:75], v[164:167], v[128:131], v[72:75]
    ds_read_b64_tr_b16 v[182:183], v19 offset:9728
    v_mfma_f32_16x16x32_bf16 v[76:79], v[164:167], v[132:135], v[76:79]
    v_mfma_f32_16x16x32_bf16 v[88:91], v[164:167], v[136:139], v[88:91]
    v_mfma_f32_16x16x32_bf16 v[92:95], v[164:167], v[140:143], v[92:95]
    s_waitcnt lgkmcnt(4)
    v_mfma_f32_16x16x32_bf16 v[232:235], v[160:163], v[184:187], v[232:235]
    v_mfma_f32_16x16x32_bf16 v[32:35], v[168:171], v[128:131], v[32:35]
    ds_read_b128 v[144:147], v9 offset:41984
    v_mfma_f32_16x16x32_bf16 v[36:39], v[168:171], v[132:135], v[36:39]
    ds_read_b128 v[148:151], v9 offset:44032
    v_mfma_f32_16x16x32_bf16 v[48:51], v[168:171], v[136:139], v[48:51]
    ds_read_b64_tr_b16 v[160:161], v18 offset:5120
    v_mfma_f32_16x16x32_bf16 v[52:55], v[168:171], v[140:143], v[52:55]
    ds_read_b64_tr_b16 v[162:163], v18 offset:5632
    v_mfma_f32_16x16x32_bf16 v[40:43], v[172:175], v[128:131], v[40:43]
    ds_read_b128 v[152:155], v9 offset:46080
    v_mfma_f32_16x16x32_bf16 v[44:47], v[172:175], v[132:135], v[44:47]
    ds_read_b128 v[156:159], v9 offset:48128
    v_mfma_f32_16x16x32_bf16 v[56:59], v[172:175], v[136:139], v[56:59]
    ds_read_b64_tr_b16 v[164:165], v19 offset:5120
    v_mfma_f32_16x16x32_bf16 v[60:63], v[172:175], v[140:143], v[60:63]
    ds_read_b64_tr_b16 v[166:167], v19 offset:5632
    s_waitcnt lgkmcnt(8)
    v_mfma_f32_16x16x32_bf16 v[96:99], v[176:179], v[128:131], v[96:99]
    ds_read_b64_tr_b16 v[168:169], v16 offset:62464
    v_mfma_f32_16x16x32_bf16 v[100:103], v[176:179], v[132:135], v[100:103]
    ds_read_b64_tr_b16 v[170:171], v16 offset:62976
    v_mfma_f32_16x16x32_bf16 v[112:115], v[176:179], v[136:139], v[112:115]
    v_mfma_f32_16x16x32_bf16 v[116:119], v[176:179], v[140:143], v[116:119]
    v_mfma_f32_16x16x32_bf16 v[104:107], v[180:183], v[128:131], v[104:107]
    ds_read_b64_tr_b16 v[172:173], v17 offset:62464
    v_mfma_f32_16x16x32_bf16 v[108:111], v[180:183], v[132:135], v[108:111]
    ds_read_b64_tr_b16 v[174:175], v17 offset:62976
    v_mfma_f32_16x16x32_bf16 v[120:123], v[180:183], v[136:139], v[120:123]
    v_mfma_f32_16x16x32_bf16 v[124:127], v[180:183], v[140:143], v[124:127]
    v_mfma_f32_16x16x32_bf16 v[236:239], v[176:179], v[184:187], v[236:239]
    s_waitcnt lgkmcnt(4)
    v_mfma_f32_16x16x32_bf16 v[64:67], v[160:163], v[144:147], v[64:67]
    ds_read_b128 v[184:187], v15 offset:17408
    v_mfma_f32_16x16x32_bf16 v[68:71], v[160:163], v[148:151], v[68:71]
    ds_read_b64_tr_b16 v[176:177], v18 offset:13312
    v_mfma_f32_16x16x32_bf16 v[80:83], v[160:163], v[152:155], v[80:83]
    ds_read_b64_tr_b16 v[178:179], v18 offset:13824
    v_mfma_f32_16x16x32_bf16 v[84:87], v[160:163], v[156:159], v[84:87]
    ds_read_b64_tr_b16 v[180:181], v19 offset:13312
    v_mfma_f32_16x16x32_bf16 v[72:75], v[164:167], v[144:147], v[72:75]
    ds_read_b64_tr_b16 v[182:183], v19 offset:13824
    v_mfma_f32_16x16x32_bf16 v[76:79], v[164:167], v[148:151], v[76:79]
    v_mfma_f32_16x16x32_bf16 v[88:91], v[164:167], v[152:155], v[88:91]
    v_mfma_f32_16x16x32_bf16 v[92:95], v[164:167], v[156:159], v[92:95]
    s_waitcnt lgkmcnt(4)
    v_mfma_f32_16x16x32_bf16 v[232:235], v[160:163], v[184:187], v[232:235]
    v_mfma_f32_16x16x32_bf16 v[32:35], v[168:171], v[144:147], v[32:35]
    v_mfma_f32_16x16x32_bf16 v[36:39], v[168:171], v[148:151], v[36:39]
    v_mfma_f32_16x16x32_bf16 v[48:51], v[168:171], v[152:155], v[48:51]
    v_mfma_f32_16x16x32_bf16 v[52:55], v[168:171], v[156:159], v[52:55]
    v_mfma_f32_16x16x32_bf16 v[40:43], v[172:175], v[144:147], v[40:43]
    v_mfma_f32_16x16x32_bf16 v[44:47], v[172:175], v[148:151], v[44:47]
    v_mfma_f32_16x16x32_bf16 v[56:59], v[172:175], v[152:155], v[56:59]
    v_mfma_f32_16x16x32_bf16 v[60:63], v[172:175], v[156:159], v[60:63]
    s_waitcnt lgkmcnt(0)
    v_mfma_f32_16x16x32_bf16 v[96:99], v[176:179], v[144:147], v[96:99]
    v_mfma_f32_16x16x32_bf16 v[100:103], v[176:179], v[148:151], v[100:103]
    v_mfma_f32_16x16x32_bf16 v[112:115], v[176:179], v[152:155], v[112:115]
    v_mfma_f32_16x16x32_bf16 v[116:119], v[176:179], v[156:159], v[116:119]
    v_mfma_f32_16x16x32_bf16 v[104:107], v[180:183], v[144:147], v[104:107]
    v_mfma_f32_16x16x32_bf16 v[108:111], v[180:183], v[148:151], v[108:111]
    v_mfma_f32_16x16x32_bf16 v[120:123], v[180:183], v[152:155], v[120:123]
    v_mfma_f32_16x16x32_bf16 v[124:127], v[180:183], v[156:159], v[124:127]
    v_mfma_f32_16x16x32_bf16 v[236:239], v[176:179], v[184:187], v[236:239]
    s_branch L_bloopend
L_bodd:
    s_barrier
    s_setprio 2
    s_cmp_eq_u32 s100, 1920
    s_cbranch_scc0 L_noready
    s_waitcnt vmcnt(0)
    s_atomic_add s35, s[32:33], 0x0
L_noready:
    ds_read_b128 v[128:131], v8 offset:0
    ds_read_b128 v[132:135], v8 offset:2048
    ds_read_b64_tr_b16 v[160:161], v16 offset:24576
    ds_read_b64_tr_b16 v[162:163], v16 offset:25088
    ds_read_b128 v[136:139], v8 offset:4096
    ds_read_b128 v[140:143], v8 offset:6144
    ds_read_b64_tr_b16 v[164:165], v17 offset:24576
    ds_read_b64_tr_b16 v[166:167], v17 offset:25088
    ds_read_b64_tr_b16 v[168:169], v16 offset:16384
    ds_read_b64_tr_b16 v[170:171], v16 offset:16896
    ds_read_b64_tr_b16 v[172:173], v17 offset:16384
    ds_read_b64_tr_b16 v[174:175], v17 offset:16896
    s_waitcnt lgkmcnt(4)
    v_mfma_f32_16x16x32_bf16 v[64:67], v[160:163], v[128:131], 0
    ds_read_b128 v[184:187], v12 offset:40960
    v_mfma_f32_16x16x32_bf16 v[68:71], v[160:163], v[132:135], 0
    ds_read_b64_tr_b16 v[176:177], v16 offset:32768
    v_mfma_f32_16x16x32_bf16 v[80:83], v[160:163], v[136:139], 0
    ds_read_b64_tr_b16 v[178:179], v16 offset:33280
    v_mfma_f32_16x16x32_bf16 v[84:87], v[160:163], v[140:143], 0
    ds_read_b64_tr_b16 v[180:181], v17 offset:32768
    v_mfma_f32_16x16x32_bf16 v[72:75], v[164:167], v[128:131], 0
    ds_read_b64_tr_b16 v[182:183], v17 offset:33280
    v_mfma_f32_16x16x32_bf16 v[76:79], v[164:167], v[132:135], 0
    v_mfma_f32_16x16x32_bf16 v[88:91], v[164:167], v[136:139], 0
    v_mfma_f32_16x16x32_bf16 v[92:95], v[164:167], v[140:143], 0
    s_waitcnt lgkmcnt(4)
    v_mfma_f32_16x16x32_bf16 v[232:235], v[164:167], v[184:187], 0
    v_mfma_f32_16x16x32_bf16 v[32:35], v[168:171], v[128:131], 0
    ds_read_b128 v[144:147], v9 offset:0
    v_mfma_f32_16x16x32_bf16 v[36:39], v[168:171], v[132:135], 0
    ds_read_b128 v[148:151], v9 offset:2048
    v_mfma_f32_16x16x32_bf16 v[48:51], v[168:171], v[136:139], 0
    ds_read_b64_tr_b16 v[160:161], v16 offset:28672
    v_mfma_f32_16x16x32_bf16 v[52:55], v[168:171], v[140:143], 0
    ds_read_b64_tr_b16 v[162:163], v16 offset:29184
    v_mfma_f32_16x16x32_bf16 v[40:43], v[172:175], v[128:131], 0
    ds_read_b128 v[152:155], v9 offset:4096
    v_mfma_f32_16x16x32_bf16 v[44:47], v[172:175], v[132:135], 0
    ds_read_b128 v[156:159], v9 offset:6144
    v_mfma_f32_16x16x32_bf16 v[56:59], v[172:175], v[136:139], 0
    ds_read_b64_tr_b16 v[164:165], v17 offset:28672
    v_mfma_f32_16x16x32_bf16 v[60:63], v[172:175], v[140:143], 0
    ds_read_b64_tr_b16 v[166:167], v17 offset:29184
    s_waitcnt lgkmcnt(8)
    v_mfma_f32_16x16x32_bf16 v[96:99], v[176:179], v[128:131], 0
    ds_read_b64_tr_b16 v[168:169], v16 offset:20480
    v_mfma_f32_16x16x32_bf16 v[100:103], v[176:179], v[132:135], 0
    ds_read_b64_tr_b16 v[170:171], v16 offset:20992
    v_mfma_f32_16x16x32_bf16 v[112:115], v[176:179], v[136:139], 0
    v_mfma_f32_16x16x32_bf16 v[116:119], v[176:179], v[140:143], 0
    v_mfma_f32_16x16x32_bf16 v[104:107], v[180:183], v[128:131], 0
    ds_read_b64_tr_b16 v[172:173], v17 offset:20480
    v_mfma_f32_16x16x32_bf16 v[108:111], v[180:183], v[132:135], 0
    ds_read_b64_tr_b16 v[174:175], v17 offset:20992
    v_mfma_f32_16x16x32_bf16 v[120:123], v[180:183], v[136:139], 0
    v_mfma_f32_16x16x32_bf16 v[124:127], v[180:183], v[140:143], 0
    v_mfma_f32_16x16x32_bf16 v[236:239], v[180:183], v[184:187], 0
    s_waitcnt lgkmcnt(4)
    v_mfma_f32_16x16x32_bf16 v[64:67], v[160:163], v[144:147], v[64:67]
    ds_read_b128 v[184:187], v13 offset:40960
    v_mfma_f32_16x16x32_bf16 v[68:71], v[160:163], v[148:151], v[68:71]
    ds_read_b64_tr_b16 v[176:177], v16 offset:36864
    v_mfma_f32_16x16x32_bf16 v[80:83], v[160:163], v[152:155], v[80:83]
    ds_read_b64_tr_b16 v[178:179], v16 offset:37376
    v_mfma_f32_16x16x32_bf16 v[84:87], v[160:163], v[156:159], v[84:87]
    ds_read_b64_tr_b16 v[180:181], v17 offset:36864
    v_mfma_f32_16x16x32_bf16 v[72:75], v[164:167], v[144:147], v[72:75]
    ds_read_b64_tr_b16 v[182:183], v17 offset:37376
    v_mfma_f32_16x16x32_bf16 v[76:79], v[164:167], v[148:151], v[76:79]
    v_mfma_f32_16x16x32_bf16 v[88:91], v[164:167], v[152:155], v[88:91]
    v_mfma_f32_16x16x32_bf16 v[92:95], v[164:167], v[156:159], v[92:95]
    s_waitcnt lgkmcnt(4)
    v_mfma_f32_16x16x32_bf16 v[232:235], v[164:167], v[184:187], v[232:235]
    s_waitcnt lgkmcnt(0)
    s_barrier
    v_mfma_f32_16x16x32_bf16 v[32:35], v[168:171], v[144:147], v[32:35]
    ds_read_b128 v[128:131], v8 offset:41984
    v_mfma_f32_16x16x32_bf16 v[36:39], v[168:171], v[148:151], v[36:39]
    ds_read_b128 v[132:135], v8 offset:44032
    v_mfma_f32_16x16x32_bf16 v[48:51], v[168:171], v[152:155], v[48:51]
    ds_read_b64_tr_b16 v[160:161], v18 offset:1024
    v_mfma_f32_16x16x32_bf16 v[52:55], v[168:171], v[156:159], v[52:55]
    ds_read_b64_tr_b16 v[162:163], v18 offset:1536
    v_mfma_f32_16x16x32_bf16 v[40:43], v[172:175], v[144:147], v[40:43]
    ds_read_b128 v[136:139], v8 offset:46080
    v_mfma_f32_16x16x32_bf16 v[44:47], v[172:175], v[148:151], v[44:47]
    ds_read_b128 v[140:143], v8 offset:48128
    v_mfma_f32_16x16x32_bf16 v[56:59], v[172:175], v[152:155], v[56:59]
    ds_read_b64_tr_b16 v[164:165], v19 offset:1024
    v_mfma_f32_16x16x32_bf16 v[60:63], v[172:175], v[156:159], v[60:63]
    ds_read_b64_tr_b16 v[166:167], v19 offset:1536
    v_mfma_f32_16x16x32_bf16 v[96:99], v[176:179], v[144:147], v[96:99]
    ds_read_b64_tr_b16 v[168:169], v16 offset:58368
    v_mfma_f32_16x16x32_bf16 v[100:103], v[176:179], v[148:151], v[100:103]
    ds_read_b64_tr_b16 v[170:171], v16 offset:58880
    v_mfma_f32_16x16x32_bf16 v[112:115], v[176:179], v[152:155], v[112:115]
    v_mfma_f32_16x16x32_bf16 v[116:119], v[176:179], v[156:159], v[116:119]
    v_mfma_f32_16x16x32_bf16 v[104:107], v[180:183], v[144:147], v[104:107]
    ds_read_b64_tr_b16 v[172:173], v17 offset:58368
    v_mfma_f32_16x16x32_bf16 v[108:111], v[180:183], v[148:151], v[108:111]
    ds_read_b64_tr_b16 v[174:175], v17 offset:58880
    v_mfma_f32_16x16x32_bf16 v[120:123], v[180:183], v[152:155], v[120:123]
    v_mfma_f32_16x16x32_bf16 v[124:127], v[180:183], v[156:159], v[124:127]
    v_mfma_f32_16x16x32_bf16 v[236:239], v[180:183], v[184:187], v[236:239]
    s_waitcnt lgkmcnt(4)
    v_mfma_f32_16x16x32_bf16 v[64:67], v[160:163], v[128:131], v[64:67]
    ds_read_b128 v[184:187], v14 offset:17408
    v_mfma_f32_16x16x32_bf16 v[68:71], v[160:163], v[132:135], v[68:71]
    ds_read_b64_tr_b16 v[176:177], v18 offset:9216
    v_mfma_f32_16x16x32_bf16 v[80:83], v[160:163], v[136:139], v[80:83]
    ds_read_b64_tr_b16 v[178:179], v18 offset:9728
    v_mfma_f32_16x16x32_bf16 v[84:87], v[160:163], v[140:143], v[84:87]
    ds_read_b64_tr_b16 v[180:181], v19 offset:9216
    v_mfma_f32_16x16x32_bf16 v[72:75], v[164:167], v[128:131], v[72:75]
    ds_read_b64_tr_b16 v[182:183], v19 offset:9728
    v_mfma_f32_16x16x32_bf16 v[76:79], v[164:167], v[132:135], v[76:79]
    v_mfma_f32_16x16x32_bf16 v[88:91], v[164:167], v[136:139], v[88:91]
    v_mfma_f32_16x16x32_bf16 v[92:95], v[164:167], v[140:143], v[92:95]
    s_waitcnt lgkmcnt(4)
    v_mfma_f32_16x16x32_bf16 v[232:235], v[164:167], v[184:187], v[232:235]
    v_mfma_f32_16x16x32_bf16 v[32:35], v[168:171], v[128:131], v[32:35]
    ds_read_b128 v[144:147], v9 offset:41984
    v_mfma_f32_16x16x32_bf16 v[36:39], v[168:171], v[132:135], v[36:39]
    ds_read_b128 v[148:151], v9 offset:44032
    v_mfma_f32_16x16x32_bf16 v[48:51], v[168:171], v[136:139], v[48:51]
    ds_read_b64_tr_b16 v[160:161], v18 offset:5120
    v_mfma_f32_16x16x32_bf16 v[52:55], v[168:171], v[140:143], v[52:55]
    ds_read_b64_tr_b16 v[162:163], v18 offset:5632
    v_mfma_f32_16x16x32_bf16 v[40:43], v[172:175], v[128:131], v[40:43]
    ds_read_b128 v[152:155], v9 offset:46080
    v_mfma_f32_16x16x32_bf16 v[44:47], v[172:175], v[132:135], v[44:47]
    ds_read_b128 v[156:159], v9 offset:48128
    v_mfma_f32_16x16x32_bf16 v[56:59], v[172:175], v[136:139], v[56:59]
    ds_read_b64_tr_b16 v[164:165], v19 offset:5120
    v_mfma_f32_16x16x32_bf16 v[60:63], v[172:175], v[140:143], v[60:63]
    ds_read_b64_tr_b16 v[166:167], v19 offset:5632
    s_waitcnt lgkmcnt(8)
    v_mfma_f32_16x16x32_bf16 v[96:99], v[176:179], v[128:131], v[96:99]
    ds_read_b64_tr_b16 v[168:169], v16 offset:62464
    v_mfma_f32_16x16x32_bf16 v[100:103], v[176:179], v[132:135], v[100:103]
    ds_read_b64_tr_b16 v[170:171], v16 offset:62976
    v_mfma_f32_16x16x32_bf16 v[112:115], v[176:179], v[136:139], v[112:115]
    v_mfma_f32_16x16x32_bf16 v[116:119], v[176:179], v[140:143], v[116:119]
    v_mfma_f32_16x16x32_bf16 v[104:107], v[180:183], v[128:131], v[104:107]
    ds_read_b64_tr_b16 v[172:173], v17 offset:62464
    v_mfma_f32_16x16x32_bf16 v[108:111], v[180:183], v[132:135], v[108:111]
    ds_read_b64_tr_b16 v[174:175], v17 offset:62976
    v_mfma_f32_16x16x32_bf16 v[120:123], v[180:183], v[136:139], v[120:123]
    v_mfma_f32_16x16x32_bf16 v[124:127], v[180:183], v[140:143], v[124:127]
    v_mfma_f32_16x16x32_bf16 v[236:239], v[180:183], v[184:187], v[236:239]
    s_waitcnt lgkmcnt(4)
    v_mfma_f32_16x16x32_bf16 v[64:67], v[160:163], v[144:147], v[64:67]
    ds_read_b128 v[184:187], v15 offset:17408
    v_mfma_f32_16x16x32_bf16 v[68:71], v[160:163], v[148:151], v[68:71]
    ds_read_b64_tr_b16 v[176:177], v18 offset:13312
    v_mfma_f32_16x16x32_bf16 v[80:83], v[160:163], v[152:155], v[80:83]
    ds_read_b64_tr_b16 v[178:179], v18 offset:13824
    v_mfma_f32_16x16x32_bf16 v[84:87], v[160:163], v[156:159], v[84:87]
    ds_read_b64_tr_b16 v[180:181], v19 offset:13312
    v_mfma_f32_16x16x32_bf16 v[72:75], v[164:167], v[144:147], v[72:75]
    ds_read_b64_tr_b16 v[182:183], v19 offset:13824
    v_mfma_f32_16x16x32_bf16 v[76:79], v[164:167], v[148:151], v[76:79]
    v_mfma_f32_16x16x32_bf16 v[88:91], v[164:167], v[152:155], v[88:91]
    v_mfma_f32_16x16x32_bf16 v[92:95], v[164:167], v[156:159], v[92:95]
    s_waitcnt lgkmcnt(4)
    v_mfma_f32_16x16x32_bf16 v[232:235], v[164:167], v[184:187], v[232:235]
    s_waitcnt lgkmcnt(0)
    s_barrier
    v_mfma_f32_16x16x32_bf16 v[32:35], v[168:171], v[144:147], v[32:35]
    ds_read_b128 v[128:131], v10 offset:18432
    v_mfma_f32_16x16x32_bf16 v[36:39], v[168:171], v[148:151], v[36:39]
    ds_read_b128 v[132:135], v10 offset:20480
    v_mfma_f32_16x16x32_bf16 v[48:51], v[168:171], v[152:155], v[48:51]
    ds_read_b64_tr_b16 v[160:161], v18 offset:43008
    v_mfma_f32_16x16x32_bf16 v[52:55], v[168:171], v[156:159], v[52:55]
    ds_read_b64_tr_b16 v[162:163], v18 offset:43520
    v_mfma_f32_16x16x32_bf16 v[40:43], v[172:175], v[144:147], v[40:43]
    ds_read_b128 v[136:139], v10 offset:22528
    v_mfma_f32_16x16x32_bf16 v[44:47], v[172:175], v[148:151], v[44:47]
    ds_read_b128 v[140:143], v10 offset:24576
    v_mfma_f32_16x16x32_bf16 v[56:59], v[172:175], v[152:155], v[56:59]
    ds_read_b64_tr_b16 v[164:165], v19 offset:43008
    v_mfma_f32_16x16x32_bf16 v[60:63], v[172:175], v[156:159], v[60:63]
    ds_read_b64_tr_b16 v[166:167], v19 offset:43520
    v_mfma_f32_16x16x32_bf16 v[96:99], v[176:179], v[144:147], v[96:99]
    ds_read_b64_tr_b16 v[168:169], v18 offset:34816
    v_mfma_f32_16x16x32_bf16 v[100:103], v[176:179], v[148:151], v[100:103]
    ds_read_b64_tr_b16 v[170:171], v18 offset:35328
    v_mfma_f32_16x16x32_bf16 v[112:115], v[176:179], v[152:155], v[112:115]
    v_mfma_f32_16x16x32_bf16 v[116:119], v[176:179], v[156:159], v[116:119]
    v_mfma_f32_16x16x32_bf16 v[104:107], v[180:183], v[144:147], v[104:107]
    ds_read_b64_tr_b16 v[172:173], v19 offset:34816
    v_mfma_f32_16x16x32_bf16 v[108:111], v[180:183], v[148:151], v[108:111]
    ds_read_b64_tr_b16 v[174:175], v19 offset:35328
    v_mfma_f32_16x16x32_bf16 v[120:123], v[180:183], v[152:155], v[120:123]
    v_mfma_f32_16x16x32_bf16 v[124:127], v[180:183], v[156:159], v[124:127]
    v_mfma_f32_16x16x32_bf16 v[236:239], v[180:183], v[184:187], v[236:239]
    s_waitcnt lgkmcnt(4)
    v_mfma_f32_16x16x32_bf16 v[64:67], v[160:163], v[128:131], v[64:67]
    ds_read_b128 v[184:187], v14 offset:59392
    v_mfma_f32_16x16x32_bf16 v[68:71], v[160:163], v[132:135], v[68:71]
    ds_read_b64_tr_b16 v[176:177], v18 offset:51200
    v_mfma_f32_16x16x32_bf16 v[80:83], v[160:163], v[136:139], v[80:83]
    ds_read_b64_tr_b16 v[178:179], v18 offset:51712
    v_mfma_f32_16x16x32_bf16 v[84:87], v[160:163], v[140:143], v[84:87]
    ds_read_b64_tr_b16 v[180:181], v19 offset:51200
    v_mfma_f32_16x16x32_bf16 v[72:75], v[164:167], v[128:131], v[72:75]
    ds_read_b64_tr_b16 v[182:183], v19 offset:51712
    v_mfma_f32_16x16x32_bf16 v[76:79], v[164:167], v[132:135], v[76:79]
    v_mfma_f32_16x16x32_bf16 v[88:91], v[164:167], v[136:139], v[88:91]
    v_mfma_f32_16x16x32_bf16 v[92:95], v[164:167], v[140:143], v[92:95]
    s_waitcnt lgkmcnt(4)
    v_mfma_f32_16x16x32_bf16 v[232:235], v[164:167], v[184:187], v[232:235]
    v_mfma_f32_16x16x32_bf16 v[32:35], v[168:171], v[128:131], v[32:35]
    ds_read_b128 v[144:147], v11 offset:18432
    v_mfma_f32_16x16x32_bf16 v[36:39], v[168:171], v[132:135], v[36:39]
    ds_read_b128 v[148:151], v11 offset:20480
    v_mfma_f32_16x16x32_bf16 v[48:51], v[168:171], v[136:139], v[48:51]
    ds_read_b64_tr_b16 v[160:161], v18 offset:47104
    v_mfma_f32_16x16x32_bf16 v[52:55], v[168:171], v[140:143], v[52:55]
    ds_read_b64_tr_b16 v[162:163], v18 offset:47616
    v_mfma_f32_16x16x32_bf16 v[40:43], v[172:175], v[128:131], v[40:43]
    ds_read_b128 v[152:155], v11 offset:22528
    v_mfma_f32_16x16x32_bf16 v[44:47], v[172:175], v[132:135], v[44:47]
    ds_read_b128 v[156:159], v11 offset:24576
    v_mfma_f32_16x16x32_bf16 v[56:59], v[172:175], v[136:139], v[56:59]
    ds_read_b64_tr_b16 v[164:165], v19 offset:47104
    v_mfma_f32_16x16x32_bf16 v[60:63], v[172:175], v[140:143], v[60:63]
    ds_read_b64_tr_b16 v[166:167], v19 offset:47616
    s_waitcnt lgkmcnt(8)
    v_mfma_f32_16x16x32_bf16 v[96:99], v[176:179], v[128:131], v[96:99]
    ds_read_b64_tr_b16 v[168:169], v18 offset:38912
    v_mfma_f32_16x16x32_bf16 v[100:103], v[176:179], v[132:135], v[100:103]
    ds_read_b64_tr_b16 v[170:171], v18 offset:39424
    v_mfma_f32_16x16x32_bf16 v[112:115], v[176:179], v[136:139], v[112:115]
    v_mfma_f32_16x16x32_bf16 v[116:119], v[176:179], v[140:143], v[116:119]
    v_mfma_f32_16x16x32_bf16 v[104:107], v[180:183], v[128:131], v[104:107]
    ds_read_b64_tr_b16 v[172:173], v19 offset:38912
    v_mfma_f32_16x16x32_bf16 v[108:111], v[180:183], v[132:135], v[108:111]
    ds_read_b64_tr_b16 v[174:175], v19 offset:39424
    v_mfma_f32_16x16x32_bf16 v[120:123], v[180:183], v[136:139], v[120:123]
    v_mfma_f32_16x16x32_bf16 v[124:127], v[180:183], v[140:143], v[124:127]
    v_mfma_f32_16x16x32_bf16 v[236:239], v[180:183], v[184:187], v[236:239]
    s_waitcnt lgkmcnt(4)
    v_mfma_f32_16x16x32_bf16 v[64:67], v[160:163], v[144:147], v[64:67]
    ds_read_b128 v[184:187], v15 offset:59392
    v_mfma_f32_16x16x32_bf16 v[68:71], v[160:163], v[148:151], v[68:71]
    ds_read_b64_tr_b16 v[176:177], v18 offset:55296
    v_mfma_f32_16x16x32_bf16 v[80:83], v[160:163], v[152:155], v[80:83]
    ds_read_b64_tr_b16 v[178:179], v18 offset:55808
    v_mfma_f32_16x16x32_bf16 v[84:87], v[160:163], v[156:159], v[84:87]
    ds_read_b64_tr_b16 v[180:181], v19 offset:55296
    v_mfma_f32_16x16x32_bf16 v[72:75], v[164:167], v[144:147], v[72:75]
    ds_read_b64_tr_b16 v[182:183], v19 offset:55808
    v_mfma_f32_16x16x32_bf16 v[76:79], v[164:167], v[148:151], v[76:79]
    v_mfma_f32_16x16x32_bf16 v[88:91], v[164:167], v[152:155], v[88:91]
    v_mfma_f32_16x16x32_bf16 v[92:95], v[164:167], v[156:159], v[92:95]
    s_waitcnt lgkmcnt(4)
    v_mfma_f32_16x16x32_bf16 v[232:235], v[164:167], v[184:187], v[232:235]
    s_waitcnt lgkmcnt(0)
    s_barrier
    v_mfma_f32_16x16x32_bf16 v[32:35], v[168:171], v[144:147], v[32:35]
    ds_read_b128 v[128:131], v8 offset:0
    v_mfma_f32_16x16x32_bf16 v[36:39], v[168:171], v[148:151], v[36:39]
    ds_read_b128 v[132:135], v8 offset:2048
    v_mfma_f32_16x16x32_bf16 v[48:51], v[168:171], v[152:155], v[48:51]
    ds_read_b64_tr_b16 v[160:161], v16 offset:24576
    v_mfma_f32_16x16x32_bf16 v[52:55], v[168:171], v[156:159], v[52:55]
    ds_read_b64_tr_b16 v[162:163], v16 offset:25088
    v_mfma_f32_16x16x32_bf16 v[40:43], v[172:175], v[144:147], v[40:43]
    ds_read_b128 v[136:139], v8 offset:4096
    v_mfma_f32_16x16x32_bf16 v[44:47], v[172:175], v[148:151], v[44:47]
    ds_read_b128 v[140:143], v8 offset:6144
    v_mfma_f32_16x16x32_bf16 v[56:59], v[172:175], v[152:155], v[56:59]
    ds_read_b64_tr_b16 v[164:165], v17 offset:24576
    v_mfma_f32_16x16x32_bf16 v[60:63], v[172:175], v[156:159], v[60:63]
    ds_read_b64_tr_b16 v[166:167], v17 offset:25088
    v_mfma_f32_16x16x32_bf16 v[96:99], v[176:179], v[144:147], v[96:99]
    ds_read_b64_tr_b16 v[168:169], v16 offset:16384
    v_mfma_f32_16x16x32_bf16 v[100:103], v[176:179], v[148:151], v[100:103]
    ds_read_b64_tr_b16 v[170:171], v16 offset:16896
    v_mfma_f32_16x16x32_bf16 v[112:115], v[176:179], v[152:155], v[112:115]
    v_mfma_f32_16x16x32_bf16 v[116:119], v[176:179], v[156:159], v[116:119]
    v_mfma_f32_16x16x32_bf16 v[104:107], v[180:183], v[144:147], v[104:107]
    ds_read_b64_tr_b16 v[172:173], v17 offset:16384
    v_mfma_f32_16x16x32_bf16 v[108:111], v[180:183], v[148:151], v[108:111]
    ds_read_b64_tr_b16 v[174:175], v17 offset:16896
    v_mfma_f32_16x16x32_bf16 v[120:123], v[180:183], v[152:155], v[120:123]
    v_mfma_f32_16x16x32_bf16 v[124:127], v[180:183], v[156:159], v[124:127]
    v_mfma_f32_16x16x32_bf16 v[236:239], v[180:183], v[184:187], v[236:239]
    s_waitcnt lgkmcnt(4)
    v_mfma_f32_16x16x32_bf16 v[64:67], v[160:163], v[128:131], v[64:67]
    ds_read_b128 v[184:187], v12 offset:40960
    v_mfma_f32_16x16x32_bf16 v[68:71], v[160:163], v[132:135], v[68:71]
    ds_read_b64_tr_b16 v[176:177], v16 offset:32768
    v_mfma_f32_16x16x32_bf16 v[80:83], v[160:163], v[136:139], v[80:83]
    ds_read_b64_tr_b16 v[178:179], v16 offset:33280
    v_mfma_f32_16x16x32_bf16 v[84:87], v[160:163], v[140:143], v[84:87]
    ds_read_b64_tr_b16 v[180:181], v17 offset:32768
    v_mfma_f32_16x16x32_bf16 v[72:75], v[164:167], v[128:131], v[72:75]
    ds_read_b64_tr_b16 v[182:183], v17 offset:33280
    v_mfma_f32_16x16x32_bf16 v[76:79], v[164:167], v[132:135], v[76:79]
    v_mfma_f32_16x16x32_bf16 v[88:91], v[164:167], v[136:139], v[88:91]
    v_mfma_f32_16x16x32_bf16 v[92:95], v[164:167], v[140:143], v[92:95]
    s_waitcnt lgkmcnt(4)
    v_mfma_f32_16x16x32_bf16 v[232:235], v[164:167], v[184:187], v[232:235]
    v_mfma_f32_16x16x32_bf16 v[32:35], v[168:171], v[128:131], v[32:35]
    ds_read_b128 v[144:147], v9 offset:0
    v_mfma_f32_16x16x32_bf16 v[36:39], v[168:171], v[132:135], v[36:39]
    ds_read_b128 v[148:151], v9 offset:2048
    v_mfma_f32_16x16x32_bf16 v[48:51], v[168:171], v[136:139], v[48:51]
    ds_read_b64_tr_b16 v[160:161], v16 offset:28672
    v_mfma_f32_16x16x32_bf16 v[52:55], v[168:171], v[140:143], v[52:55]
    ds_read_b64_tr_b16 v[162:163], v16 offset:29184
    v_mfma_f32_16x16x32_bf16 v[40:43], v[172:175], v[128:131], v[40:43]
    ds_read_b128 v[152:155], v9 offset:4096
    v_mfma_f32_16x16x32_bf16 v[44:47], v[172:175], v[132:135], v[44:47]
    ds_read_b128 v[156:159], v9 offset:6144
    v_mfma_f32_16x16x32_bf16 v[56:59], v[172:175], v[136:139], v[56:59]
    ds_read_b64_tr_b16 v[164:165], v17 offset:28672
    v_mfma_f32_16x16x32_bf16 v[60:63], v[172:175], v[140:143], v[60:63]
    ds_read_b64_tr_b16 v[166:167], v17 offset:29184
    s_waitcnt lgkmcnt(8)
    v_mfma_f32_16x16x32_bf16 v[96:99], v[176:179], v[128:131], v[96:99]
    ds_read_b64_tr_b16 v[168:169], v16 offset:20480
    v_mfma_f32_16x16x32_bf16 v[100:103], v[176:179], v[132:135], v[100:103]
    ds_read_b64_tr_b16 v[170:171], v16 offset:20992
    v_mfma_f32_16x16x32_bf16 v[112:115], v[176:179], v[136:139], v[112:115]
    v_mfma_f32_16x16x32_bf16 v[116:119], v[176:179], v[140:143], v[116:119]
    v_mfma_f32_16x16x32_bf16 v[104:107], v[180:183], v[128:131], v[104:107]
    ds_read_b64_tr_b16 v[172:173], v17 offset:20480
    v_mfma_f32_16x16x32_bf16 v[108:111], v[180:183], v[132:135], v[108:111]
    ds_read_b64_tr_b16 v[174:175], v17 offset:20992
    v_mfma_f32_16x16x32_bf16 v[120:123], v[180:183], v[136:139], v[120:123]
    v_mfma_f32_16x16x32_bf16 v[124:127], v[180:183], v[140:143], v[124:127]
    v_mfma_f32_16x16x32_bf16 v[236:239], v[180:183], v[184:187], v[236:239]
    s_waitcnt lgkmcnt(4)
    v_mfma_f32_16x16x32_bf16 v[64:67], v[160:163], v[144:147], v[64:67]
    ds_read_b128 v[184:187], v13 offset:40960
    v_mfma_f32_16x16x32_bf16 v[68:71], v[160:163], v[148:151], v[68:71]
    ds_read_b64_tr_b16 v[176:177], v16 offset:36864
    v_mfma_f32_16x16x32_bf16 v[80:83], v[160:163], v[152:155], v[80:83]
    ds_read_b64_tr_b16 v[178:179], v16 offset:37376
    v_mfma_f32_16x16x32_bf16 v[84:87], v[160:163], v[156:159], v[84:87]
    ds_read_b64_tr_b16 v[180:181], v17 offset:36864
    v_mfma_f32_16x16x32_bf16 v[72:75], v[164:167], v[144:147], v[72:75]
    ds_read_b64_tr_b16 v[182:183], v17 offset:37376
    v_mfma_f32_16x16x32_bf16 v[76:79], v[164:167], v[148:151], v[76:79]
    v_mfma_f32_16x16x32_bf16 v[88:91], v[164:167], v[152:155], v[88:91]
    v_mfma_f32_16x16x32_bf16 v[92:95], v[164:167], v[156:159], v[92:95]
    s_waitcnt lgkmcnt(4)
    v_mfma_f32_16x16x32_bf16 v[232:235], v[164:167], v[184:187], v[232:235]
    s_waitcnt lgkmcnt(0)
    s_barrier
    v_mfma_f32_16x16x32_bf16 v[32:35], v[168:171], v[144:147], v[32:35]
    ds_read_b128 v[128:131], v8 offset:41984
    v_mfma_f32_16x16x32_bf16 v[36:39], v[168:171], v[148:151], v[36:39]
    ds_read_b128 v[132:135], v8 offset:44032
    v_mfma_f32_16x16x32_bf16 v[48:51], v[168:171], v[152:155], v[48:51]
    ds_read_b64_tr_b16 v[160:161], v18 offset:1024
    v_mfma_f32_16x16x32_bf16 v[52:55], v[168:171], v[156:159], v[52:55]
    ds_read_b64_tr_b16 v[162:163], v18 offset:1536
    v_mfma_f32_16x16x32_bf16 v[40:43], v[172:175], v[144:147], v[40:43]
    ds_read_b128 v[136:139], v8 offset:46080
    v_mfma_f32_16x16x32_bf16 v[44:47], v[172:175], v[148:151], v[44:47]
    ds_read_b128 v[140:143], v8 offset:48128
    v_mfma_f32_16x16x32_bf16 v[56:59], v[172:175], v[152:155], v[56:59]
    ds_read_b64_tr_b16 v[164:165], v19 offset:1024
    v_mfma_f32_16x16x32_bf16 v[60:63], v[172:175], v[156:159], v[60:63]
    ds_read_b64_tr_b16 v[166:167], v19 offset:1536
    v_mfma_f32_16x16x32_bf16 v[96:99], v[176:179], v[144:147], v[96:99]
    ds_read_b64_tr_b16 v[168:169], v16 offset:58368
    v_mfma_f32_16x16x32_bf16 v[100:103], v[176:179], v[148:151], v[100:103]
    ds_read_b64_tr_b16 v[170:171], v16 offset:58880
    v_mfma_f32_16x16x32_bf16 v[112:115], v[176:179], v[152:155], v[112:115]
    v_mfma_f32_16x16x32_bf16 v[116:119], v[176:179], v[156:159], v[116:119]
    v_mfma_f32_16x16x32_bf16 v[104:107], v[180:183], v[144:147], v[104:107]
    ds_read_b64_tr_b16 v[172:173], v17 offset:58368
    v_mfma_f32_16x16x32_bf16 v[108:111], v[180:183], v[148:151], v[108:111]
    ds_read_b64_tr_b16 v[174:175], v17 offset:58880
    v_mfma_f32_16x16x32_bf16 v[120:123], v[180:183], v[152:155], v[120:123]
    v_mfma_f32_16x16x32_bf16 v[124:127], v[180:183], v[156:159], v[124:127]
    v_mfma_f32_16x16x32_bf16 v[236:239], v[180:183], v[184:187], v[236:239]
    s_waitcnt lgkmcnt(4)
    v_mfma_f32_16x16x32_bf16 v[64:67], v[160:163], v[128:131], v[64:67]
    ds_read_b128 v[184:187], v14 offset:17408
    v_mfma_f32_16x16x32_bf16 v[68:71], v[160:163], v[132:135], v[68:71]
    ds_read_b64_tr_b16 v[176:177], v18 offset:9216
    v_mfma_f32_16x16x32_bf16 v[80:83], v[160:163], v[136:139], v[80:83]
    ds_read_b64_tr_b16 v[178:179], v18 offset:9728
    v_mfma_f32_16x16x32_bf16 v[84:87], v[160:163], v[140:143], v[84:87]
    ds_read_b64_tr_b16 v[180:181], v19 offset:9216
    v_mfma_f32_16x16x32_bf16 v[72:75], v[164:167], v[128:131], v[72:75]
    ds_read_b64_tr_b16 v[182:183], v19 offset:9728
    v_mfma_f32_16x16x32_bf16 v[76:79], v[164:167], v[132:135], v[76:79]
    v_mfma_f32_16x16x32_bf16 v[88:91], v[164:167], v[136:139], v[88:91]
    v_mfma_f32_16x16x32_bf16 v[92:95], v[164:167], v[140:143], v[92:95]
    s_waitcnt lgkmcnt(4)
    v_mfma_f32_16x16x32_bf16 v[232:235], v[164:167], v[184:187], v[232:235]
    v_mfma_f32_16x16x32_bf16 v[32:35], v[168:171], v[128:131], v[32:35]
    ds_read_b128 v[144:147], v9 offset:41984
    v_mfma_f32_16x16x32_bf16 v[36:39], v[168:171], v[132:135], v[36:39]
    ds_read_b128 v[148:151], v9 offset:44032
    v_mfma_f32_16x16x32_bf16 v[48:51], v[168:171], v[136:139], v[48:51]
    ds_read_b64_tr_b16 v[160:161], v18 offset:5120
    v_mfma_f32_16x16x32_bf16 v[52:55], v[168:171], v[140:143], v[52:55]
    ds_read_b64_tr_b16 v[162:163], v18 offset:5632
    v_mfma_f32_16x16x32_bf16 v[40:43], v[172:175], v[128:131], v[40:43]
    ds_read_b128 v[152:155], v9 offset:46080
    v_mfma_f32_16x16x32_bf16 v[44:47], v[172:175], v[132:135], v[44:47]
    ds_read_b128 v[156:159], v9 offset:48128
    v_mfma_f32_16x16x32_bf16 v[56:59], v[172:175], v[136:139], v[56:59]
    ds_read_b64_tr_b16 v[164:165], v19 offset:5120
    v_mfma_f32_16x16x32_bf16 v[60:63], v[172:175], v[140:143], v[60:63]
    ds_read_b64_tr_b16 v[166:167], v19 offset:5632
    s_waitcnt lgkmcnt(8)
    v_mfma_f32_16x16x32_bf16 v[96:99], v[176:179], v[128:131], v[96:99]
    ds_read_b64_tr_b16 v[168:169], v16 offset:62464
    v_mfma_f32_16x16x32_bf16 v[100:103], v[176:179], v[132:135], v[100:103]
    ds_read_b64_tr_b16 v[170:171], v16 offset:62976
    v_mfma_f32_16x16x32_bf16 v[112:115], v[176:179], v[136:139], v[112:115]
    v_mfma_f32_16x16x32_bf16 v[116:119], v[176:179], v[140:143], v[116:119]
    v_mfma_f32_16x16x32_bf16 v[104:107], v[180:183], v[128:131], v[104:107]
    ds_read_b64_tr_b16 v[172:173], v17 offset:62464
    v_mfma_f32_16x16x32_bf16 v[108:111], v[180:183], v[132:135], v[108:111]
    ds_read_b64_tr_b16 v[174:175], v17 offset:62976
    v_mfma_f32_16x16x32_bf16 v[120:123], v[180:183], v[136:139], v[120:123]
    v_mfma_f32_16x16x32_bf16 v[124:127], v[180:183], v[140:143], v[124:127]
    v_mfma_f32_16x16x32_bf16 v[236:239], v[180:183], v[184:187], v[236:239]
    s_waitcnt lgkmcnt(4)
    v_mfma_f32_16x16x32_bf16 v[64:67], v[160:163], v[144:147], v[64:67]
    ds_read_b128 v[184:187], v15 offset:17408
    v_mfma_f32_16x16x32_bf16 v[68:71], v[160:163], v[148:151], v[68:71]
    ds_read_b64_tr_b16 v[176:177], v18 offset:13312
    v_mfma_f32_16x16x32_bf16 v[80:83], v[160:163], v[152:155], v[80:83]
    ds_read_b64_tr_b16 v[178:179], v18 offset:13824
    v_mfma_f32_16x16x32_bf16 v[84:87], v[160:163], v[156:159], v[84:87]
    ds_read_b64_tr_b16 v[180:181], v19 offset:13312
    v_mfma_f32_16x16x32_bf16 v[72:75], v[164:167], v[144:147], v[72:75]
    ds_read_b64_tr_b16 v[182:183], v19 offset:13824
    v_mfma_f32_16x16x32_bf16 v[76:79], v[164:167], v[148:151], v[76:79]
    v_mfma_f32_16x16x32_bf16 v[88:91], v[164:167], v[152:155], v[88:91]
    v_mfma_f32_16x16x32_bf16 v[92:95], v[164:167], v[156:159], v[92:95]
    s_waitcnt lgkmcnt(4)
    v_mfma_f32_16x16x32_bf16 v[232:235], v[164:167], v[184:187], v[232:235]
    s_waitcnt lgkmcnt(0)
    s_barrier
    v_mfma_f32_16x16x32_bf16 v[32:35], v[168:171], v[144:147], v[32:35]
    ds_read_b128 v[128:131], v10 offset:18432
    v_mfma_f32_16x16x32_bf16 v[36:39], v[168:171], v[148:151], v[36:39]
    ds_read_b128 v[132:135], v10 offset:20480
    v_mfma_f32_16x16x32_bf16 v[48:51], v[168:171], v[152:155], v[48:51]
    ds_read_b64_tr_b16 v[160:161], v18 offset:43008
    v_mfma_f32_16x16x32_bf16 v[52:55], v[168:171], v[156:159], v[52:55]
    ds_read_b64_tr_b16 v[162:163], v18 offset:43520
    v_mfma_f32_16x16x32_bf16 v[40:43], v[172:175], v[144:147], v[40:43]
    ds_read_b128 v[136:139], v10 offset:22528
    v_mfma_f32_16x16x32_bf16 v[44:47], v[172:175], v[148:151], v[44:47]
    ds_read_b128 v[140:143], v10 offset:24576
    v_mfma_f32_16x16x32_bf16 v[56:59], v[172:175], v[152:155], v[56:59]
    ds_read_b64_tr_b16 v[164:165], v19 offset:43008
    v_mfma_f32_16x16x32_bf16 v[60:63], v[172:175], v[156:159], v[60:63]
    ds_read_b64_tr_b16 v[166:167], v19 offset:43520
    v_mfma_f32_16x16x32_bf16 v[96:99], v[176:179], v[144:147], v[96:99]
    ds_read_b64_tr_b16 v[168:169], v18 offset:34816
    v_mfma_f32_16x16x32_bf16 v[100:103], v[176:179], v[148:151], v[100:103]
    ds_read_b64_tr_b16 v[170:171], v18 offset:35328
    v_mfma_f32_16x16x32_bf16 v[112:115], v[176:179], v[152:155], v[112:115]
    v_mfma_f32_16x16x32_bf16 v[116:119], v[176:179], v[156:159], v[116:119]
    v_mfma_f32_16x16x32_bf16 v[104:107], v[180:183], v[144:147], v[104:107]
    ds_read_b64_tr_b16 v[172:173], v19 offset:34816
    v_mfma_f32_16x16x32_bf16 v[108:111], v[180:183], v[148:151], v[108:111]
    ds_read_b64_tr_b16 v[174:175], v19 offset:35328
    v_mfma_f32_16x16x32_bf16 v[120:123], v[180:183], v[152:155], v[120:123]
    v_mfma_f32_16x16x32_bf16 v[124:127], v[180:183], v[156:159], v[124:127]
    v_mfma_f32_16x16x32_bf16 v[236:239], v[180:183], v[184:187], v[236:239]
    s_waitcnt lgkmcnt(4)
    v_mfma_f32_16x16x32_bf16 v[64:67], v[160:163], v[128:131], v[64:67]
    ds_read_b128 v[184:187], v14 offset:59392
    v_mfma_f32_16x16x32_bf16 v[68:71], v[160:163], v[132:135], v[68:71]
    ds_read_b64_tr_b16 v[176:177], v18 offset:51200
    v_mfma_f32_16x16x32_bf16 v[80:83], v[160:163], v[136:139], v[80:83]
    ds_read_b64_tr_b16 v[178:179], v18 offset:51712
    v_mfma_f32_16x16x32_bf16 v[84:87], v[160:163], v[140:143], v[84:87]
    ds_read_b64_tr_b16 v[180:181], v19 offset:51200
    v_mfma_f32_16x16x32_bf16 v[72:75], v[164:167], v[128:131], v[72:75]
    ds_read_b64_tr_b16 v[182:183], v19 offset:51712
    v_mfma_f32_16x16x32_bf16 v[76:79], v[164:167], v[132:135], v[76:79]
    v_mfma_f32_16x16x32_bf16 v[88:91], v[164:167], v[136:139], v[88:91]
    v_mfma_f32_16x16x32_bf16 v[92:95], v[164:167], v[140:143], v[92:95]
    s_waitcnt lgkmcnt(4)
    v_mfma_f32_16x16x32_bf16 v[232:235], v[164:167], v[184:187], v[232:235]
    v_mfma_f32_16x16x32_bf16 v[32:35], v[168:171], v[128:131], v[32:35]
    ds_read_b128 v[144:147], v11 offset:18432
    v_mfma_f32_16x16x32_bf16 v[36:39], v[168:171], v[132:135], v[36:39]
    ds_read_b128 v[148:151], v11 offset:20480
    v_mfma_f32_16x16x32_bf16 v[48:51], v[168:171], v[136:139], v[48:51]
    ds_read_b64_tr_b16 v[160:161], v18 offset:47104
    v_mfma_f32_16x16x32_bf16 v[52:55], v[168:171], v[140:143], v[52:55]
    ds_read_b64_tr_b16 v[162:163], v18 offset:47616
    v_mfma_f32_16x16x32_bf16 v[40:43], v[172:175], v[128:131], v[40:43]
    ds_read_b128 v[152:155], v11 offset:22528
    v_mfma_f32_16x16x32_bf16 v[44:47], v[172:175], v[132:135], v[44:47]
    ds_read_b128 v[156:159], v11 offset:24576
    v_mfma_f32_16x16x32_bf16 v[56:59], v[172:175], v[136:139], v[56:59]
    ds_read_b64_tr_b16 v[164:165], v19 offset:47104
    v_mfma_f32_16x16x32_bf16 v[60:63], v[172:175], v[140:143], v[60:63]
    ds_read_b64_tr_b16 v[166:167], v19 offset:47616
    s_waitcnt lgkmcnt(8)
    v_mfma_f32_16x16x32_bf16 v[96:99], v[176:179], v[128:131], v[96:99]
    ds_read_b64_tr_b16 v[168:169], v18 offset:38912
    v_mfma_f32_16x16x32_bf16 v[100:103], v[176:179], v[132:135], v[100:103]
    ds_read_b64_tr_b16 v[170:171], v18 offset:39424
    v_mfma_f32_16x16x32_bf16 v[112:115], v[176:179], v[136:139], v[112:115]
    v_mfma_f32_16x16x32_bf16 v[116:119], v[176:179], v[140:143], v[116:119]
    v_mfma_f32_16x16x32_bf16 v[104:107], v[180:183], v[128:131], v[104:107]
    ds_read_b64_tr_b16 v[172:173], v19 offset:38912
    v_mfma_f32_16x16x32_bf16 v[108:111], v[180:183], v[132:135], v[108:111]
    ds_read_b64_tr_b16 v[174:175], v19 offset:39424
    v_mfma_f32_16x16x32_bf16 v[120:123], v[180:183], v[136:139], v[120:123]
    v_mfma_f32_16x16x32_bf16 v[124:127], v[180:183], v[140:143], v[124:127]
    v_mfma_f32_16x16x32_bf16 v[236:239], v[180:183], v[184:187], v[236:239]
    s_waitcnt lgkmcnt(4)
    v_mfma_f32_16x16x32_bf16 v[64:67], v[160:163], v[144:147], v[64:67]
    ds_read_b128 v[184:187], v15 offset:59392
    v_mfma_f32_16x16x32_bf16 v[68:71], v[160:163], v[148:151], v[68:71]
    ds_read_b64_tr_b16 v[176:177], v18 offset:55296
    v_mfma_f32_16x16x32_bf16 v[80:83], v[160:163], v[152:155], v[80:83]
    ds_read_b64_tr_b16 v[178:179], v18 offset:55808
    v_mfma_f32_16x16x32_bf16 v[84:87], v[160:163], v[156:159], v[84:87]
    ds_read_b64_tr_b16 v[180:181], v19 offset:55296
    v_mfma_f32_16x16x32_bf16 v[72:75], v[164:167], v[144:147], v[72:75]
    ds_read_b64_tr_b16 v[182:183], v19 offset:55808
    v_mfma_f32_16x16x32_bf16 v[76:79], v[164:167], v[148:151], v[76:79]
    v_mfma_f32_16x16x32_bf16 v[88:91], v[164:167], v[152:155], v[88:91]
    v_mfma_f32_16x16x32_bf16 v[92:95], v[164:167], v[156:159], v[92:95]
    s_waitcnt lgkmcnt(4)
    v_mfma_f32_16x16x32_bf16 v[232:235], v[164:167], v[184:187], v[232:235]
    s_waitcnt lgkmcnt(0)
    s_barrier
    v_mfma_f32_16x16x32_bf16 v[32:35], v[168:171], v[144:147], v[32:35]
    ds_read_b128 v[128:131], v8 offset:0
    v_mfma_f32_16x16x32_bf16 v[36:39], v[168:171], v[148:151], v[36:39]
    ds_read_b128 v[132:135], v8 offset:2048
    v_mfma_f32_16x16x32_bf16 v[48:51], v[168:171], v[152:155], v[48:51]
    ds_read_b64_tr_b16 v[160:161], v16 offset:24576
    v_mfma_f32_16x16x32_bf16 v[52:55], v[168:171], v[156:159], v[52:55]
    ds_read_b64_tr_b16 v[162:163], v16 offset:25088
    v_mfma_f32_16x16x32_bf16 v[40:43], v[172:175], v[144:147], v[40:43]
    ds_read_b128 v[136:139], v8 offset:4096
    v_mfma_f32_16x16x32_bf16 v[44:47], v[172:175], v[148:151], v[44:47]
    ds_read_b128 v[140:143], v8 offset:6144
    v_mfma_f32_16x16x32_bf16 v[56:59], v[172:175], v[152:155], v[56:59]
    ds_read_b64_tr_b16 v[164:165], v17 offset:24576
    v_mfma_f32_16x16x32_bf16 v[60:63], v[172:175], v[156:159], v[60:63]
    ds_read_b64_tr_b16 v[166:167], v17 offset:25088
    v_mfma_f32_16x16x32_bf16 v[96:99], v[176:179], v[144:147], v[96:99]
    ds_read_b64_tr_b16 v[168:169], v16 offset:16384
    v_mfma_f32_16x16x32_bf16 v[100:103], v[176:179], v[148:151], v[100:103]
    ds_read_b64_tr_b16 v[170:171], v16 offset:16896
    v_mfma_f32_16x16x32_bf16 v[112:115], v[176:179], v[152:155], v[112:115]
    v_mfma_f32_16x16x32_bf16 v[116:119], v[176:179], v[156:159], v[116:119]
    v_mfma_f32_16x16x32_bf16 v[104:107], v[180:183], v[144:147], v[104:107]
    ds_read_b64_tr_b16 v[172:173], v17 offset:16384
    v_mfma_f32_16x16x32_bf16 v[108:111], v[180:183], v[148:151], v[108:111]
    ds_read_b64_tr_b16 v[174:175], v17 offset:16896
    v_mfma_f32_16x16x32_bf16 v[120:123], v[180:183], v[152:155], v[120:123]
    v_mfma_f32_16x16x32_bf16 v[124:127], v[180:183], v[156:159], v[124:127]
    v_mfma_f32_16x16x32_bf16 v[236:239], v[180:183], v[184:187], v[236:239]
    s_waitcnt lgkmcnt(4)
    v_mfma_f32_16x16x32_bf16 v[64:67], v[160:163], v[128:131], v[64:67]
    ds_read_b128 v[184:187], v12 offset:40960
    v_mfma_f32_16x16x32_bf16 v[68:71], v[160:163], v[132:135], v[68:71]
    ds_read_b64_tr_b16 v[176:177], v16 offset:32768
    v_mfma_f32_16x16x32_bf16 v[80:83], v[160:163], v[136:139], v[80:83]
    ds_read_b64_tr_b16 v[178:179], v16 offset:33280
    v_mfma_f32_16x16x32_bf16 v[84:87], v[160:163], v[140:143], v[84:87]
    ds_read_b64_tr_b16 v[180:181], v17 offset:32768
    v_mfma_f32_16x16x32_bf16 v[72:75], v[164:167], v[128:131], v[72:75]
    ds_read_b64_tr_b16 v[182:183], v17 offset:33280
    v_mfma_f32_16x16x32_bf16 v[76:79], v[164:167], v[132:135], v[76:79]
    v_mfma_f32_16x16x32_bf16 v[88:91], v[164:167], v[136:139], v[88:91]
    v_mfma_f32_16x16x32_bf16 v[92:95], v[164:167], v[140:143], v[92:95]
    s_waitcnt lgkmcnt(4)
    v_mfma_f32_16x16x32_bf16 v[232:235], v[164:167], v[184:187], v[232:235]
    v_mfma_f32_16x16x32_bf16 v[32:35], v[168:171], v[128:131], v[32:35]
    ds_read_b128 v[144:147], v9 offset:0
    v_mfma_f32_16x16x32_bf16 v[36:39], v[168:171], v[132:135], v[36:39]
    ds_read_b128 v[148:151], v9 offset:2048
    v_mfma_f32_16x16x32_bf16 v[48:51], v[168:171], v[136:139], v[48:51]
    ds_read_b64_tr_b16 v[160:161], v16 offset:28672
    v_mfma_f32_16x16x32_bf16 v[52:55], v[168:171], v[140:143], v[52:55]
    ds_read_b64_tr_b16 v[162:163], v16 offset:29184
    v_mfma_f32_16x16x32_bf16 v[40:43], v[172:175], v[128:131], v[40:43]
    ds_read_b128 v[152:155], v9 offset:4096
    v_mfma_f32_16x16x32_bf16 v[44:47], v[172:175], v[132:135], v[44:47]
    ds_read_b128 v[156:159], v9 offset:6144
    v_mfma_f32_16x16x32_bf16 v[56:59], v[172:175], v[136:139], v[56:59]
    ds_read_b64_tr_b16 v[164:165], v17 offset:28672
    v_mfma_f32_16x16x32_bf16 v[60:63], v[172:175], v[140:143], v[60:63]
    ds_read_b64_tr_b16 v[166:167], v17 offset:29184
    s_waitcnt lgkmcnt(8)
    v_mfma_f32_16x16x32_bf16 v[96:99], v[176:179], v[128:131], v[96:99]
    ds_read_b64_tr_b16 v[168:169], v16 offset:20480
    v_mfma_f32_16x16x32_bf16 v[100:103], v[176:179], v[132:135], v[100:103]
    ds_read_b64_tr_b16 v[170:171], v16 offset:20992
    v_mfma_f32_16x16x32_bf16 v[112:115], v[176:179], v[136:139], v[112:115]
    v_mfma_f32_16x16x32_bf16 v[116:119], v[176:179], v[140:143], v[116:119]
    v_mfma_f32_16x16x32_bf16 v[104:107], v[180:183], v[128:131], v[104:107]
    ds_read_b64_tr_b16 v[172:173], v17 offset:20480
    v_mfma_f32_16x16x32_bf16 v[108:111], v[180:183], v[132:135], v[108:111]
    ds_read_b64_tr_b16 v[174:175], v17 offset:20992
    v_mfma_f32_16x16x32_bf16 v[120:123], v[180:183], v[136:139], v[120:123]
    v_mfma_f32_16x16x32_bf16 v[124:127], v[180:183], v[140:143], v[124:127]
    v_mfma_f32_16x16x32_bf16 v[236:239], v[180:183], v[184:187], v[236:239]
    s_waitcnt lgkmcnt(4)
    v_mfma_f32_16x16x32_bf16 v[64:67], v[160:163], v[144:147], v[64:67]
    ds_read_b128 v[184:187], v13 offset:40960
    v_mfma_f32_16x16x32_bf16 v[68:71], v[160:163], v[148:151], v[68:71]
    ds_read_b64_tr_b16 v[176:177], v16 offset:36864
    v_mfma_f32_16x16x32_bf16 v[80:83], v[160:163], v[152:155], v[80:83]
    ds_read_b64_tr_b16 v[178:179], v16 offset:37376
    v_mfma_f32_16x16x32_bf16 v[84:87], v[160:163], v[156:159], v[84:87]
    ds_read_b64_tr_b16 v[180:181], v17 offset:36864
    v_mfma_f32_16x16x32_bf16 v[72:75], v[164:167], v[144:147], v[72:75]
    ds_read_b64_tr_b16 v[182:183], v17 offset:37376
    v_mfma_f32_16x16x32_bf16 v[76:79], v[164:167], v[148:151], v[76:79]
    v_mfma_f32_16x16x32_bf16 v[88:91], v[164:167], v[152:155], v[88:91]
    v_mfma_f32_16x16x32_bf16 v[92:95], v[164:167], v[156:159], v[92:95]
    s_waitcnt lgkmcnt(4)
    v_mfma_f32_16x16x32_bf16 v[232:235], v[164:167], v[184:187], v[232:235]
    s_waitcnt lgkmcnt(0)
    s_barrier
    v_mfma_f32_16x16x32_bf16 v[32:35], v[168:171], v[144:147], v[32:35]
    ds_read_b128 v[128:131], v8 offset:41984
    v_mfma_f32_16x16x32_bf16 v[36:39], v[168:171], v[148:151], v[36:39]
    ds_read_b128 v[132:135], v8 offset:44032
    v_mfma_f32_16x16x32_bf16 v[48:51], v[168:171], v[152:155], v[48:51]
    ds_read_b64_tr_b16 v[160:161], v18 offset:1024
    v_mfma_f32_16x16x32_bf16 v[52:55], v[168:171], v[156:159], v[52:55]
    ds_read_b64_tr_b16 v[162:163], v18 offset:1536
    v_mfma_f32_16x16x32_bf16 v[40:43], v[172:175], v[144:147], v[40:43]
    ds_read_b128 v[136:139], v8 offset:46080
    v_mfma_f32_16x16x32_bf16 v[44:47], v[172:175], v[148:151], v[44:47]
    ds_read_b128 v[140:143], v8 offset:48128
    v_mfma_f32_16x16x32_bf16 v[56:59], v[172:175], v[152:155], v[56:59]
    ds_read_b64_tr_b16 v[164:165], v19 offset:1024
    v_mfma_f32_16x16x32_bf16 v[60:63], v[172:175], v[156:159], v[60:63]
    ds_read_b64_tr_b16 v[166:167], v19 offset:1536
    v_mfma_f32_16x16x32_bf16 v[96:99], v[176:179], v[144:147], v[96:99]
    ds_read_b64_tr_b16 v[168:169], v16 offset:58368
    v_mfma_f32_16x16x32_bf16 v[100:103], v[176:179], v[148:151], v[100:103]
    ds_read_b64_tr_b16 v[170:171], v16 offset:58880
    v_mfma_f32_16x16x32_bf16 v[112:115], v[176:179], v[152:155], v[112:115]
    v_mfma_f32_16x16x32_bf16 v[116:119], v[176:179], v[156:159], v[116:119]
    v_mfma_f32_16x16x32_bf16 v[104:107], v[180:183], v[144:147], v[104:107]
    ds_read_b64_tr_b16 v[172:173], v17 offset:58368
    v_mfma_f32_16x16x32_bf16 v[108:111], v[180:183], v[148:151], v[108:111]
    ds_read_b64_tr_b16 v[174:175], v17 offset:58880
    v_mfma_f32_16x16x32_bf16 v[120:123], v[180:183], v[152:155], v[120:123]
    v_mfma_f32_16x16x32_bf16 v[124:127], v[180:183], v[156:159], v[124:127]
    v_mfma_f32_16x16x32_bf16 v[236:239], v[180:183], v[184:187], v[236:239]
    s_waitcnt lgkmcnt(4)
    v_mfma_f32_16x16x32_bf16 v[64:67], v[160:163], v[128:131], v[64:67]
    ds_read_b128 v[184:187], v14 offset:17408
    v_mfma_f32_16x16x32_bf16 v[68:71], v[160:163], v[132:135], v[68:71]
    ds_read_b64_tr_b16 v[176:177], v18 offset:9216
    v_mfma_f32_16x16x32_bf16 v[80:83], v[160:163], v[136:139], v[80:83]
    ds_read_b64_tr_b16 v[178:179], v18 offset:9728
    v_mfma_f32_16x16x32_bf16 v[84:87], v[160:163], v[140:143], v[84:87]
    ds_read_b64_tr_b16 v[180:181], v19 offset:9216
    v_mfma_f32_16x16x32_bf16 v[72:75], v[164:167], v[128:131], v[72:75]
    ds_read_b64_tr_b16 v[182:183], v19 offset:9728
    v_mfma_f32_16x16x32_bf16 v[76:79], v[164:167], v[132:135], v[76:79]
    v_mfma_f32_16x16x32_bf16 v[88:91], v[164:167], v[136:139], v[88:91]
    v_mfma_f32_16x16x32_bf16 v[92:95], v[164:167], v[140:143], v[92:95]
    s_waitcnt lgkmcnt(4)
    v_mfma_f32_16x16x32_bf16 v[232:235], v[164:167], v[184:187], v[232:235]
    v_mfma_f32_16x16x32_bf16 v[32:35], v[168:171], v[128:131], v[32:35]
    ds_read_b128 v[144:147], v9 offset:41984
    v_mfma_f32_16x16x32_bf16 v[36:39], v[168:171], v[132:135], v[36:39]
    ds_read_b128 v[148:151], v9 offset:44032
    v_mfma_f32_16x16x32_bf16 v[48:51], v[168:171], v[136:139], v[48:51]
    ds_read_b64_tr_b16 v[160:161], v18 offset:5120
    v_mfma_f32_16x16x32_bf16 v[52:55], v[168:171], v[140:143], v[52:55]
    ds_read_b64_tr_b16 v[162:163], v18 offset:5632
    v_mfma_f32_16x16x32_bf16 v[40:43], v[172:175], v[128:131], v[40:43]
    ds_read_b128 v[152:155], v9 offset:46080
    v_mfma_f32_16x16x32_bf16 v[44:47], v[172:175], v[132:135], v[44:47]
    ds_read_b128 v[156:159], v9 offset:48128
    v_mfma_f32_16x16x32_bf16 v[56:59], v[172:175], v[136:139], v[56:59]
    ds_read_b64_tr_b16 v[164:165], v19 offset:5120
    v_mfma_f32_16x16x32_bf16 v[60:63], v[172:175], v[140:143], v[60:63]
    ds_read_b64_tr_b16 v[166:167], v19 offset:5632
    s_waitcnt lgkmcnt(8)
    v_mfma_f32_16x16x32_bf16 v[96:99], v[176:179], v[128:131], v[96:99]
    ds_read_b64_tr_b16 v[168:169], v16 offset:62464
    v_mfma_f32_16x16x32_bf16 v[100:103], v[176:179], v[132:135], v[100:103]
    ds_read_b64_tr_b16 v[170:171], v16 offset:62976
    v_mfma_f32_16x16x32_bf16 v[112:115], v[176:179], v[136:139], v[112:115]
    v_mfma_f32_16x16x32_bf16 v[116:119], v[176:179], v[140:143], v[116:119]
    v_mfma_f32_16x16x32_bf16 v[104:107], v[180:183], v[128:131], v[104:107]
    ds_read_b64_tr_b16 v[172:173], v17 offset:62464
    v_mfma_f32_16x16x32_bf16 v[108:111], v[180:183], v[132:135], v[108:111]
    ds_read_b64_tr_b16 v[174:175], v17 offset:62976
    v_mfma_f32_16x16x32_bf16 v[120:123], v[180:183], v[136:139], v[120:123]
    v_mfma_f32_16x16x32_bf16 v[124:127], v[180:183], v[140:143], v[124:127]
    v_mfma_f32_16x16x32_bf16 v[236:239], v[180:183], v[184:187], v[236:239]
    s_waitcnt lgkmcnt(4)
    v_mfma_f32_16x16x32_bf16 v[64:67], v[160:163], v[144:147], v[64:67]
    ds_read_b128 v[184:187], v15 offset:17408
    v_mfma_f32_16x16x32_bf16 v[68:71], v[160:163], v[148:151], v[68:71]
    ds_read_b64_tr_b16 v[176:177], v18 offset:13312
    v_mfma_f32_16x16x32_bf16 v[80:83], v[160:163], v[152:155], v[80:83]
    ds_read_b64_tr_b16 v[178:179], v18 offset:13824
    v_mfma_f32_16x16x32_bf16 v[84:87], v[160:163], v[156:159], v[84:87]
    ds_read_b64_tr_b16 v[180:181], v19 offset:13312
    v_mfma_f32_16x16x32_bf16 v[72:75], v[164:167], v[144:147], v[72:75]
    ds_read_b64_tr_b16 v[182:183], v19 offset:13824
    v_mfma_f32_16x16x32_bf16 v[76:79], v[164:167], v[148:151], v[76:79]
    v_mfma_f32_16x16x32_bf16 v[88:91], v[164:167], v[152:155], v[88:91]
    v_mfma_f32_16x16x32_bf16 v[92:95], v[164:167], v[156:159], v[92:95]
    s_waitcnt lgkmcnt(4)
    v_mfma_f32_16x16x32_bf16 v[232:235], v[164:167], v[184:187], v[232:235]
    v_mfma_f32_16x16x32_bf16 v[32:35], v[168:171], v[144:147], v[32:35]
    v_mfma_f32_16x16x32_bf16 v[36:39], v[168:171], v[148:151], v[36:39]
    v_mfma_f32_16x16x32_bf16 v[48:51], v[168:171], v[152:155], v[48:51]
    v_mfma_f32_16x16x32_bf16 v[52:55], v[168:171], v[156:159], v[52:55]
    v_mfma_f32_16x16x32_bf16 v[40:43], v[172:175], v[144:147], v[40:43]
    v_mfma_f32_16x16x32_bf16 v[44:47], v[172:175], v[148:151], v[44:47]
    v_mfma_f32_16x16x32_bf16 v[56:59], v[172:175], v[152:155], v[56:59]
    v_mfma_f32_16x16x32_bf16 v[60:63], v[172:175], v[156:159], v[60:63]
    s_waitcnt lgkmcnt(0)
    v_mfma_f32_16x16x32_bf16 v[96:99], v[176:179], v[144:147], v[96:99]
    v_mfma_f32_16x16x32_bf16 v[100:103], v[176:179], v[148:151], v[100:103]
    v_mfma_f32_16x16x32_bf16 v[112:115], v[176:179], v[152:155], v[112:115]
    v_mfma_f32_16x16x32_bf16 v[116:119], v[176:179], v[156:159], v[116:119]
    v_mfma_f32_16x16x32_bf16 v[104:107], v[180:183], v[144:147], v[104:107]
    v_mfma_f32_16x16x32_bf16 v[108:111], v[180:183], v[148:151], v[108:111]
    v_mfma_f32_16x16x32_bf16 v[120:123], v[180:183], v[152:155], v[120:123]
    v_mfma_f32_16x16x32_bf16 v[124:127], v[180:183], v[156:159], v[124:127]
    v_mfma_f32_16x16x32_bf16 v[236:239], v[180:183], v[184:187], v[236:239]
L_bloopend:
    v_cvt_pk_bf16_f32 v164, v80, v81
    v_cvt_pk_bf16_f32 v165, v82, v83
    v_cvt_pk_bf16_f32 v166, v84, v85
    v_cvt_pk_bf16_f32 v167, v86, v87
    v_cvt_pk_bf16_f32 v168, v88, v89
    v_cvt_pk_bf16_f32 v169, v90, v91
    v_cvt_pk_bf16_f32 v170, v92, v93
    v_cvt_pk_bf16_f32 v171, v94, v95
    v_permlane16_swap_b32 v164, v166
    v_permlane16_swap_b32 v165, v167
    ds_write_b128 v24, v[164:167] offset:1280
    v_cvt_pk_bf16_f32 v172, v48, v49
    v_cvt_pk_bf16_f32 v173, v50, v51
    v_cvt_pk_bf16_f32 v174, v52, v53
    v_cvt_pk_bf16_f32 v175, v54, v55
    v_permlane16_swap_b32 v168, v170
    v_permlane16_swap_b32 v169, v171
    ds_write_b128 v24, v[168:171] offset:5632
    v_cvt_pk_bf16_f32 v176, v56, v57
    v_cvt_pk_bf16_f32 v177, v58, v59
    v_cvt_pk_bf16_f32 v178, v60, v61
    v_cvt_pk_bf16_f32 v179, v62, v63
    v_permlane16_swap_b32 v172, v174
    v_permlane16_swap_b32 v173, v175
    ds_write_b128 v22, v[172:175] offset:0
    v_cvt_pk_bf16_f32 v136, v64, v65
    v_cvt_pk_bf16_f32 v137, v66, v67
    v_cvt_pk_bf16_f32 v138, v68, v69
    v_cvt_pk_bf16_f32 v139, v70, v71
    v_permlane16_swap_b32 v176, v178
    v_permlane16_swap_b32 v177, v179
    ds_write_b128 v22, v[176:179] offset:1024
    v_cvt_pk_bf16_f32 v140, v72, v73
    v_cvt_pk_bf16_f32 v141, v74, v75
    v_cvt_pk_bf16_f32 v142, v76, v77
    v_cvt_pk_bf16_f32 v143, v78, v79
    v_permlane16_swap_b32 v136, v138
    v_permlane16_swap_b32 v137, v139
    ds_write_b128 v24, v[136:139] offset:256
    v_cvt_pk_bf16_f32 v128, v32, v33
    v_cvt_pk_bf16_f32 v129, v34, v35
    v_cvt_pk_bf16_f32 v130, v36, v37
    v_cvt_pk_bf16_f32 v131, v38, v39
    v_permlane16_swap_b32 v140, v142
    v_permlane16_swap_b32 v141, v143
    ds_write_b128 v24, v[140:143] offset:4608
    v_cvt_pk_bf16_f32 v132, v40, v41
    v_cvt_pk_bf16_f32 v133, v42, v43
    v_cvt_pk_bf16_f32 v134, v44, v45
    v_cvt_pk_bf16_f32 v135, v46, v47
    v_permlane16_swap_b32 v128, v130
    v_permlane16_swap_b32 v129, v131
    v_permlane16_swap_b32 v132, v134
    v_permlane16_swap_b32 v133, v135
    v_cvt_pk_bf16_f32 v232, v232, v233
    v_cvt_pk_bf16_f32 v233, v234, v235
    ds_write_b64 v25, v[232:233] offset:0
    v_cvt_pk_bf16_f32 v236, v236, v237
    v_cvt_pk_bf16_f32 v237, v238, v239
    ds_write_b64 v25, v[236:237] offset:17408
    s_waitcnt lgkmcnt(0)
    s_barrier
    ds_read_b128 v[144:147], v26 offset:0
    ds_read_b128 v[148:151], v26 offset:4352
    v_mfma_f32_32x32x16_bf16 v[32:47], v[136:139], v[128:131], v[188:203]
    v_mfma_f32_32x32x16_bf16 v[48:63], v[140:143], v[132:135], v[188:203]
    s_waitcnt lgkmcnt(1)
    v_mfma_f32_32x32x16_bf16 v[64:79], v[144:147], v[128:131], v[192:207]
    s_waitcnt lgkmcnt(0)
    v_mfma_f32_32x32x16_bf16 v[80:95], v[148:151], v[132:135], v[192:207]
    v_cvt_pk_bf16_f32 v220, v96, v97
    v_cvt_pk_bf16_f32 v221, v98, v99
    v_cvt_pk_bf16_f32 v222, v100, v101
    v_cvt_pk_bf16_f32 v223, v102, v103
    v_cvt_pk_bf16_f32 v224, v104, v105
    v_cvt_pk_bf16_f32 v225, v106, v107
    v_cvt_pk_bf16_f32 v226, v108, v109
    v_cvt_pk_bf16_f32 v227, v110, v111
    v_permlane16_swap_b32 v220, v222
    v_permlane16_swap_b32 v221, v223
    ds_write_b128 v24, v[220:223] offset:17664
    v_cvt_pk_bf16_f32 v228, v112, v113
    v_cvt_pk_bf16_f32 v229, v114, v115
    v_cvt_pk_bf16_f32 v230, v116, v117
    v_cvt_pk_bf16_f32 v231, v118, v119
    v_permlane16_swap_b32 v224, v226
    v_permlane16_swap_b32 v225, v227
    ds_write_b128 v24, v[224:227] offset:22016
    v_cvt_pk_bf16_f32 v232, v120, v121
    v_cvt_pk_bf16_f32 v233, v122, v123
    v_cvt_pk_bf16_f32 v234, v124, v125
    v_cvt_pk_bf16_f32 v235, v126, v127
    v_permlane16_swap_b32 v228, v230
    v_permlane16_swap_b32 v229, v231
    ds_write_b128 v24, v[228:231] offset:18688
    v_permlane16_swap_b32 v232, v234
    v_permlane16_swap_b32 v233, v235
    ds_write_b128 v24, v[232:235] offset:23040
    s_setprio 1
    s_branch L_bsoft
L_battn:
    ds_read_b128 v[144:147], v26 offset:0
    ds_read_b128 v[148:151], v26 offset:4352
    s_waitcnt lgkmcnt(1)
    v_mfma_f32_32x32x16_bf16 v[32:47], v[136:139], v[128:131], v[188:203]
    v_mfma_f32_32x32x16_bf16 v[48:63], v[140:143], v[132:135], v[188:203]
    v_mfma_f32_32x32x16_bf16 v[64:79], v[144:147], v[128:131], v[192:207]
    s_waitcnt lgkmcnt(0)
    v_mfma_f32_32x32x16_bf16 v[80:95], v[148:151], v[132:135], v[192:207]
L_bsoft:
    s_nop 11
    v_max3_f32 v32, v32, v36, v40
    v_max3_f32 v48, v48, v52, v56
    v_max3_f32 v33, v33, v37, v41
    v_max3_f32 v49, v49, v53, v57
    v_max3_f32 v34, v34, v38, v42
    v_max3_f32 v50, v50, v54, v58
    v_max3_f32 v35, v35, v39, v43
    v_max3_f32 v51, v51, v55, v59
    v_max3_f32 v32, v32, v44, v76
    v_max3_f32 v48, v48, v60, v92
    v_max3_f32 v33, v33, v45, v77
    v_max3_f32 v49, v49, v61, v93
    v_max3_f32 v34, v34, v46, v78
    v_max3_f32 v50, v50, v62, v94
    v_max3_f32 v35, v35, v47, v79
    v_max3_f32 v51, v51, v63, v95
    v_max3_f32 v36, v32, v33, v34
    v_max3_f32 v52, v48, v49, v50
    v_max_f32 v36, v36, v35
    v_max_f32 v52, v52, v51
    s_nop 1
    v_permlane32_swap_b32 v36, v52
    v_max_f32 v36, v36, v52
    v_mul_f32 v52, 0xbeb8aa3b, v36
    v_mul_f32 v36, 0xbeb8aa3b, v36
    s_nop 1
    v_permlane32_swap_b32 v36, v52
    v_fmamk_f32 v32, v32, 0x3eb8aa3b, v36
    v_fmamk_f32 v48, v48, 0x3eb8aa3b, v52
    v_fmamk_f32 v33, v33, 0x3eb8aa3b, v36
    v_fmamk_f32 v49, v49, 0x3eb8aa3b, v52
    v_fmamk_f32 v34, v34, 0x3eb8aa3b, v36
    v_fmamk_f32 v50, v50, 0x3eb8aa3b, v52
    v_fmamk_f32 v35, v35, 0x3eb8aa3b, v36
    v_fmamk_f32 v51, v51, 0x3eb8aa3b, v52
    v_exp_f32 v32, v32
    v_exp_f32 v48, v48
    v_exp_f32 v33, v33
    v_exp_f32 v49, v49
    v_exp_f32 v34, v34
    v_exp_f32 v50, v50
    v_exp_f32 v35, v35
    v_exp_f32 v51, v51
    v_add_f32 v36, v32, v33
    v_add_f32 v52, v48, v49
    v_add_f32 v37, v34, v35
    s_waitcnt vmcnt(6) lgkmcnt(0)
    s_barrier
    ds_read_b64_tr_b16 v[152:153], v27 offset:17664
    ds_read_b64_tr_b16 v[154:155], v27 offset:17920
    ds_read_b64_tr_b16 v[156:157], v27 offset:18176
    ds_read_b64_tr_b16 v[158:159], v27 offset:18432
    ds_read_b32 v30, v30
    ds_read_b64_tr_b16 v[160:161], v27 offset:17408
    v_add_f32 v53, v50, v51
    v_add_f32 v36, v36, v37
    v_add_f32 v52, v52, v53
    s_nop 1
    v_permlane32_swap_b32 v36, v52
    v_add_f32 v36, v36, v52
    v_rcp_f32 v36, v36
    s_nop 0
    v_mov_b32 v52, v36
    s_nop 1
    v_permlane32_swap_b32 v36, v52
    v_mul_f32 v32, v32, v36
    v_mul_f32 v48, v48, v52
    v_mul_f32 v33, v33, v36
    v_mul_f32 v49, v49, v52
    v_mul_f32 v34, v34, v36
    v_mul_f32 v50, v50, v52
    v_mul_f32 v35, v35, v36
    v_mul_f32 v51, v51, v52
    v_cvt_pk_bf16_f32 v32, v32, v33
    v_cvt_pk_bf16_f32 v48, v48, v49
    v_cvt_pk_bf16_f32 v33, v34, v35
    v_cvt_pk_bf16_f32 v49, v50, v51
    v_and_b32 v172, v32, v216
    v_and_b32 v173, v33, v217
    v_and_b32 v184, v48, v216
    v_and_b32 v185, v49, v217
    s_waitcnt lgkmcnt(0)
    v_mfma_f32_32x32x8_bf16 v[96:111], v[160:161], v[172:173], 0
    v_and_b32 v164, v32, v208
    v_and_b32 v165, v33, v209
    v_and_b32 v166, v32, v210
    v_and_b32 v167, v33, v211
    v_and_b32 v168, v32, v212
    v_mfma_f32_32x32x8_bf16 v[112:127], v[160:161], v[184:185], 0
    v_and_b32 v176, v48, v208
    v_and_b32 v177, v49, v209
    v_and_b32 v178, v48, v210
    v_and_b32 v179, v49, v211
    v_and_b32 v180, v48, v212
    v_mfma_f32_32x32x16_bf16 v[96:111], v[152:155], v[164:167], v[96:111]
    v_and_b32 v169, v33, v213
    v_and_b32 v170, v32, v214
    v_and_b32 v171, v33, v215
    s_nop 0
    v_mfma_f32_32x32x16_bf16 v[112:127], v[152:155], v[176:179], v[112:127]
    v_and_b32 v181, v49, v213
    v_and_b32 v182, v48, v214
    v_and_b32 v183, v49, v215
    v_mfma_f32_32x32x16_bf16 v[96:111], v[156:159], v[168:171], v[96:111]
    s_nop 0
    v_mfma_f32_32x32x16_bf16 v[112:127], v[156:159], v[180:183], v[112:127]
    s_nop 9
    v_cvt_pk_bf16_f32 v96, v96, v97
    v_cvt_pk_bf16_f32 v97, v98, v99
    v_cvt_pk_bf16_f32 v98, v100, v101
    v_cvt_pk_bf16_f32 v99, v102, v103
    buffer_store_dwordx4 v[96:99], v28, s[20:23], 0 offen offset:0 sc1
    v_cvt_pk_bf16_f32 v120, v120, v121
    v_cvt_pk_bf16_f32 v121, v122, v123
    v_cvt_pk_bf16_f32 v122, v124, v125
    v_cvt_pk_bf16_f32 v123, v126, v127
    buffer_store_dwordx4 v[120:123], v28, s[20:23], 0 offen offset:1024 sc1
    buffer_store_dword v30, v29, s[20:23], 0 offen sc1
    s_atomic_add s35, s[20:21], s99
    s_add_u32 s99, s99, 64
    s_setprio 0
    v_mov_b32 v2, v240
    v_mov_b32 v3, v241
    v_mov_b32 v4, v242
    v_mov_b32 v5, v243
    v_mov_b32 v6, v244
    v_mov_b32 v7, v245
    v_mov_b32 v19, v246
    v_mov_b32 v20, v247
    v_mov_b32 v21, v248
    v_mov_b32 v22, v249
    v_mov_b32 v23, v250
    v_mov_b32 v24, v251
    s_mov_b32 s72, 0
    s_xor_b32 s73, s72, 4096
    s_xor_b32 s74, s72, 8192
    s_xor_b32 s75, s72, 12288
    s_cmp_eq_u32 s3, 0
    s_barrier
    s_cbranch_scc1 L_bhi
    ds_read_b64_tr_b16 v[128:129], v2 offset:0
    ds_read_b64_tr_b16 v[130:131], v2 offset:512
    ds_read_b64_tr_b16 v[132:133], v3 offset:0
    ds_read_b64_tr_b16 v[134:135], v3 offset:512
    ds_read_b64_tr_b16 v[136:137], v4 offset:0
    ds_read_b64_tr_b16 v[138:139], v4 offset:512
    ds_read_b64_tr_b16 v[140:141], v5 offset:0
    ds_read_b64_tr_b16 v[142:143], v5 offset:512
    ds_read_b64_tr_b16 v[144:145], v2 offset:4096
    ds_read_b64_tr_b16 v[146:147], v2 offset:4608
    ds_read_b64_tr_b16 v[148:149], v3 offset:4096
    ds_read_b64_tr_b16 v[150:151], v3 offset:4608
    ds_read_b64_tr_b16 v[152:153], v4 offset:4096
    ds_read_b64_tr_b16 v[154:155], v4 offset:4608
    ds_read_b64_tr_b16 v[156:157], v5 offset:4096
    ds_read_b64_tr_b16 v[158:159], v5 offset:4608
    ds_read_b64_tr_b16 v[160:161], v2 offset:8192
    ds_read_b64_tr_b16 v[162:163], v2 offset:8704
    ds_read_b64_tr_b16 v[164:165], v3 offset:8192
    ds_read_b64_tr_b16 v[166:167], v3 offset:8704
    ds_read_b64_tr_b16 v[168:169], v4 offset:8192
    ds_read_b64_tr_b16 v[170:171], v4 offset:8704
    ds_read_b64_tr_b16 v[172:173], v5 offset:8192
    ds_read_b64_tr_b16 v[174:175], v5 offset:8704
    ds_read_b64_tr_b16 v[176:177], v2 offset:12288
    ds_read_b64_tr_b16 v[178:179], v2 offset:12800
    ds_read_b64_tr_b16 v[180:181], v3 offset:12288
    ds_read_b64_tr_b16 v[182:183], v3 offset:12800
    ds_read_b64_tr_b16 v[184:185], v4 offset:12288
    ds_read_b64_tr_b16 v[186:187], v4 offset:12800
    ds_read_b64_tr_b16 v[188:189], v5 offset:12288
    ds_read_b64_tr_b16 v[190:191], v5 offset:12800
    s_mov_b32 s34, 0
    s_atomic_or s34, s[20:21], s70 glc
    v_add_u32 v2, s66, v2
    ds_read_b64_tr_b16 v[192:193], v2 offset:0
    ds_read_b64_tr_b16 v[194:195], v2 offset:512
    v_add_u32 v3, s66, v3
    ds_read_b64_tr_b16 v[196:197], v3 offset:0
    ds_read_b64_tr_b16 v[198:199], v3 offset:512
    v_add_u32 v4, s66, v4
    ds_read_b64_tr_b16 v[200:201], v4 offset:0
    ds_read_b64_tr_b16 v[202:203], v4 offset:512
    v_add_u32 v5, s66, v5
    ds_read_b64_tr_b16 v[204:205], v5 offset:0
    ds_read_b64_tr_b16 v[206:207], v5 offset:512
    ds_read_b64_tr_b16 v[208:209], v2 offset:4096
    ds_read_b64_tr_b16 v[210:211], v2 offset:4608
    ds_read_b64_tr_b16 v[212:213], v3 offset:4096
    ds_read_b64_tr_b16 v[214:215], v3 offset:4608
    ds_read_b64_tr_b16 v[216:217], v4 offset:4096
    ds_read_b64_tr_b16 v[218:219], v4 offset:4608
    ds_read_b64_tr_b16 v[220:221], v5 offset:4096
    ds_read_b64_tr_b16 v[222:223], v5 offset:4608
    ds_read_b64_tr_b16 v[224:225], v2 offset:8192
    ds_read_b64_tr_b16 v[226:227], v2 offset:8704
    ds_read_b64_tr_b16 v[228:229], v3 offset:8192
    ds_read_b64_tr_b16 v[230:231], v3 offset:8704
    ds_read_b64_tr_b16 v[232:233], v4 offset:8192
    ds_read_b64_tr_b16 v[234:235], v4 offset:8704
    ds_read_b64_tr_b16 v[236:237], v5 offset:8192
    ds_read_b64_tr_b16 v[238:239], v5 offset:8704
    ds_read_b64_tr_b16 v[240:241], v2 offset:12288
    ds_read_b64_tr_b16 v[242:243], v2 offset:12800
    ds_read_b64_tr_b16 v[244:245], v3 offset:12288
    ds_read_b64_tr_b16 v[246:247], v3 offset:12800
    ds_read_b64_tr_b16 v[248:249], v4 offset:12288
    ds_read_b64_tr_b16 v[250:251], v4 offset:12800
    ds_read_b64_tr_b16 v[252:253], v5 offset:12288
    ds_read_b64_tr_b16 v[254:255], v5 offset:12800
    s_waitcnt vmcnt(0) lgkmcnt(0)
    s_atomic_add s35, s[20:21], s99
    s_cmp_ge_u32 s34, 8
    s_cbranch_scc0 L_blate
L_bgo:
    v_xor_b32 v17, 64, v19
    buffer_load_dword v16, v19, s[20:23], s68 offen sc1
    buffer_load_dword v17, v17, s[20:23], s68 offen sc1
    buffer_load_dwordx4 v[32:35], v7, s[20:23], s72 offen offset:0 sc1
    buffer_load_dwordx4 v[36:39], v7, s[20:23], s72 offen offset:2048 sc1
    buffer_load_dwordx4 v[40:43], v7, s[20:23], s73 offen offset:0 sc1
    buffer_load_dwordx4 v[44:47], v7, s[20:23], s73 offen offset:2048 sc1
    buffer_load_dwordx4 v[48:51], v7, s[20:23], s74 offen offset:0 sc1
    buffer_load_dwordx4 v[52:55], v7, s[20:23], s74 offen offset:2048 sc1
    buffer_load_dwordx4 v[56:59], v7, s[20:23], s75 offen offset:0 sc1
    buffer_load_dwordx4 v[60:63], v7, s[20:23], s75 offen offset:2048 sc1
    buffer_load_dwordx4 v[64:67], v6, s[20:23], s72 offen offset:0 sc1
    buffer_load_dwordx4 v[68:71], v6, s[20:23], s72 offen offset:2048 sc1
    s_barrier
    s_branch L_p2mb
L_blate:
    s_mov_b32 s34, 0
    s_atomic_or s34, s[20:21], s70 glc
    s_waitcnt lgkmcnt(0)
    s_cmp_ge_u32 s34, 8
    s_cbranch_scc1 L_bgo
    s_mov_b32 s34, 0
    s_atomic_or s34, s[20:21], s70 glc
    s_barrier
    s_branch L_p2chk
L_bhi:
    v_subrev_u32 v29, 0x8000, v31
    v_add_u32 v20, 49152, v20
    s_add_u32 m0, s81, 32768
    s_mov_b32 s96, 0
    buffer_load_dwordx4 v31, s[12:15], s96 offen lds
    s_add_u32 m0, s81, 28672
    s_mov_b32 s96, 0
    buffer_load_dwordx4 v29, s[12:15], s96 offen lds
    s_add_u32 m0, s81, 122880
    s_mov_b32 s96, 262144
    buffer_load_dwordx4 v31, s[12:15], s96 offen lds
    s_add_u32 m0, s81, 118784
    s_mov_b32 s96, 262144
    buffer_load_dwordx4 v29, s[12:15], s96 offen lds
    s_add_u32 m0, s81, 131072
    s_mov_b32 s96, 327680
    buffer_load_dwordx4 v31, s[12:15], s96 offen lds
    s_add_u32 m0, s81, 126976
    s_mov_b32 s96, 327680
    buffer_load_dwordx4 v29, s[12:15], s96 offen lds
    s_waitcnt vmcnt(6)
    s_atomic_add s35, s[20:21], s99
    s_add_u32 m0, s81, 139264
    s_mov_b32 s96, 393216
    buffer_load_dwordx4 v31, s[12:15], s96 offen lds
    s_add_u32 m0, s81, 135168
    s_mov_b32 s96, 393216
    buffer_load_dwordx4 v29, s[12:15], s96 offen lds
    s_add_u32 m0, s81, 147456
    s_mov_b32 s96, 458752
    buffer_load_dwordx4 v31, s[12:15], s96 offen lds
    s_add_u32 m0, s81, 143360
    s_mov_b32 s96, 458752
    buffer_load_dwordx4 v29, s[12:15], s96 offen lds
    s_waitcnt vmcnt(0)
    s_barrier
    s_mov_b32 s34, 0
    s_atomic_or s34, s[20:21], s70 glc
    ds_read_b64_tr_b16 v[128:129], v2 offset:0
    ds_read_b64_tr_b16 v[130:131], v2 offset:512
    ds_read_b64_tr_b16 v[132:133], v3 offset:0
    ds_read_b64_tr_b16 v[134:135], v3 offset:512
    ds_read_b64_tr_b16 v[136:137], v4 offset:0
    ds_read_b64_tr_b16 v[138:139], v4 offset:512
    ds_read_b64_tr_b16 v[140:141], v5 offset:0
    ds_read_b64_tr_b16 v[142:143], v5 offset:512
    ds_read_b64_tr_b16 v[144:145], v2 offset:4096
    ds_read_b64_tr_b16 v[146:147], v2 offset:4608
    ds_read_b64_tr_b16 v[148:149], v3 offset:4096
    ds_read_b64_tr_b16 v[150:151], v3 offset:4608
    ds_read_b64_tr_b16 v[152:153], v4 offset:4096
    ds_read_b64_tr_b16 v[154:155], v4 offset:4608
    ds_read_b64_tr_b16 v[156:157], v5 offset:4096
    ds_read_b64_tr_b16 v[158:159], v5 offset:4608
    ds_read_b64_tr_b16 v[160:161], v2 offset:8192
    ds_read_b64_tr_b16 v[162:163], v2 offset:8704
    ds_read_b64_tr_b16 v[164:165], v3 offset:8192
    ds_read_b64_tr_b16 v[166:167], v3 offset:8704
    ds_read_b64_tr_b16 v[168:169], v4 offset:8192
    ds_read_b64_tr_b16 v[170:171], v4 offset:8704
    ds_read_b64_tr_b16 v[172:173], v5 offset:8192
    ds_read_b64_tr_b16 v[174:175], v5 offset:8704
    ds_read_b64_tr_b16 v[176:177], v2 offset:12288
    ds_read_b64_tr_b16 v[178:179], v2 offset:12800
    ds_read_b64_tr_b16 v[180:181], v3 offset:12288
    ds_read_b64_tr_b16 v[182:183], v3 offset:12800
    ds_read_b64_tr_b16 v[184:185], v4 offset:12288
    ds_read_b64_tr_b16 v[186:187], v4 offset:12800
    ds_read_b64_tr_b16 v[188:189], v5 offset:12288
    ds_read_b64_tr_b16 v[190:191], v5 offset:12800
    v_add_u32 v2, s66, v2
    ds_read_b64_tr_b16 v[192:193], v2 offset:0
    ds_read_b64_tr_b16 v[194:195], v2 offset:512
    v_add_u32 v3, s66, v3
    ds_read_b64_tr_b16 v[196:197], v3 offset:0
    ds_read_b64_tr_b16 v[198:199], v3 offset:512
    v_add_u32 v4, s66, v4
    ds_read_b64_tr_b16 v[200:201], v4 offset:0
    ds_read_b64_tr_b16 v[202:203], v4 offset:512
    v_add_u32 v5, s66, v5
    ds_read_b64_tr_b16 v[204:205], v5 offset:0
    ds_read_b64_tr_b16 v[206:207], v5 offset:512
    ds_read_b64_tr_b16 v[208:209], v2 offset:4096
    ds_read_b64_tr_b16 v[210:211], v2 offset:4608
    ds_read_b64_tr_b16 v[212:213], v3 offset:4096
    ds_read_b64_tr_b16 v[214:215], v3 offset:4608
    ds_read_b64_tr_b16 v[216:217], v4 offset:4096
    ds_read_b64_tr_b16 v[218:219], v4 offset:4608
    ds_read_b64_tr_b16 v[220:221], v5 offset:4096
    ds_read_b64_tr_b16 v[222:223], v5 offset:4608
    ds_read_b64_tr_b16 v[224:225], v2 offset:8192
    ds_read_b64_tr_b16 v[226:227], v2 offset:8704
    ds_read_b64_tr_b16 v[228:229], v3 offset:8192
    ds_read_b64_tr_b16 v[230:231], v3 offset:8704
    ds_read_b64_tr_b16 v[232:233], v4 offset:8192
    ds_read_b64_tr_b16 v[234:235], v4 offset:8704
    ds_read_b64_tr_b16 v[236:237], v5 offset:8192
    ds_read_b64_tr_b16 v[238:239], v5 offset:8704
    ds_read_b64_tr_b16 v[240:241], v2 offset:12288
    ds_read_b64_tr_b16 v[242:243], v2 offset:12800
    ds_read_b64_tr_b16 v[244:245], v3 offset:12288
    ds_read_b64_tr_b16 v[246:247], v3 offset:12800
    ds_read_b64_tr_b16 v[248:249], v4 offset:12288
    ds_read_b64_tr_b16 v[250:251], v4 offset:12800
    ds_read_b64_tr_b16 v[252:253], v5 offset:12288
    ds_read_b64_tr_b16 v[254:255], v5 offset:12800
L_p2chk:
    s_mov_b32 s97, 0
    s_branch L_sc19
L_sp18:
    s_mov_b32 s34, 0
    s_atomic_or s34, s[20:21], s70 glc
L_sc19:
    s_waitcnt lgkmcnt(0)
    s_cmp_ge_u32 s34, 8
    s_cbranch_scc1 L_so20
    s_add_u32 s97, s97, 1
    s_cmp_lt_u32 s97, 1048576
    s_cbranch_scc1 L_sp18
L_so20:
L_p2go:
    s_cmp_eq_u32 s3, 0
    s_cbranch_scc1 L_p2a
    v_xor_b32 v17, 64, v19
    buffer_load_dword v16, v19, s[20:23], s68 offen sc1
    buffer_load_dword v17, v17, s[20:23], s68 offen sc1
    buffer_load_dwordx4 v[32:35], v7, s[20:23], s72 offen offset:0 sc1
    buffer_load_dwordx4 v[36:39], v7, s[20:23], s72 offen offset:2048 sc1
    buffer_load_dwordx4 v[40:43], v7, s[20:23], s73 offen offset:0 sc1
    buffer_load_dwordx4 v[44:47], v7, s[20:23], s73 offen offset:2048 sc1
    buffer_load_dwordx4 v[48:51], v7, s[20:23], s74 offen offset:0 sc1
    buffer_load_dwordx4 v[52:55], v7, s[20:23], s74 offen offset:2048 sc1
    buffer_load_dwordx4 v[56:59], v7, s[20:23], s75 offen offset:0 sc1
    buffer_load_dwordx4 v[60:63], v7, s[20:23], s75 offen offset:2048 sc1
    buffer_load_dwordx4 v[64:67], v6, s[20:23], s72 offen offset:0 sc1
    buffer_load_dwordx4 v[68:71], v6, s[20:23], s72 offen offset:2048 sc1
L_p2mb:
    s_waitcnt vmcnt(9)
    v_mfma_f32_16x16x32_bf16 v[112:115], v[128:131], v[32:35], 0
    v_mfma_f32_16x16x32_bf16 v[116:119], v[132:135], v[32:35], 0
    v_mfma_f32_16x16x32_bf16 v[120:123], v[136:139], v[32:35], 0
    v_mfma_f32_16x16x32_bf16 v[124:127], v[140:143], v[32:35], 0
    buffer_load_dwordx4 v[72:75], v6, s[20:23], s73 offen offset:0 sc1
    s_waitcnt vmcnt(9)
    v_mfma_f32_16x16x32_bf16 v[112:115], v[144:147], v[36:39], v[112:115]
    v_mfma_f32_16x16x32_bf16 v[116:119], v[148:151], v[36:39], v[116:119]
    v_mfma_f32_16x16x32_bf16 v[120:123], v[152:155], v[36:39], v[120:123]
    v_mfma_f32_16x16x32_bf16 v[124:127], v[156:159], v[36:39], v[124:127]
    buffer_load_dwordx4 v[76:79], v6, s[20:23], s73 offen offset:2048 sc1
    s_waitcnt vmcnt(9)
    v_mfma_f32_16x16x32_bf16 v[112:115], v[160:163], v[40:43], v[112:115]
    v_mfma_f32_16x16x32_bf16 v[116:119], v[164:167], v[40:43], v[116:119]
    v_mfma_f32_16x16x32_bf16 v[120:123], v[168:171], v[40:43], v[120:123]
    v_mfma_f32_16x16x32_bf16 v[124:127], v[172:175], v[40:43], v[124:127]
    buffer_load_dwordx4 v[80:83], v6, s[20:23], s74 offen offset:0 sc1
    s_waitcnt vmcnt(9)
    v_mfma_f32_16x16x32_bf16 v[112:115], v[176:179], v[44:47], v[112:115]
    v_mfma_f32_16x16x32_bf16 v[116:119], v[180:183], v[44:47], v[116:119]
    v_mfma_f32_16x16x32_bf16 v[120:123], v[184:187], v[44:47], v[120:123]
    v_mfma_f32_16x16x32_bf16 v[124:127], v[188:191], v[44:47], v[124:127]
    buffer_load_dwordx4 v[84:87], v6, s[20:23], s74 offen offset:2048 sc1
    s_waitcnt vmcnt(9)
    v_mfma_f32_16x16x32_bf16 v[112:115], v[192:195], v[48:51], v[112:115]
    v_mfma_f32_16x16x32_bf16 v[116:119], v[196:199], v[48:51], v[116:119]
    v_mfma_f32_16x16x32_bf16 v[120:123], v[200:203], v[48:51], v[120:123]
    v_mfma_f32_16x16x32_bf16 v[124:127], v[204:207], v[48:51], v[124:127]
    buffer_load_dwordx4 v[88:91], v6, s[20:23], s75 offen offset:0 sc1
    s_waitcnt vmcnt(9)
    v_mfma_f32_16x16x32_bf16 v[112:115], v[208:211], v[52:55], v[112:115]
    v_mfma_f32_16x16x32_bf16 v[116:119], v[212:215], v[52:55], v[116:119]
    v_mfma_f32_16x16x32_bf16 v[120:123], v[216:219], v[52:55], v[120:123]
    v_mfma_f32_16x16x32_bf16 v[124:127], v[220:223], v[52:55], v[124:127]
    buffer_load_dwordx4 v[92:95], v6, s[20:23], s75 offen offset:2048 sc1
    s_waitcnt vmcnt(9)
    v_mfma_f32_16x16x32_bf16 v[112:115], v[224:227], v[56:59], v[112:115]
    v_mfma_f32_16x16x32_bf16 v[116:119], v[228:231], v[56:59], v[116:119]
    v_mfma_f32_16x16x32_bf16 v[120:123], v[232:235], v[56:59], v[120:123]
    v_mfma_f32_16x16x32_bf16 v[124:127], v[236:239], v[56:59], v[124:127]
    s_waitcnt vmcnt(8)
    v_mfma_f32_16x16x32_bf16 v[112:115], v[240:243], v[60:63], v[112:115]
    v_mfma_f32_16x16x32_bf16 v[116:119], v[244:247], v[60:63], v[116:119]
    v_mfma_f32_16x16x32_bf16 v[120:123], v[248:251], v[60:63], v[120:123]
    v_mfma_f32_16x16x32_bf16 v[124:127], v[252:255], v[60:63], v[124:127]
    s_waitcnt vmcnt(7)
    v_mfma_f32_16x16x32_bf16 v[96:99], v[128:131], v[64:67], 0
    v_permlane32_swap_b32 v16, v17
    v_mfma_f32_16x16x32_bf16 v[100:103], v[132:135], v[64:67], 0
    v_add_f32 v16, v16, v17
    v_mfma_f32_16x16x32_bf16 v[104:107], v[136:139], v[64:67], 0
    v_mov_b32 v17, v16
    v_mfma_f32_16x16x32_bf16 v[108:111], v[140:143], v[64:67], 0
    s_waitcnt vmcnt(6)
    v_mfma_f32_16x16x32_bf16 v[96:99], v[144:147], v[68:71], v[96:99]
    v_permlane16_swap_b32 v16, v17
    v_mfma_f32_16x16x32_bf16 v[100:103], v[148:151], v[68:71], v[100:103]
    v_add_f32 v16, v16, v17
    v_mfma_f32_16x16x32_bf16 v[104:107], v[152:155], v[68:71], v[104:107]
    s_bitcmp1_b32 s70, 6
    v_cmp_u_f32 vcc, v112, v16
    s_cbranch_scc1 L_give21
    s_cbranch_vccnz L_redo
L_give21:
    v_mfma_f32_16x16x32_bf16 v[108:111], v[156:159], v[68:71], v[108:111]
    v_min_u32 v16, -2, v16
    ds_write_b128 v20, v[112:115] offset:0
    s_waitcnt vmcnt(5)
    v_mfma_f32_16x16x32_bf16 v[96:99], v[160:163], v[72:75], v[96:99]
    v_mov_b32 v17, v16
    v_mfma_f32_16x16x32_bf16 v[100:103], v[164:167], v[72:75], v[100:103]
    v_mfma_f32_16x16x32_bf16 v[104:107], v[168:171], v[72:75], v[104:107]
    v_permlane32_swap_b32 v16, v17
    ds_write_b128 v20, v[116:119] offset:1024
    v_mfma_f32_16x16x32_bf16 v[108:111], v[172:175], v[72:75], v[108:111]
    s_waitcnt vmcnt(4)
    v_mfma_f32_16x16x32_bf16 v[96:99], v[176:179], v[76:79], v[96:99]
    v_mfma_f32_16x16x32_bf16 v[100:103], v[180:183], v[76:79], v[100:103]
    ds_write_b128 v20, v[120:123] offset:2048
    v_mfma_f32_16x16x32_bf16 v[104:107], v[184:187], v[76:79], v[104:107]
    v_mfma_f32_16x16x32_bf16 v[108:111], v[188:191], v[76:79], v[108:111]
    s_waitcnt vmcnt(3)
    v_mfma_f32_16x16x32_bf16 v[96:99], v[192:195], v[80:83], v[96:99]
    ds_write_b128 v20, v[124:127] offset:3072
    v_mfma_f32_16x16x32_bf16 v[100:103], v[196:199], v[80:83], v[100:103]
    v_mfma_f32_16x16x32_bf16 v[104:107], v[200:203], v[80:83], v[104:107]
    v_mfma_f32_16x16x32_bf16 v[108:111], v[204:207], v[80:83], v[108:111]
    s_waitcnt vmcnt(2)
    v_mfma_f32_16x16x32_bf16 v[96:99], v[208:211], v[84:87], v[96:99]
    v_mfma_f32_16x16x32_bf16 v[100:103], v[212:215], v[84:87], v[100:103]
    v_mfma_f32_16x16x32_bf16 v[104:107], v[216:219], v[84:87], v[104:107]
    s_waitcnt lgkmcnt(0)
    ds_write_b32 v24, v17
    v_mfma_f32_16x16x32_bf16 v[108:111], v[220:223], v[84:87], v[108:111]
    s_waitcnt vmcnt(1)
    v_mfma_f32_16x16x32_bf16 v[96:99], v[224:227], v[88:91], v[96:99]
    v_mfma_f32_16x16x32_bf16 v[100:103], v[228:231], v[88:91], v[100:103]
    v_mfma_f32_16x16x32_bf16 v[104:107], v[232:235], v[88:91], v[104:107]
    v_mfma_f32_16x16x32_bf16 v[108:111], v[236:239], v[88:91], v[108:111]
    s_waitcnt vmcnt(0)
    v_mfma_f32_16x16x32_bf16 v[96:99], v[240:243], v[92:95], v[96:99]
    v_mfma_f32_16x16x32_bf16 v[100:103], v[244:247], v[92:95], v[100:103]
    v_mfma_f32_16x16x32_bf16 v[104:107], v[248:251], v[92:95], v[104:107]
    v_mfma_f32_16x16x32_bf16 v[108:111], v[252:255], v[92:95], v[108:111]
    s_mov_b32 s97, 0
L_spin22:
    ds_read_b32 v17, v23
    s_waitcnt lgkmcnt(0)
    v_cmp_eq_u32 vcc, -1, v17
    s_cbranch_vccz L_spun23
    s_add_u32 s97, s97, 1
    s_cmp_lt_u32 s97, 1048576
    s_cbranch_scc1 L_spin22
L_spun23:
    ds_read_b128 v[32:35], v21 offset:0
    ds_read_b128 v[36:39], v21 offset:1024
    ds_read_b128 v[40:43], v21 offset:2048
    ds_read_b128 v[44:47], v21 offset:3072
    v_add_f32 v8, v16, v17
    v_mul_f32 v8, 0xbfb8aa3b, v8
    v_exp_f32 v8, v8
    s_nop 0
    v_add_f32 v8, 1.0, v8
    v_rcp_f32 v16, v8
    s_nop 0
    v_sub_f32 v8, 1.0, v16
    ds_write_b32 v23, v16 offset:1024
    s_bitcmp1_b32 s70, 6
    v_cmp_u_f32 vcc, v96, v96
    s_cbranch_scc1 L_takeb
    s_cbranch_vccz L_takeb
    s_add_u32 s70, s70, 64
    s_mov_b32 s97, 0
L_sp24:
    s_mov_b32 s34, 0
    s_atomic_or s34, s[20:21], s70 glc
L_sc25:
    s_waitcnt lgkmcnt(0)
    s_cmp_ge_u32 s34, 8
    s_cbranch_scc1 L_so26
    s_add_u32 s97, s97, 1
    s_cmp_lt_u32 s97, 1048576
    s_cbranch_scc1 L_sp24
L_so26:
    buffer_load_dwordx4 v[64:67], v6, s[20:23], s72 offen offset:0 sc1
    buffer_load_dwordx4 v[68:71], v6, s[20:23], s72 offen offset:2048 sc1
    buffer_load_dwordx4 v[72:75], v6, s[20:23], s73 offen offset:0 sc1
    buffer_load_dwordx4 v[76:79], v6, s[20:23], s73 offen offset:2048 sc1
    buffer_load_dwordx4 v[80:83], v6, s[20:23], s74 offen offset:0 sc1
    buffer_load_dwordx4 v[84:87], v6, s[20:23], s74 offen offset:2048 sc1
    buffer_load_dwordx4 v[88:91], v6, s[20:23], s75 offen offset:0 sc1
    buffer_load_dwordx4 v[92:95], v6, s[20:23], s75 offen offset:2048 sc1
    s_waitcnt vmcnt(7)
    v_mfma_f32_16x16x32_bf16 v[96:99], v[128:131], v[64:67], 0
    v_mfma_f32_16x16x32_bf16 v[100:103], v[132:135], v[64:67], 0
    v_mfma_f32_16x16x32_bf16 v[104:107], v[136:139], v[64:67], 0
    v_mfma_f32_16x16x32_bf16 v[108:111], v[140:143], v[64:67], 0
    s_waitcnt vmcnt(6)
    v_mfma_f32_16x16x32_bf16 v[96:99], v[144:147], v[68:71], v[96:99]
    v_mfma_f32_16x16x32_bf16 v[100:103], v[148:151], v[68:71], v[100:103]
    v_mfma_f32_16x16x32_bf16 v[104:107], v[152:155], v[68:71], v[104:107]
    v_mfma_f32_16x16x32_bf16 v[108:111], v[156:159], v[68:71], v[108:111]
    s_waitcnt vmcnt(5)
    v_mfma_f32_16x16x32_bf16 v[96:99], v[160:163], v[72:75], v[96:99]
    v_mfma_f32_16x16x32_bf16 v[100:103], v[164:167], v[72:75], v[100:103]
    v_mfma_f32_16x16x32_bf16 v[104:107], v[168:171], v[72:75], v[104:107]
    v_mfma_f32_16x16x32_bf16 v[108:111], v[172:175], v[72:75], v[108:111]
    s_waitcnt vmcnt(4)
    v_mfma_f32_16x16x32_bf16 v[96:99], v[176:179], v[76:79], v[96:99]
    v_mfma_f32_16x16x32_bf16 v[100:103], v[180:183], v[76:79], v[100:103]
    v_mfma_f32_16x16x32_bf16 v[104:107], v[184:187], v[76:79], v[104:107]
    v_mfma_f32_16x16x32_bf16 v[108:111], v[188:191], v[76:79], v[108:111]
    s_waitcnt vmcnt(3)
    v_mfma_f32_16x16x32_bf16 v[96:99], v[192:195], v[80:83], v[96:99]
    v_mfma_f32_16x16x32_bf16 v[100:103], v[196:199], v[80:83], v[100:103]
    v_mfma_f32_16x16x32_bf16 v[104:107], v[200:203], v[80:83], v[104:107]
    v_mfma_f32_16x16x32_bf16 v[108:111], v[204:207], v[80:83], v[108:111]
    s_waitcnt vmcnt(2)
    v_mfma_f32_16x16x32_bf16 v[96:99], v[208:211], v[84:87], v[96:99]
    v_mfma_f32_16x16x32_bf16 v[100:103], v[212:215], v[84:87], v[100:103]
    v_mfma_f32_16x16x32_bf16 v[104:107], v[216:219], v[84:87], v[104:107]
    v_mfma_f32_16x16x32_bf16 v[108:111], v[220:223], v[84:87], v[108:111]
    s_waitcnt vmcnt(1)
    v_mfma_f32_16x16x32_bf16 v[96:99], v[224:227], v[88:91], v[96:99]
    v_mfma_f32_16x16x32_bf16 v[100:103], v[228:231], v[88:91], v[100:103]
    v_mfma_f32_16x16x32_bf16 v[104:107], v[232:235], v[88:91], v[104:107]
    v_mfma_f32_16x16x32_bf16 v[108:111], v[236:239], v[88:91], v[108:111]
    s_waitcnt vmcnt(0)
    v_mfma_f32_16x16x32_bf16 v[96:99], v[240:243], v[92:95], v[96:99]
    v_mfma_f32_16x16x32_bf16 v[100:103], v[244:247], v[92:95], v[100:103]
    v_mfma_f32_16x16x32_bf16 v[104:107], v[248:251], v[92:95], v[104:107]
    v_mfma_f32_16x16x32_bf16 v[108:111], v[252:255], v[92:95], v[108:111]
L_takeb:
    s_waitcnt lgkmcnt(4)
    s_nop 6
    v_add_f32 v96, v96, v32
    v_add_f32 v97, v97, v33
    v_add_f32 v98, v98, v34
    v_add_f32 v99, v99, v35
    v_mul_f32 v96, v96, v8
    v_mul_f32 v97, v97, v8
    v_mul_f32 v98, v98, v8
    v_mul_f32 v99, v99, v8
    ds_write_b128 v21, v[96:99] offset:0
    s_waitcnt lgkmcnt(4)
    v_add_f32 v100, v100, v36
    v_add_f32 v101, v101, v37
    v_add_f32 v102, v102, v38
    v_add_f32 v103, v103, v39
    v_mul_f32 v100, v100, v8
    v_mul_f32 v101, v101, v8
    v_mul_f32 v102, v102, v8
    v_mul_f32 v103, v103, v8
    ds_write_b128 v21, v[100:103] offset:1024
    s_waitcnt lgkmcnt(4)
    v_add_f32 v104, v104, v40
    v_add_f32 v105, v105, v41
    v_add_f32 v106, v106, v42
    v_add_f32 v107, v107, v43
    v_mul_f32 v104, v104, v8
    v_mul_f32 v105, v105, v8
    v_mul_f32 v106, v106, v8
    v_mul_f32 v107, v107, v8
    ds_write_b128 v21, v[104:107] offset:2048
    s_waitcnt lgkmcnt(4)
    v_add_f32 v108, v108, v44
    v_add_f32 v109, v109, v45
    v_add_f32 v110, v110, v46
    v_add_f32 v111, v111, v47
    v_mul_f32 v108, v108, v8
    v_mul_f32 v109, v109, v8
    v_mul_f32 v110, v110, v8
    v_mul_f32 v111, v111, v8
    ds_write_b128 v21, v[108:111] offset:3072
    s_waitcnt lgkmcnt(0)
    s_barrier
    s_branch L_done
L_redo:
    s_add_u32 s70, s70, 64
    s_mov_b32 s34, 0
    s_waitcnt vmcnt(0)
    s_nop 7
    s_branch L_p2chk
L_p2a:
    s_setprio 0
    buffer_load_dwordx4 v[32:35], v7, s[20:23], s72 offen offset:0 sc1
    buffer_load_dwordx4 v[36:39], v7, s[20:23], s72 offen offset:2048 sc1
    buffer_load_dwordx4 v[40:43], v7, s[20:23], s73 offen offset:0 sc1
    buffer_load_dwordx4 v[44:47], v7, s[20:23], s73 offen offset:2048 sc1
    buffer_load_dwordx4 v[48:51], v7, s[20:23], s74 offen offset:0 sc1
    buffer_load_dwordx4 v[52:55], v7, s[20:23], s74 offen offset:2048 sc1
    buffer_load_dwordx4 v[56:59], v7, s[20:23], s75 offen offset:0 sc1
    buffer_load_dwordx4 v[60:63], v7, s[20:23], s75 offen offset:2048 sc1
    buffer_load_dwordx4 v[64:67], v6, s[20:23], s72 offen offset:0 sc1
    buffer_load_dwordx4 v[68:71], v6, s[20:23], s72 offen offset:2048 sc1
    s_waitcnt vmcnt(9)
    v_mfma_f32_16x16x32_bf16 v[112:115], v[128:131], v[32:35], 0
    v_mfma_f32_16x16x32_bf16 v[116:119], v[132:135], v[32:35], 0
    v_mfma_f32_16x16x32_bf16 v[120:123], v[136:139], v[32:35], 0
    v_mfma_f32_16x16x32_bf16 v[124:127], v[140:143], v[32:35], 0
    buffer_load_dwordx4 v[72:75], v6, s[20:23], s73 offen offset:0 sc1
    s_waitcnt vmcnt(9)
    v_mfma_f32_16x16x32_bf16 v[112:115], v[144:147], v[36:39], v[112:115]
    v_mfma_f32_16x16x32_bf16 v[116:119], v[148:151], v[36:39], v[116:119]
    v_mfma_f32_16x16x32_bf16 v[120:123], v[152:155], v[36:39], v[120:123]
    v_mfma_f32_16x16x32_bf16 v[124:127], v[156:159], v[36:39], v[124:127]
    buffer_load_dwordx4 v[76:79], v6, s[20:23], s73 offen offset:2048 sc1
    s_waitcnt vmcnt(9)
    v_mfma_f32_16x16x32_bf16 v[112:115], v[160:163], v[40:43], v[112:115]
    v_mfma_f32_16x16x32_bf16 v[116:119], v[164:167], v[40:43], v[116:119]
    v_mfma_f32_16x16x32_bf16 v[120:123], v[168:171], v[40:43], v[120:123]
    v_mfma_f32_16x16x32_bf16 v[124:127], v[172:175], v[40:43], v[124:127]
    buffer_load_dwordx4 v[80:83], v6, s[20:23], s74 offen offset:0 sc1
    s_waitcnt vmcnt(9)
    v_mfma_f32_16x16x32_bf16 v[112:115], v[176:179], v[44:47], v[112:115]
    v_mfma_f32_16x16x32_bf16 v[116:119], v[180:183], v[44:47], v[116:119]
    v_mfma_f32_16x16x32_bf16 v[120:123], v[184:187], v[44:47], v[120:123]
    v_mfma_f32_16x16x32_bf16 v[124:127], v[188:191], v[44:47], v[124:127]
    buffer_load_dwordx4 v[84:87], v6, s[20:23], s74 offen offset:2048 sc1
    s_waitcnt vmcnt(9)
    v_mfma_f32_16x16x32_bf16 v[112:115], v[192:195], v[48:51], v[112:115]
    v_mfma_f32_16x16x32_bf16 v[116:119], v[196:199], v[48:51], v[116:119]
    v_mfma_f32_16x16x32_bf16 v[120:123], v[200:203], v[48:51], v[120:123]
    v_mfma_f32_16x16x32_bf16 v[124:127], v[204:207], v[48:51], v[124:127]
    buffer_load_dwordx4 v[88:91], v6, s[20:23], s75 offen offset:0 sc1
    s_waitcnt vmcnt(9)
    v_mfma_f32_16x16x32_bf16 v[112:115], v[208:211], v[52:55], v[112:115]
    v_mfma_f32_16x16x32_bf16 v[116:119], v[212:215], v[52:55], v[116:119]
    v_mfma_f32_16x16x32_bf16 v[120:123], v[216:219], v[52:55], v[120:123]
    v_mfma_f32_16x16x32_bf16 v[124:127], v[220:223], v[52:55], v[124:127]
    buffer_load_dwordx4 v[92:95], v6, s[20:23], s75 offen offset:2048 sc1
    s_waitcnt vmcnt(9)
    v_mfma_f32_16x16x32_bf16 v[112:115], v[224:227], v[56:59], v[112:115]
    v_mfma_f32_16x16x32_bf16 v[116:119], v[228:231], v[56:59], v[116:119]
    v_mfma_f32_16x16x32_bf16 v[120:123], v[232:235], v[56:59], v[120:123]
    v_mfma_f32_16x16x32_bf16 v[124:127], v[236:239], v[56:59], v[124:127]
    s_waitcnt vmcnt(8)
    v_mfma_f32_16x16x32_bf16 v[112:115], v[240:243], v[60:63], v[112:115]
    v_mfma_f32_16x16x32_bf16 v[116:119], v[244:247], v[60:63], v[116:119]
    v_mfma_f32_16x16x32_bf16 v[120:123], v[248:251], v[60:63], v[120:123]
    v_mfma_f32_16x16x32_bf16 v[124:127], v[252:255], v[60:63], v[124:127]
    s_waitcnt vmcnt(7)
    v_mfma_f32_16x16x32_bf16 v[96:99], v[128:131], v[64:67], 0
    v_mfma_f32_16x16x32_bf16 v[100:103], v[132:135], v[64:67], 0
    v_mfma_f32_16x16x32_bf16 v[104:107], v[136:139], v[64:67], 0
    s_bitcmp1_b32 s70, 6
    v_cmp_u_f32 vcc, v112, v112
    s_cbranch_scc1 L_give27
    s_cbranch_vccnz L_redo
L_give27:
    v_mfma_f32_16x16x32_bf16 v[108:111], v[140:143], v[64:67], 0
    ds_write_b128 v20, v[112:115] offset:0
    s_waitcnt vmcnt(6)
    v_mfma_f32_16x16x32_bf16 v[96:99], v[144:147], v[68:71], v[96:99]
    v_mfma_f32_16x16x32_bf16 v[100:103], v[148:151], v[68:71], v[100:103]
    ds_write_b128 v20, v[116:119] offset:1024
    v_mfma_f32_16x16x32_bf16 v[104:107], v[152:155], v[68:71], v[104:107]
    v_mfma_f32_16x16x32_bf16 v[108:111], v[156:159], v[68:71], v[108:111]
    ds_write_b128 v20, v[120:123] offset:2048
    s_waitcnt vmcnt(5)
    v_mfma_f32_16x16x32_bf16 v[96:99], v[160:163], v[72:75], v[96:99]
    v_mfma_f32_16x16x32_bf16 v[100:103], v[164:167], v[72:75], v[100:103]
    ds_write_b128 v20, v[124:127] offset:3072
    v_mfma_f32_16x16x32_bf16 v[104:107], v[168:171], v[72:75], v[104:107]
    v_mfma_f32_16x16x32_bf16 v[108:111], v[172:175], v[72:75], v[108:111]
    s_waitcnt vmcnt(4)
    v_mfma_f32_16x16x32_bf16 v[96:99], v[176:179], v[76:79], v[96:99]
    v_mfma_f32_16x16x32_bf16 v[100:103], v[180:183], v[76:79], v[100:103]
    v_mfma_f32_16x16x32_bf16 v[104:107], v[184:187], v[76:79], v[104:107]
    s_waitcnt lgkmcnt(0)
    s_barrier
    ds_read_b32 v16, v23 offset:1024
    ds_read_b128 v[32:35], v21 offset:49152
    v_mfma_f32_16x16x32_bf16 v[108:111], v[188:191], v[76:79], v[108:111]
    ds_read_b128 v[48:51], v21 offset:0
    ds_read_b128 v[36:39], v21 offset:50176
    s_waitcnt vmcnt(3)
    v_mfma_f32_16x16x32_bf16 v[96:99], v[192:195], v[80:83], v[96:99]
    ds_read_b128 v[52:55], v21 offset:1024
    ds_read_b128 v[40:43], v21 offset:51200
    v_mfma_f32_16x16x32_bf16 v[100:103], v[196:199], v[80:83], v[100:103]
    ds_read_b128 v[56:59], v21 offset:2048
    ds_read_b128 v[44:47], v21 offset:52224
    v_mfma_f32_16x16x32_bf16 v[104:107], v[200:203], v[80:83], v[104:107]
    ds_read_b128 v[60:63], v21 offset:3072
    v_mfma_f32_16x16x32_bf16 v[108:111], v[204:207], v[80:83], v[108:111]
    s_waitcnt vmcnt(2)
    v_mfma_f32_16x16x32_bf16 v[96:99], v[208:211], v[84:87], v[96:99]
    v_mfma_f32_16x16x32_bf16 v[100:103], v[212:215], v[84:87], v[100:103]
    v_mfma_f32_16x16x32_bf16 v[104:107], v[216:219], v[84:87], v[104:107]
    s_waitcnt lgkmcnt(0)
    v_fmac_f32 v48, v32, v16
    v_fmac_f32 v49, v33, v16
    v_mfma_f32_16x16x32_bf16 v[108:111], v[220:223], v[84:87], v[108:111]
    v_fmac_f32 v50, v34, v16
    v_fmac_f32 v51, v35, v16
    s_waitcnt vmcnt(1)
    v_mfma_f32_16x16x32_bf16 v[96:99], v[224:227], v[88:91], v[96:99]
    v_fmac_f32 v52, v36, v16
    v_fmac_f32 v53, v37, v16
    v_mfma_f32_16x16x32_bf16 v[100:103], v[228:231], v[88:91], v[100:103]
    v_fmac_f32 v54, v38, v16
    v_fmac_f32 v55, v39, v16
    v_mfma_f32_16x16x32_bf16 v[104:107], v[232:235], v[88:91], v[104:107]
    v_fmac_f32 v56, v40, v16
    v_fmac_f32 v57, v41, v16
    v_mfma_f32_16x16x32_bf16 v[108:111], v[236:239], v[88:91], v[108:111]
    v_fmac_f32 v58, v42, v16
    v_fmac_f32 v59, v43, v16
    s_waitcnt vmcnt(0)
    v_mfma_f32_16x16x32_bf16 v[96:99], v[240:243], v[92:95], v[96:99]
    v_fmac_f32 v60, v44, v16
    v_fmac_f32 v61, v45, v16
    v_mfma_f32_16x16x32_bf16 v[100:103], v[244:247], v[92:95], v[100:103]
    v_fmac_f32 v62, v46, v16
    v_fmac_f32 v63, v47, v16
    v_mfma_f32_16x16x32_bf16 v[104:107], v[248:251], v[92:95], v[104:107]
    v_mfma_f32_16x16x32_bf16 v[108:111], v[252:255], v[92:95], v[108:111]
    s_bitcmp1_b32 s70, 6
    v_cmp_u_f32 vcc, v96, v96
    s_cbranch_scc1 L_takea
    s_cbranch_vccz L_takea
    s_add_u32 s70, s70, 64
    s_mov_b32 s97, 0
L_sp28:
    s_mov_b32 s34, 0
    s_atomic_or s34, s[20:21], s70 glc
L_sc29:
    s_waitcnt lgkmcnt(0)
    s_cmp_ge_u32 s34, 8
    s_cbranch_scc1 L_so30
    s_add_u32 s97, s97, 1
    s_cmp_lt_u32 s97, 1048576
    s_cbranch_scc1 L_sp28
L_so30:
    buffer_load_dwordx4 v[64:67], v6, s[20:23], s72 offen offset:0 sc1
    buffer_load_dwordx4 v[68:71], v6, s[20:23], s72 offen offset:2048 sc1
    buffer_load_dwordx4 v[72:75], v6, s[20:23], s73 offen offset:0 sc1
    buffer_load_dwordx4 v[76:79], v6, s[20:23], s73 offen offset:2048 sc1
    buffer_load_dwordx4 v[80:83], v6, s[20:23], s74 offen offset:0 sc1
    buffer_load_dwordx4 v[84:87], v6, s[20:23], s74 offen offset:2048 sc1
    buffer_load_dwordx4 v[88:91], v6, s[20:23], s75 offen offset:0 sc1
    buffer_load_dwordx4 v[92:95], v6, s[20:23], s75 offen offset:2048 sc1
    s_waitcnt vmcnt(7)
    v_mfma_f32_16x16x32_bf16 v[96:99], v[128:131], v[64:67], 0
    v_mfma_f32_16x16x32_bf16 v[100:103], v[132:135], v[64:67], 0
    v_mfma_f32_16x16x32_bf16 v[104:107], v[136:139], v[64:67], 0
    v_mfma_f32_16x16x32_bf16 v[108:111], v[140:143], v[64:67], 0
    s_waitcnt vmcnt(6)
    v_mfma_f32_16x16x32_bf16 v[96:99], v[144:147], v[68:71], v[96:99]
    v_mfma_f32_16x16x32_bf16 v[100:103], v[148:151], v[68:71], v[100:103]
    v_mfma_f32_16x16x32_bf16 v[104:107], v[152:155], v[68:71], v[104:107]
    v_mfma_f32_16x16x32_bf16 v[108:111], v[156:159], v[68:71], v[108:111]
    s_waitcnt vmcnt(5)
    v_mfma_f32_16x16x32_bf16 v[96:99], v[160:163], v[72:75], v[96:99]
    v_mfma_f32_16x16x32_bf16 v[100:103], v[164:167], v[72:75], v[100:103]
    v_mfma_f32_16x16x32_bf16 v[104:107], v[168:171], v[72:75], v[104:107]
    v_mfma_f32_16x16x32_bf16 v[108:111], v[172:175], v[72:75], v[108:111]
    s_waitcnt vmcnt(4)
    v_mfma_f32_16x16x32_bf16 v[96:99], v[176:179], v[76:79], v[96:99]
    v_mfma_f32_16x16x32_bf16 v[100:103], v[180:183], v[76:79], v[100:103]
    v_mfma_f32_16x16x32_bf16 v[104:107], v[184:187], v[76:79], v[104:107]
    v_mfma_f32_16x16x32_bf16 v[108:111], v[188:191], v[76:79], v[108:111]
    s_waitcnt vmcnt(3)
    v_mfma_f32_16x16x32_bf16 v[96:99], v[192:195], v[80:83], v[96:99]
    v_mfma_f32_16x16x32_bf16 v[100:103], v[196:199], v[80:83], v[100:103]
    v_mfma_f32_16x16x32_bf16 v[104:107], v[200:203], v[80:83], v[104:107]
    v_mfma_f32_16x16x32_bf16 v[108:111], v[204:207], v[80:83], v[108:111]
    s_waitcnt vmcnt(2)
    v_mfma_f32_16x16x32_bf16 v[96:99], v[208:211], v[84:87], v[96:99]
    v_mfma_f32_16x16x32_bf16 v[100:103], v[212:215], v[84:87], v[100:103]
    v_mfma_f32_16x16x32_bf16 v[104:107], v[216:219], v[84:87], v[104:107]
    v_mfma_f32_16x16x32_bf16 v[108:111], v[220:223], v[84:87], v[108:111]
    s_waitcnt vmcnt(1)
    v_mfma_f32_16x16x32_bf16 v[96:99], v[224:227], v[88:91], v[96:99]
    v_mfma_f32_16x16x32_bf16 v[100:103], v[228:231], v[88:91], v[100:103]
    v_mfma_f32_16x16x32_bf16 v[104:107], v[232:235], v[88:91], v[104:107]
    v_mfma_f32_16x16x32_bf16 v[108:111], v[236:239], v[88:91], v[108:111]
    s_waitcnt vmcnt(0)
    v_mfma_f32_16x16x32_bf16 v[96:99], v[240:243], v[92:95], v[96:99]
    v_mfma_f32_16x16x32_bf16 v[100:103], v[244:247], v[92:95], v[100:103]
    v_mfma_f32_16x16x32_bf16 v[104:107], v[248:251], v[92:95], v[104:107]
    v_mfma_f32_16x16x32_bf16 v[108:111], v[252:255], v[92:95], v[108:111]
L_takea:
    s_nop 7
    v_pk_fma_f32 v[96:97], v[96:97], v[16:17], v[48:49] op_sel_hi:[1,0,1]
    v_pk_fma_f32 v[98:99], v[98:99], v[16:17], v[50:51] op_sel_hi:[1,0,1]
    v_cvt_pk_bf16_f32 v112, v96, v97
    v_pk_fma_f32 v[100:101], v[100:101], v[16:17], v[52:53] op_sel_hi:[1,0,1]
    v_cvt_pk_bf16_f32 v113, v98, v99
    v_pk_fma_f32 v[102:103], v[102:103], v[16:17], v[54:55] op_sel_hi:[1,0,1]
    v_cvt_pk_bf16_f32 v114, v100, v101
    v_pk_fma_f32 v[104:105], v[104:105], v[16:17], v[56:57] op_sel_hi:[1,0,1]
    v_cvt_pk_bf16_f32 v115, v102, v103
    v_pk_fma_f32 v[106:107], v[106:107], v[16:17], v[58:59] op_sel_hi:[1,0,1]
    v_cvt_pk_bf16_f32 v116, v104, v105
    v_pk_fma_f32 v[108:109], v[108:109], v[16:17], v[60:61] op_sel_hi:[1,0,1]
    v_cvt_pk_bf16_f32 v117, v106, v107
    v_permlane16_swap_b32 v112, v114
    v_permlane16_swap_b32 v113, v115
    buffer_store_dwordx4 v[112:115], v22, s[24:27], s69 offen sc1
    v_pk_fma_f32 v[110:111], v[110:111], v[16:17], v[62:63] op_sel_hi:[1,0,1]
    v_cvt_pk_bf16_f32 v118, v108, v109
    v_cvt_pk_bf16_f32 v119, v110, v111
    s_nop 0
    v_permlane16_swap_b32 v116, v118
    v_permlane16_swap_b32 v117, v119
    buffer_store_dwordx4 v[116:119], v22, s[24:27], s69 offen offset:64 sc1
L_done:
L_end:
    s_endpgm
.if (L_end - gated_mix__linear_kernel_hedgehog__sliding_local_dilated__prompt_kernel) > 49152
.error "code prefetch too short"
.endif
.fill (49664 - (L_end - gated_mix__linear_kernel_hedgehog__sliding_local_dilated__prompt_kernel)) / 4, 4, 0xbf810000
.section .rodata,"a"
.p2align 6
.amdhsa_kernel gated_mix__linear_kernel_hedgehog__sliding_local_dilated__prompt_kernel
  .amdhsa_next_free_vgpr 256
  .amdhsa_next_free_sgpr 102
  .amdhsa_accum_offset 256
  .amdhsa_group_segment_fixed_size 0
  .amdhsa_kernarg_size 88
  .amdhsa_user_sgpr_count 2
  .amdhsa_user_sgpr_kernarg_segment_ptr 1
  .amdhsa_system_sgpr_workgroup_id_x 1
.end_amdhsa_kernel
```
